```python
import torch

def _softmax(x, axis=-1):
    return torch.softmax(x, dim=axis)

def _gelu(x):
    return torch.nn.functional.gelu(x, approximate='tanh')

def _silu(x):
    return torch.nn.functional.silu(x)

def _sigmoid(x):
    return torch.sigmoid(x)

def _layernorm(x, axis=-1, eps=1e-05):
    m = x.mean(dim=axis, keepdim=True)
    v = x.var(dim=axis, keepdim=True, unbiased=False)
    return (x - m) / torch.sqrt(v + eps)

def _scatter_add(tgt, idx, src, axis=0):
    return tgt.clone().index_add_(axis, idx, src)

def _segment_sum(src, seg, n):
    out = torch.zeros((n,) + src.shape[1:], dtype=src.dtype)
    return out.index_add_(0, seg, src)

def _pad(x, pw):
    flat = tuple((v for pair in reversed(pw) for v in pair))
    return torch.nn.functional.pad(x, flat)
kernel_name = 'adaLN_cond__memory_aug_recurrent_mem_tr__mixer_channel_mlp__prompt'

def setup_inputs():

    _w = lambda a: (lambda t: t.to(torch.bfloat16) if t.is_floating_point() else t)(torch.as_tensor(a))

    def _A_setup():
        B, S, Dm = (1, 2048, 640)
        H, Dh = (32, 128)
        M, seg = (8, 32)
        seg = min(seg, S)
        S = S // seg * seg
        return {'x': _w((lambda *s: torch.randn(*s, dtype=torch.bfloat16) * 0.05)(B, S, Dm)), 'mem0': _w((lambda *s: torch.randn(*s, dtype=torch.bfloat16) * 0.4)(B, M, Dm)), 'Wq': _w((lambda *s: torch.randn(*s, dtype=torch.bfloat16) * 1.6)(Dm, H, Dh) * Dm ** (-0.5)), 'Wk': _w((lambda *s: torch.randn(*s, dtype=torch.bfloat16) * 1.6)(Dm, H, Dh) * Dm ** (-0.5)), 'Wv': _w((lambda *s: torch.randn(*s, dtype=torch.bfloat16) * 0.4)(Dm, H, Dh) * Dm ** (-0.5)), 'Wo': _w((lambda *s: torch.randn(*s, dtype=torch.bfloat16) * 0.4)(H, Dh, Dm) * (H * Dh) ** (-0.5)), 'seg_len': seg}
    _A_in = _A_setup()

    def _B_setup():
        B, S, D, F = (1, 2048, 640, 1728)
        return {'x': _w((lambda *s: torch.randn(*s, dtype=torch.bfloat16) * 0.05)(B, S, D)), 'w1': _w((lambda *s: torch.randn(*s, dtype=torch.bfloat16) * 1.6)(D, F) * D ** (-0.5)), 'b1': _w((lambda *s: torch.randn(*s, dtype=torch.bfloat16) * 0.8)(F)), 'w2': _w((lambda *s: torch.randn(*s, dtype=torch.bfloat16) * 0.1)(F, D) * F ** (-0.5)), 'b2': _w((lambda *s: torch.randn(*s, dtype=torch.bfloat16) * 0.1)(D))}
    _B_in = _B_setup()
    return {'A_x': _A_in['x'], 'A_mem0': _A_in['mem0'], 'A_Wq': _A_in['Wq'], 'A_Wk': _A_in['Wk'], 'A_Wv': _A_in['Wv'], 'A_Wo': _A_in['Wo'], 'A_seg_len': _A_in['seg_len'], 'B_x': _B_in['x'], 'B_w1': _B_in['w1'], 'B_b1': _B_in['b1'], 'B_w2': _B_in['w2'], 'B_b2': _B_in['b2'], 'c': _w((lambda *s: torch.randn(*s, dtype=torch.bfloat16) * 0.1)(1, 640) * 8.0), 'w_mod': _w((lambda *s: torch.randn(*s, dtype=torch.bfloat16) * 0.1)(640, 6 * 640) * 640 ** (-0.5) * 8.0)}

def reference(A_x, A_mem0, A_Wq, A_Wk, A_Wv, A_Wo, A_seg_len, B_x, B_w1, B_b1, B_w2, B_b2, c, w_mod):

    def _A_ref(x, mem0, Wq, Wk, Wv, Wo, seg_len):
        B, S, Dm = x.shape
        H, Dh = (Wq.shape[1], Wq.shape[2])
        M = mem0.shape[1]
        scale = Dh ** (-0.5)
        n_seg = S // seg_len
        L = M + seg_len
        idx = torch.arange(L)
        mask = (idx[:, None] < M) | (idx[:, None] >= idx[None, :])
        mem = mem0
        outs = []
        for s in range(n_seg):
            xs = x[:, s * seg_len:(s + 1) * seg_len, :].clone()
            h = torch.concatenate([mem, xs], axis=1)
            q = torch.einsum('btd,dhe->bhte', h, Wq)
            k = torch.einsum('btd,dhe->bhte', h, Wk)
            v = torch.einsum('btd,dhe->bhte', h, Wv)
            scores = torch.einsum('bhqe,bhke->bhqk', q, k) * scale
            scores = torch.where(mask[None, None], scores, -1000000000.0)
            p = _softmax(scores, axis=-1)
            o = torch.einsum('bhqk,bhke->bhqe', p, v)
            o = torch.einsum('bhte,hed->btd', o, Wo)
            mem = o[:, :M, :].clone()
            outs.append(o[:, M:, :])
        return torch.concatenate(outs, axis=1)

    def _B_ref(x, w1, b1, w2, b2):
        y = _layernorm(x, axis=-1)
        h = _gelu(torch.einsum('bsd,df->bsf', y, w1) + b1)
        return torch.einsum('bsf,fd->bsd', h, w2) + b2
    x = A_x
    mod = (_silu(c) @ w_mod).reshape(c.shape[0], 6, 1, -1)
    sa, ca, ga, sb, cb, gb = (mod[:, 0].clone(), mod[:, 1].clone(), mod[:, 2].clone(), mod[:, 3].clone(), mod[:, 4].clone(), mod[:, 5].clone())
    h = _layernorm(x, axis=-1) * (1 + ca) + sa
    x = x + ga * _A_ref(h, A_mem0, A_Wq, A_Wk, A_Wv, A_Wo, A_seg_len)
    h = _layernorm(x, axis=-1) * (1 + cb) + sb
    x = x + gb * _B_ref(h, B_w1, B_b1, B_w2, B_b2)
    return x
```

```asm
; @launch grid=(256,1,1) block=(256,1,1) lds=163840
.amdgcn_target "amdgcn-amd-amdhsa--gfx950"
.text
.globl adaLN_cond__memory_aug_recurrent_mem_tr__mixer_channel_mlp__prompt_kernel
.p2align 8
.type adaLN_cond__memory_aug_recurrent_mem_tr__mixer_channel_mlp__prompt_kernel,@function
adaLN_cond__memory_aug_recurrent_mem_tr__mixer_channel_mlp__prompt_kernel:
    s_cmp_lt_u32 s2, 256
    s_cbranch_scc1 L_start
    s_endpgm
L_exit:
    s_endpgm
L_start:
    s_getpc_b64 s[8:9]
L_pc:
    s_lshr_b32 s10, s2, 3
    s_lshl_b32 s10, s10, 11
    v_min_u32 v2, 15, v0
    v_lshl_add_u32 v2, v2, 7, s10
    v_min_u32 v2, L_last-L_pc, v2
    global_load_dword v252, v2, s[8:9]
    s_load_dwordx2 s[4:5], s[0:1], 128
    s_load_dwordx2 s[96:97], s[0:1], 120
    v_lshrrev_b32 v1, 6, v0
    s_nop 0
    v_readfirstlane_b32 s26, v1
    s_mov_b32 s6, 268435456
    s_mov_b32 s7, 0x20000
    s_mov_b32 s31, 100000
    s_waitcnt lgkmcnt(0)
    s_getreg_b32 s24, hwreg(HW_REG_XCC_ID, 0, 3)
    s_lshr_b32 s25, s2, 3
    s_mov_b32 s98, 0
    s_lshl_b32 s8, s24, 2
    s_lshr_b32 s24, 1733562418, s8
    s_and_b32 s24, s24, 7
L_dispatch:
    s_cmp_ge_u32 s24, 5
    s_cbranch_scc1 L_team
    s_cmp_eq_u32 s24, 4
    s_cbranch_scc1 L_qa
    s_cmp_eq_u32 s24, 3
    s_cbranch_scc1 L_v
    s_cmp_eq_u32 s24, 2
    s_cbranch_scc1 L_k
    s_mov_b32 s27, s24
    s_load_dwordx2 s[76:77], s[0:1], 16
    s_load_dwordx2 s[80:81], s[0:1], 24
    s_load_dwordx2 s[84:85], s[0:1], 32
    s_load_dwordx2 s[88:89], s[0:1], 40
    v_and_b32 v0, 63, v0
    v_and_b32 v40, 15, v0
    v_lshrrev_b32 v41, 4, v0
    v_lshlrev_b32 v4, 4, v0
    v_and_b32 v42, 1, v41
    v_lshrrev_b32 v43, 1, v41
    s_lshr_b32 s53, s26, 1
    s_and_b32 s54, s26, 1
    v_lshlrev_b32 v44, 2, v41
    v_xor_b32 v44, v44, v40
    v_lshlrev_b32 v44, 4, v44
    s_lshl_b32 s55, s25, 8
    v_add_u32 v44, s55, v44
    v_lshlrev_b32 v45, 6, v42
    v_lshl_add_u32 v45, v43, 1, v45
    s_lshl_b32 s55, s53, 2
    s_add_u32 s55, s55, s54
    v_add_u32 v45, s55, v45
    v_lshl_add_u32 v60, v45, 13, v44
    s_mul_i32 s92, s27, 2621440
    s_sub_u32 s51, 2621440, s92
    s_lshl_b32 s63, s26, 12
    s_waitcnt lgkmcnt(0)
    s_mov_b32 s78, 5242880
    s_mov_b32 s79, 0x20000
    s_mov_b32 s82, 5242880
    s_mov_b32 s83, 0x20000
    s_mov_b32 s86, 5242880
    s_mov_b32 s87, 0x20000
    s_mov_b32 s90, 5242880
    s_mov_b32 s91, 0x20000
    s_add_u32 m0, s63, 131072
    s_add_u32 s56, s92, 0
    buffer_load_dwordx4 v60, s[84:87], s56 offen offset:0 lds
    s_add_u32 s56, s92, 1047552
    buffer_load_dwordx4 v60, s[84:87], s56 offen offset:1024 lds
    s_add_u32 s56, s92, 63488
    buffer_load_dwordx4 v60, s[84:87], s56 offen offset:2048 lds
    s_add_u32 s56, s92, 1111040
    buffer_load_dwordx4 v60, s[84:87], s56 offen offset:3072 lds
    s_add_u32 m0, s63, 147456
    s_add_u32 s56, s92, 0
    buffer_load_dwordx4 v60, s[76:79], s56 offen offset:0 lds
    s_add_u32 s56, s92, 1047552
    buffer_load_dwordx4 v60, s[76:79], s56 offen offset:1024 lds
    s_add_u32 s56, s92, 63488
    buffer_load_dwordx4 v60, s[76:79], s56 offen offset:2048 lds
    s_add_u32 s56, s92, 1111040
    buffer_load_dwordx4 v60, s[76:79], s56 offen offset:3072 lds
    s_add_u32 m0, s63, 65536
    s_add_u32 s56, s92, 0
    buffer_load_dwordx4 v60, s[80:83], s56 offen offset:0 lds
    s_add_u32 s56, s92, 1047552
    buffer_load_dwordx4 v60, s[80:83], s56 offen offset:1024 lds
    s_add_u32 s56, s92, 63488
    buffer_load_dwordx4 v60, s[80:83], s56 offen offset:2048 lds
    s_add_u32 s56, s92, 1111040
    buffer_load_dwordx4 v60, s[80:83], s56 offen offset:3072 lds
    s_add_u32 m0, s63, 81920
    s_add_u32 s56, s92, 131072
    buffer_load_dwordx4 v60, s[84:87], s56 offen offset:0 lds
    s_add_u32 s56, s92, 1178624
    buffer_load_dwordx4 v60, s[84:87], s56 offen offset:1024 lds
    s_add_u32 s56, s92, 194560
    buffer_load_dwordx4 v60, s[84:87], s56 offen offset:2048 lds
    s_add_u32 s56, s92, 1242112
    buffer_load_dwordx4 v60, s[84:87], s56 offen offset:3072 lds
    v_lshl_add_u32 v45, v43, 3, v42
    s_lshl_b32 s55, s53, 4
    s_lshl_b32 s56, s54, 2
    s_add_u32 s55, s55, s56
    v_add_u32 v45, s55, v45
    v_lshl_add_u32 v61, v45, 13, v44
    v_bfe_u32 v45, v0, 3, 1
    v_lshl_add_u32 v45, v42, 3, v45
    v_lshl_add_u32 v45, v43, 2, v45
    s_lshl_b32 s55, s53, 6
    s_lshl_b32 s56, s54, 4
    s_add_u32 s55, s55, s56
    v_add_u32 v45, s55, v45
    v_mul_u32_u24 v45, 1280, v45
    v_and_b32 v53, 7, v0
    v_lshlrev_b32 v47, 1, v41
    v_xor_b32 v46, v53, v47
    v_lshl_add_u32 v45, v46, 4, v45
    s_mul_i32 s55, s25, 163840
    s_mul_i32 s56, s27, 640
    s_add_u32 s55, s55, s56
    v_add_u32 v62, s55, v45
    v_bfe_u32 v45, v0, 2, 2
    v_and_b32 v46, 3, v0
    v_xor_b32 v47, s26, v45
    v_lshl_add_u32 v47, v47, 2, v46
    v_lshlrev_b32 v47, 4, v47
    v_lshl_add_u32 v47, v45, 8, v47
    v_lshl_add_u32 v63, v41, 12, v47
    v_lshl_add_u32 v47, v42, 2, v45
    v_lshrrev_b32 v48, 1, v47
    v_xor_b32 v48, s26, v48
    v_lshlrev_b32 v48, 5, v48
    v_lshl_add_u32 v48, v46, 3, v48
    v_lshl_add_u32 v48, v47, 7, v48
    v_lshl_add_u32 v64, v43, 12, v48
    s_add_u32 s55, s63, 49152
    v_add_u32 v18, s55, v4
    v_add_u32 v19, 0x10000, v18
    s_mov_b32 s29, -1
    s_cmp_eq_u32 s26, 0
    s_cselect_b32 s29, s25, s29
    s_and_b32 s53, s25, 3
    s_lshl_b32 s53, s53, 2
    s_or_b32 s53, s53, s26
    s_lshr_b32 s54, s25, 2
    s_add_u32 s54, s54, 32
    s_cmp_eq_u32 s53, 1
    s_cselect_b32 s29, s54, s29
    s_max_i32 s53, s29, 0
    s_lshl_b32 s53, s53, 7
    v_bfe_u32 v47, v0, 1, 1
    v_and_b32 v48, 1, v0
    v_bfe_u32 v49, v0, 2, 1
    v_lshlrev_b32 v50, 3, v48
    v_lshl_add_u32 v50, v42, 4, v50
    v_lshl_add_u32 v50, v47, 5, v50
    v_lshl_add_u32 v50, v49, 6, v50
    v_add_u32 v15, s53, v50
    s_lshl_b32 s53, s27, 6
    s_add_u32 s53, s53, s25
    s_lshl_b32 s53, s53, 8
    s_add_u32 s2, s53, 32768
    v_mov_b32 v1, 0x4444
    v_mov_b32 v50, 0xeeee
    v_cmp_eq_u32 vcc, 1, v47
    s_nop 1
    v_cndmask_b32 v1, v1, v50, vcc
    v_lshl_add_u32 v50, v45, 1, v48
    v_lshlrev_b32 v50, 4, v50
    v_lshl_add_u32 v51, v47, 7, v50
    v_lshl_add_u32 v9, v41, 8, v51
    s_lshl_b32 s53, s26, 10
    v_add_u32 v10, s53, v9
    v_add_u32 v52, s53, v4
    v_lshrrev_b32 v52, 2, v52
    v_add_u32 v6, 0x1000, v52
    v_lshl_add_u32 v52, v46, 4, s53
    v_lshl_add_u32 v52, v42, 6, v52
    v_lshl_add_u32 v52, v45, 7, v52
    v_lshl_add_u32 v5, v43, 9, v52
    v_xor_b32 v7, 0x400, v5
    v_xor_b32 v8, 0x800, v5
    s_lshl_b32 s53, s26, 2
    s_add_u32 s53, s53, 14336
    v_add_u32 v11, s53, v9
    v_lshl_add_u32 v51, v41, 7, v50
    s_lshl_b32 s53, s26, 9
    v_add_u32 v12, s53, v51
    v_lshrrev_b32 v94, 1, v4
    v_mov_b32 v95, 0
    v_lshrrev_b32 v52, 3, v40
    v_lshl_add_u32 v51, v52, 2, v41
    s_lshl_b32 s53, s26, 3
    v_add_u32 v51, s53, v51
    v_lshlrev_b32 v52, 4, v53
    v_lshl_add_u32 v51, v51, 12, v52
    s_lshl_b32 s54, s25, 7
    v_add_u32 v13, s54, v51
    s_lshl_b32 s53, s26, 1
    s_add_u32 s53, s53, 32
    v_add_u32 v51, s53, v43
    v_and_b32 v52, 31, v0
    v_lshlrev_b32 v52, 2, v52
    v_lshl_add_u32 v51, v51, 12, v52
    v_add_u32 v14, s54, v51
    s_lshl_b32 s53, s26, 11
    v_lshl_add_u32 v51, v41, 9, s53
    v_lshl_add_u32 v17, v40, 4, v51
    v_lshrrev_b32 v52, 3, v40
    v_lshl_add_u32 v51, v52, 8, v51
    v_lshl_add_u32 v16, v53, 4, v51
    v_mov_b32 v54, 0x3f80
    v_lshlrev_b32 v55, 4, v48
    v_lshlrev_b32 v55, v55, v54
    v_cmp_eq_u32 vcc, v45, v41
    s_nop 1
    v_cndmask_b32 v55, 0, v55, vcc
    v_cmp_eq_u32 vcc, 0, v47
    s_nop 1
    v_cndmask_b32 v2, 0, v55, vcc
    v_cndmask_b32 v3, v55, 0, vcc
    v_lshlrev_b32 v55, 4, v49
    v_lshlrev_b32 v55, v55, v54
    v_cmp_gt_u32 vcc, 8, v40
    s_nop 1
    v_cndmask_b32 v55, 0, v55, vcc
    v_cmp_eq_u32 vcc, 0, v46
    s_nop 1
    v_cndmask_b32 v56, 0, v55, vcc
    v_cmp_eq_u32 vcc, 1, v46
    s_nop 1
    v_cndmask_b32 v57, 0, v55, vcc
    v_cmp_eq_u32 vcc, 2, v46
    s_nop 1
    v_cndmask_b32 v58, 0, v55, vcc
    v_cmp_eq_u32 vcc, 3, v46
    s_nop 1
    v_cndmask_b32 v59, 0, v55, vcc
    ds_write_b128 v4, v[56:59] offset:17408
    s_mov_b32 s58, 0x33333333
    s_mov_b32 s59, 0x33333333
    s_mov_b32 s46, 1040356334
    s_and_b32 s3, s25, 3
    s_cmp_eq_u32 s25, 31
    s_cselect_b32 s3, 1, s3
    s_and_b32 s53, s25, 28
    s_or_b32 s53, s53, 1
    s_cmp_eq_u32 s25, 19
    s_cselect_b32 s53, 31, s53
    s_cselect_b32 s3, 0, s3
    s_cmp_eq_u32 s25, 23
    s_cselect_b32 s53, 31, s53
    s_cselect_b32 s3, 2, s3
    s_cmp_eq_u32 s25, 27
    s_cselect_b32 s53, 31, s53
    s_cselect_b32 s3, 3, s3
    s_mov_b32 s62, s3
    v_bfe_u32 v70, v0, 1, 4
    v_lshlrev_b32 v71, 7, v48
    v_lshl_add_u32 v70, v70, 13, v71
    s_lshl_b32 s54, s53, 8
    v_add_u32 v70, s54, v70
    s_lshl_b32 s54, s26, 17
    v_add_u32 v71, s54, v70
    s_lshl_b32 s54, s26, 19
    v_add_u32 v70, s54, v70
    s_lshl_b32 s54, s26, 5
    v_add_u32 v72, s54, v0
    v_mul_u32_u24 v72, 1280, v72
    s_mul_i32 s54, s53, 163840
    s_mul_i32 s55, s27, 640
    s_add_u32 s54, s54, s55
    v_add_u32 v72, s54, v72
    v_xor_b32 v0, 0xc00, v5
    s_waitcnt vmcnt(12)
    s_barrier
    v_add_u32 v65, 131072, v63
    s_cmp_lg_u32 s26, 0
    s_cbranch_scc1 L_tr_2
    ds_read_b64_tr_b16 a[0:1], v65 offset:0
    ds_read_b64_tr_b16 a[2:3], v65 offset:1024
    ds_read_b64_tr_b16 a[4:5], v65 offset:2048
    ds_read_b64_tr_b16 a[6:7], v65 offset:3072
    ds_read_b64_tr_b16 a[8:9], v65 offset:8
    ds_read_b64_tr_b16 a[10:11], v65 offset:1032
    ds_read_b64_tr_b16 a[12:13], v65 offset:2056
    ds_read_b64_tr_b16 a[14:15], v65 offset:3080
    s_branch L_tr_1
L_tr_2:
    s_cmp_lg_u32 s26, 1
    s_cbranch_scc1 L_tr_3
    ds_read_b64_tr_b16 a[48:49], v65 offset:0
    ds_read_b64_tr_b16 a[50:51], v65 offset:1024
    ds_read_b64_tr_b16 a[52:53], v65 offset:2048
    ds_read_b64_tr_b16 a[54:55], v65 offset:3072
    ds_read_b64_tr_b16 a[56:57], v65 offset:8
    ds_read_b64_tr_b16 a[58:59], v65 offset:1032
    ds_read_b64_tr_b16 a[60:61], v65 offset:2056
    ds_read_b64_tr_b16 a[62:63], v65 offset:3080
    s_branch L_tr_1
L_tr_3:
    s_cmp_lg_u32 s26, 2
    s_cbranch_scc1 L_tr_4
    ds_read_b64_tr_b16 a[96:97], v65 offset:0
    ds_read_b64_tr_b16 a[98:99], v65 offset:1024
    ds_read_b64_tr_b16 a[100:101], v65 offset:2048
    ds_read_b64_tr_b16 a[102:103], v65 offset:3072
    ds_read_b64_tr_b16 a[104:105], v65 offset:8
    ds_read_b64_tr_b16 a[106:107], v65 offset:1032
    ds_read_b64_tr_b16 a[108:109], v65 offset:2056
    ds_read_b64_tr_b16 a[110:111], v65 offset:3080
    s_branch L_tr_1
L_tr_4:
    ds_read_b64_tr_b16 a[144:145], v65 offset:0
    ds_read_b64_tr_b16 a[146:147], v65 offset:1024
    ds_read_b64_tr_b16 a[148:149], v65 offset:2048
    ds_read_b64_tr_b16 a[150:151], v65 offset:3072
    ds_read_b64_tr_b16 a[152:153], v65 offset:8
    ds_read_b64_tr_b16 a[154:155], v65 offset:1032
    ds_read_b64_tr_b16 a[156:157], v65 offset:2056
    ds_read_b64_tr_b16 a[158:159], v65 offset:3080
L_tr_1:
    s_waitcnt lgkmcnt(0)
    s_waitcnt vmcnt(8)
    s_barrier
    s_add_u32 m0, s63, 98304
    s_add_u32 s56, s92, 131072
    buffer_load_dwordx4 v60, s[76:79], s56 offen offset:0 lds
    s_add_u32 s56, s92, 1178624
    buffer_load_dwordx4 v60, s[76:79], s56 offen offset:1024 lds
    s_add_u32 s56, s92, 194560
    buffer_load_dwordx4 v60, s[76:79], s56 offen offset:2048 lds
    s_add_u32 s56, s92, 1242112
    buffer_load_dwordx4 v60, s[76:79], s56 offen offset:3072 lds
    v_add_u32 v65, 147456, v63
    s_cmp_lg_u32 s26, 0
    s_cbranch_scc1 L_tr_6
    ds_read_b64_tr_b16 a[16:17], v65 offset:0
    ds_read_b64_tr_b16 a[18:19], v65 offset:1024
    ds_read_b64_tr_b16 a[20:21], v65 offset:2048
    ds_read_b64_tr_b16 a[22:23], v65 offset:3072
    ds_read_b64_tr_b16 a[24:25], v65 offset:8
    ds_read_b64_tr_b16 a[26:27], v65 offset:1032
    ds_read_b64_tr_b16 a[28:29], v65 offset:2056
    ds_read_b64_tr_b16 a[30:31], v65 offset:3080
    s_branch L_tr_5
L_tr_6:
    s_cmp_lg_u32 s26, 1
    s_cbranch_scc1 L_tr_7
    ds_read_b64_tr_b16 a[64:65], v65 offset:0
    ds_read_b64_tr_b16 a[66:67], v65 offset:1024
    ds_read_b64_tr_b16 a[68:69], v65 offset:2048
    ds_read_b64_tr_b16 a[70:71], v65 offset:3072
    ds_read_b64_tr_b16 a[72:73], v65 offset:8
    ds_read_b64_tr_b16 a[74:75], v65 offset:1032
    ds_read_b64_tr_b16 a[76:77], v65 offset:2056
    ds_read_b64_tr_b16 a[78:79], v65 offset:3080
    s_branch L_tr_5
L_tr_7:
    s_cmp_lg_u32 s26, 2
    s_cbranch_scc1 L_tr_8
    ds_read_b64_tr_b16 a[112:113], v65 offset:0
    ds_read_b64_tr_b16 a[114:115], v65 offset:1024
    ds_read_b64_tr_b16 a[116:117], v65 offset:2048
    ds_read_b64_tr_b16 a[118:119], v65 offset:3072
    ds_read_b64_tr_b16 a[120:121], v65 offset:8
    ds_read_b64_tr_b16 a[122:123], v65 offset:1032
    ds_read_b64_tr_b16 a[124:125], v65 offset:2056
    ds_read_b64_tr_b16 a[126:127], v65 offset:3080
    s_branch L_tr_5
L_tr_8:
    ds_read_b64_tr_b16 a[160:161], v65 offset:0
    ds_read_b64_tr_b16 a[162:163], v65 offset:1024
    ds_read_b64_tr_b16 a[164:165], v65 offset:2048
    ds_read_b64_tr_b16 a[166:167], v65 offset:3072
    ds_read_b64_tr_b16 a[168:169], v65 offset:8
    ds_read_b64_tr_b16 a[170:171], v65 offset:1032
    ds_read_b64_tr_b16 a[172:173], v65 offset:2056
    ds_read_b64_tr_b16 a[174:175], v65 offset:3080
L_tr_5:
    s_waitcnt lgkmcnt(0)
    s_waitcnt vmcnt(8)
    s_barrier
    s_add_u32 m0, s63, 114688
    s_add_u32 s56, s92, 131072
    buffer_load_dwordx4 v60, s[80:83], s56 offen offset:0 lds
    s_add_u32 s56, s92, 1178624
    buffer_load_dwordx4 v60, s[80:83], s56 offen offset:1024 lds
    s_add_u32 s56, s92, 194560
    buffer_load_dwordx4 v60, s[80:83], s56 offen offset:2048 lds
    s_add_u32 s56, s92, 1242112
    buffer_load_dwordx4 v60, s[80:83], s56 offen offset:3072 lds
    v_add_u32 v65, 65536, v63
    s_cmp_lg_u32 s26, 0
    s_cbranch_scc1 L_tr_10
    ds_read_b64_tr_b16 a[32:33], v65 offset:0
    ds_read_b64_tr_b16 a[34:35], v65 offset:1024
    ds_read_b64_tr_b16 a[36:37], v65 offset:2048
    ds_read_b64_tr_b16 a[38:39], v65 offset:3072
    ds_read_b64_tr_b16 a[40:41], v65 offset:8
    ds_read_b64_tr_b16 a[42:43], v65 offset:1032
    ds_read_b64_tr_b16 a[44:45], v65 offset:2056
    ds_read_b64_tr_b16 a[46:47], v65 offset:3080
    s_branch L_tr_9
L_tr_10:
    s_cmp_lg_u32 s26, 1
    s_cbranch_scc1 L_tr_11
    ds_read_b64_tr_b16 a[80:81], v65 offset:0
    ds_read_b64_tr_b16 a[82:83], v65 offset:1024
    ds_read_b64_tr_b16 a[84:85], v65 offset:2048
    ds_read_b64_tr_b16 a[86:87], v65 offset:3072
    ds_read_b64_tr_b16 a[88:89], v65 offset:8
    ds_read_b64_tr_b16 a[90:91], v65 offset:1032
    ds_read_b64_tr_b16 a[92:93], v65 offset:2056
    ds_read_b64_tr_b16 a[94:95], v65 offset:3080
    s_branch L_tr_9
L_tr_11:
    s_cmp_lg_u32 s26, 2
    s_cbranch_scc1 L_tr_12
    ds_read_b64_tr_b16 a[128:129], v65 offset:0
    ds_read_b64_tr_b16 a[130:131], v65 offset:1024
    ds_read_b64_tr_b16 a[132:133], v65 offset:2048
    ds_read_b64_tr_b16 a[134:135], v65 offset:3072
    ds_read_b64_tr_b16 a[136:137], v65 offset:8
    ds_read_b64_tr_b16 a[138:139], v65 offset:1032
    ds_read_b64_tr_b16 a[140:141], v65 offset:2056
    ds_read_b64_tr_b16 a[142:143], v65 offset:3080
    s_branch L_tr_9
L_tr_12:
    ds_read_b64_tr_b16 a[176:177], v65 offset:0
    ds_read_b64_tr_b16 a[178:179], v65 offset:1024
    ds_read_b64_tr_b16 a[180:181], v65 offset:2048
    ds_read_b64_tr_b16 a[182:183], v65 offset:3072
    ds_read_b64_tr_b16 a[184:185], v65 offset:8
    ds_read_b64_tr_b16 a[186:187], v65 offset:1032
    ds_read_b64_tr_b16 a[188:189], v65 offset:2056
    ds_read_b64_tr_b16 a[190:191], v65 offset:3080
L_tr_9:
    s_waitcnt lgkmcnt(0)
    s_waitcnt vmcnt(8)
    s_barrier
    s_add_u32 m0, s63, 32768
    s_add_u32 s56, s92, 262144
    buffer_load_dwordx4 v60, s[84:87], s56 offen offset:0 lds
    s_add_u32 s56, s92, 1309696
    buffer_load_dwordx4 v60, s[84:87], s56 offen offset:1024 lds
    s_add_u32 s56, s92, 325632
    buffer_load_dwordx4 v60, s[84:87], s56 offen offset:2048 lds
    s_add_u32 s56, s92, 1373184
    buffer_load_dwordx4 v60, s[84:87], s56 offen offset:3072 lds
    v_add_u32 v65, 81920, v63
    s_cmp_lg_u32 s26, 0
    s_cbranch_scc1 L_tr_14
    ds_read_b64_tr_b16 a[48:49], v65 offset:0
    ds_read_b64_tr_b16 a[50:51], v65 offset:1024
    ds_read_b64_tr_b16 a[52:53], v65 offset:2048
    ds_read_b64_tr_b16 a[54:55], v65 offset:3072
    ds_read_b64_tr_b16 a[56:57], v65 offset:8
    ds_read_b64_tr_b16 a[58:59], v65 offset:1032
    ds_read_b64_tr_b16 a[60:61], v65 offset:2056
    ds_read_b64_tr_b16 a[62:63], v65 offset:3080
    s_branch L_tr_13
L_tr_14:
    s_cmp_lg_u32 s26, 1
    s_cbranch_scc1 L_tr_15
    ds_read_b64_tr_b16 a[0:1], v65 offset:0
    ds_read_b64_tr_b16 a[2:3], v65 offset:1024
    ds_read_b64_tr_b16 a[4:5], v65 offset:2048
    ds_read_b64_tr_b16 a[6:7], v65 offset:3072
    ds_read_b64_tr_b16 a[8:9], v65 offset:8
    ds_read_b64_tr_b16 a[10:11], v65 offset:1032
    ds_read_b64_tr_b16 a[12:13], v65 offset:2056
    ds_read_b64_tr_b16 a[14:15], v65 offset:3080
    s_branch L_tr_13
L_tr_15:
    s_cmp_lg_u32 s26, 2
    s_cbranch_scc1 L_tr_16
    ds_read_b64_tr_b16 a[144:145], v65 offset:0
    ds_read_b64_tr_b16 a[146:147], v65 offset:1024
    ds_read_b64_tr_b16 a[148:149], v65 offset:2048
    ds_read_b64_tr_b16 a[150:151], v65 offset:3072
    ds_read_b64_tr_b16 a[152:153], v65 offset:8
    ds_read_b64_tr_b16 a[154:155], v65 offset:1032
    ds_read_b64_tr_b16 a[156:157], v65 offset:2056
    ds_read_b64_tr_b16 a[158:159], v65 offset:3080
    s_branch L_tr_13
L_tr_16:
    ds_read_b64_tr_b16 a[96:97], v65 offset:0
    ds_read_b64_tr_b16 a[98:99], v65 offset:1024
    ds_read_b64_tr_b16 a[100:101], v65 offset:2048
    ds_read_b64_tr_b16 a[102:103], v65 offset:3072
    ds_read_b64_tr_b16 a[104:105], v65 offset:8
    ds_read_b64_tr_b16 a[106:107], v65 offset:1032
    ds_read_b64_tr_b16 a[108:109], v65 offset:2056
    ds_read_b64_tr_b16 a[110:111], v65 offset:3080
L_tr_13:
    s_waitcnt lgkmcnt(0)
    s_waitcnt vmcnt(8)
    s_barrier
    s_add_u32 m0, s63, 131072
    s_add_u32 s56, s92, 262144
    buffer_load_dwordx4 v60, s[76:79], s56 offen offset:0 lds
    s_add_u32 s56, s92, 1309696
    buffer_load_dwordx4 v60, s[76:79], s56 offen offset:1024 lds
    s_add_u32 s56, s92, 325632
    buffer_load_dwordx4 v60, s[76:79], s56 offen offset:2048 lds
    s_add_u32 s56, s92, 1373184
    buffer_load_dwordx4 v60, s[76:79], s56 offen offset:3072 lds
    v_add_u32 v65, 98304, v63
    s_cmp_lg_u32 s26, 0
    s_cbranch_scc1 L_tr_18
    ds_read_b64_tr_b16 a[64:65], v65 offset:0
    ds_read_b64_tr_b16 a[66:67], v65 offset:1024
    ds_read_b64_tr_b16 a[68:69], v65 offset:2048
    ds_read_b64_tr_b16 a[70:71], v65 offset:3072
    ds_read_b64_tr_b16 a[72:73], v65 offset:8
    ds_read_b64_tr_b16 a[74:75], v65 offset:1032
    ds_read_b64_tr_b16 a[76:77], v65 offset:2056
    ds_read_b64_tr_b16 a[78:79], v65 offset:3080
    s_branch L_tr_17
L_tr_18:
    s_cmp_lg_u32 s26, 1
    s_cbranch_scc1 L_tr_19
    ds_read_b64_tr_b16 a[16:17], v65 offset:0
    ds_read_b64_tr_b16 a[18:19], v65 offset:1024
    ds_read_b64_tr_b16 a[20:21], v65 offset:2048
    ds_read_b64_tr_b16 a[22:23], v65 offset:3072
    ds_read_b64_tr_b16 a[24:25], v65 offset:8
    ds_read_b64_tr_b16 a[26:27], v65 offset:1032
    ds_read_b64_tr_b16 a[28:29], v65 offset:2056
    ds_read_b64_tr_b16 a[30:31], v65 offset:3080
    s_branch L_tr_17
L_tr_19:
    s_cmp_lg_u32 s26, 2
    s_cbranch_scc1 L_tr_20
    ds_read_b64_tr_b16 a[160:161], v65 offset:0
    ds_read_b64_tr_b16 a[162:163], v65 offset:1024
    ds_read_b64_tr_b16 a[164:165], v65 offset:2048
    ds_read_b64_tr_b16 a[166:167], v65 offset:3072
    ds_read_b64_tr_b16 a[168:169], v65 offset:8
    ds_read_b64_tr_b16 a[170:171], v65 offset:1032
    ds_read_b64_tr_b16 a[172:173], v65 offset:2056
    ds_read_b64_tr_b16 a[174:175], v65 offset:3080
    s_branch L_tr_17
L_tr_20:
    ds_read_b64_tr_b16 a[112:113], v65 offset:0
    ds_read_b64_tr_b16 a[114:115], v65 offset:1024
    ds_read_b64_tr_b16 a[116:117], v65 offset:2048
    ds_read_b64_tr_b16 a[118:119], v65 offset:3072
    ds_read_b64_tr_b16 a[120:121], v65 offset:8
    ds_read_b64_tr_b16 a[122:123], v65 offset:1032
    ds_read_b64_tr_b16 a[124:125], v65 offset:2056
    ds_read_b64_tr_b16 a[126:127], v65 offset:3080
L_tr_17:
    s_waitcnt lgkmcnt(0)
    s_waitcnt vmcnt(8)
    s_barrier
    s_add_u32 m0, s63, 147456
    s_add_u32 s56, s92, 262144
    buffer_load_dwordx4 v60, s[80:83], s56 offen offset:0 lds
    s_add_u32 s56, s92, 1309696
    buffer_load_dwordx4 v60, s[80:83], s56 offen offset:1024 lds
    s_add_u32 s56, s92, 325632
    buffer_load_dwordx4 v60, s[80:83], s56 offen offset:2048 lds
    s_add_u32 s56, s92, 1373184
    buffer_load_dwordx4 v60, s[80:83], s56 offen offset:3072 lds
    v_add_u32 v65, 114688, v63
    s_cmp_lg_u32 s26, 0
    s_cbranch_scc1 L_tr_22
    ds_read_b64_tr_b16 a[80:81], v65 offset:0
    ds_read_b64_tr_b16 a[82:83], v65 offset:1024
    ds_read_b64_tr_b16 a[84:85], v65 offset:2048
    ds_read_b64_tr_b16 a[86:87], v65 offset:3072
    ds_read_b64_tr_b16 a[88:89], v65 offset:8
    ds_read_b64_tr_b16 a[90:91], v65 offset:1032
    ds_read_b64_tr_b16 a[92:93], v65 offset:2056
    ds_read_b64_tr_b16 a[94:95], v65 offset:3080
    s_branch L_tr_21
L_tr_22:
    s_cmp_lg_u32 s26, 1
    s_cbranch_scc1 L_tr_23
    ds_read_b64_tr_b16 a[32:33], v65 offset:0
    ds_read_b64_tr_b16 a[34:35], v65 offset:1024
    ds_read_b64_tr_b16 a[36:37], v65 offset:2048
    ds_read_b64_tr_b16 a[38:39], v65 offset:3072
    ds_read_b64_tr_b16 a[40:41], v65 offset:8
    ds_read_b64_tr_b16 a[42:43], v65 offset:1032
    ds_read_b64_tr_b16 a[44:45], v65 offset:2056
    ds_read_b64_tr_b16 a[46:47], v65 offset:3080
    s_branch L_tr_21
L_tr_23:
    s_cmp_lg_u32 s26, 2
    s_cbranch_scc1 L_tr_24
    ds_read_b64_tr_b16 a[176:177], v65 offset:0
    ds_read_b64_tr_b16 a[178:179], v65 offset:1024
    ds_read_b64_tr_b16 a[180:181], v65 offset:2048
    ds_read_b64_tr_b16 a[182:183], v65 offset:3072
    ds_read_b64_tr_b16 a[184:185], v65 offset:8
    ds_read_b64_tr_b16 a[186:187], v65 offset:1032
    ds_read_b64_tr_b16 a[188:189], v65 offset:2056
    ds_read_b64_tr_b16 a[190:191], v65 offset:3080
    s_branch L_tr_21
L_tr_24:
    ds_read_b64_tr_b16 a[128:129], v65 offset:0
    ds_read_b64_tr_b16 a[130:131], v65 offset:1024
    ds_read_b64_tr_b16 a[132:133], v65 offset:2048
    ds_read_b64_tr_b16 a[134:135], v65 offset:3072
    ds_read_b64_tr_b16 a[136:137], v65 offset:8
    ds_read_b64_tr_b16 a[138:139], v65 offset:1032
    ds_read_b64_tr_b16 a[140:141], v65 offset:2056
    ds_read_b64_tr_b16 a[142:143], v65 offset:3080
L_tr_21:
    s_waitcnt lgkmcnt(0)
    s_waitcnt vmcnt(8)
    s_barrier
    s_add_u32 m0, s63, 65536
    s_add_u32 s56, s92, 393216
    buffer_load_dwordx4 v60, s[84:87], s56 offen offset:0 lds
    s_add_u32 s56, s92, 1440768
    buffer_load_dwordx4 v60, s[84:87], s56 offen offset:1024 lds
    s_add_u32 s56, s92, 456704
    buffer_load_dwordx4 v60, s[84:87], s56 offen offset:2048 lds
    s_add_u32 s56, s92, 1504256
    buffer_load_dwordx4 v60, s[84:87], s56 offen offset:3072 lds
    v_add_u32 v65, 32768, v63
    s_cmp_lg_u32 s26, 0
    s_cbranch_scc1 L_tr_26
    ds_read_b64_tr_b16 a[96:97], v65 offset:0
    ds_read_b64_tr_b16 a[98:99], v65 offset:1024
    ds_read_b64_tr_b16 a[100:101], v65 offset:2048
    ds_read_b64_tr_b16 a[102:103], v65 offset:3072
    ds_read_b64_tr_b16 a[104:105], v65 offset:8
    ds_read_b64_tr_b16 a[106:107], v65 offset:1032
    ds_read_b64_tr_b16 a[108:109], v65 offset:2056
    ds_read_b64_tr_b16 a[110:111], v65 offset:3080
    s_branch L_tr_25
L_tr_26:
    s_cmp_lg_u32 s26, 1
    s_cbranch_scc1 L_tr_27
    ds_read_b64_tr_b16 a[144:145], v65 offset:0
    ds_read_b64_tr_b16 a[146:147], v65 offset:1024
    ds_read_b64_tr_b16 a[148:149], v65 offset:2048
    ds_read_b64_tr_b16 a[150:151], v65 offset:3072
    ds_read_b64_tr_b16 a[152:153], v65 offset:8
    ds_read_b64_tr_b16 a[154:155], v65 offset:1032
    ds_read_b64_tr_b16 a[156:157], v65 offset:2056
    ds_read_b64_tr_b16 a[158:159], v65 offset:3080
    s_branch L_tr_25
L_tr_27:
    s_cmp_lg_u32 s26, 2
    s_cbranch_scc1 L_tr_28
    ds_read_b64_tr_b16 a[0:1], v65 offset:0
    ds_read_b64_tr_b16 a[2:3], v65 offset:1024
    ds_read_b64_tr_b16 a[4:5], v65 offset:2048
    ds_read_b64_tr_b16 a[6:7], v65 offset:3072
    ds_read_b64_tr_b16 a[8:9], v65 offset:8
    ds_read_b64_tr_b16 a[10:11], v65 offset:1032
    ds_read_b64_tr_b16 a[12:13], v65 offset:2056
    ds_read_b64_tr_b16 a[14:15], v65 offset:3080
    s_branch L_tr_25
L_tr_28:
    ds_read_b64_tr_b16 a[48:49], v65 offset:0
    ds_read_b64_tr_b16 a[50:51], v65 offset:1024
    ds_read_b64_tr_b16 a[52:53], v65 offset:2048
    ds_read_b64_tr_b16 a[54:55], v65 offset:3072
    ds_read_b64_tr_b16 a[56:57], v65 offset:8
    ds_read_b64_tr_b16 a[58:59], v65 offset:1032
    ds_read_b64_tr_b16 a[60:61], v65 offset:2056
    ds_read_b64_tr_b16 a[62:63], v65 offset:3080
L_tr_25:
    s_waitcnt lgkmcnt(0)
    s_waitcnt vmcnt(8)
    s_barrier
    s_add_u32 m0, s63, 81920
    s_add_u32 s56, s92, 393216
    buffer_load_dwordx4 v60, s[76:79], s56 offen offset:0 lds
    s_add_u32 s56, s92, 1440768
    buffer_load_dwordx4 v60, s[76:79], s56 offen offset:1024 lds
    s_add_u32 s56, s92, 456704
    buffer_load_dwordx4 v60, s[76:79], s56 offen offset:2048 lds
    s_add_u32 s56, s92, 1504256
    buffer_load_dwordx4 v60, s[76:79], s56 offen offset:3072 lds
    v_add_u32 v65, 131072, v63
    s_cmp_lg_u32 s26, 0
    s_cbranch_scc1 L_tr_30
    ds_read_b64_tr_b16 a[112:113], v65 offset:0
    ds_read_b64_tr_b16 a[114:115], v65 offset:1024
    ds_read_b64_tr_b16 a[116:117], v65 offset:2048
    ds_read_b64_tr_b16 a[118:119], v65 offset:3072
    ds_read_b64_tr_b16 a[120:121], v65 offset:8
    ds_read_b64_tr_b16 a[122:123], v65 offset:1032
    ds_read_b64_tr_b16 a[124:125], v65 offset:2056
    ds_read_b64_tr_b16 a[126:127], v65 offset:3080
    s_branch L_tr_29
L_tr_30:
    s_cmp_lg_u32 s26, 1
    s_cbranch_scc1 L_tr_31
    ds_read_b64_tr_b16 a[160:161], v65 offset:0
    ds_read_b64_tr_b16 a[162:163], v65 offset:1024
    ds_read_b64_tr_b16 a[164:165], v65 offset:2048
    ds_read_b64_tr_b16 a[166:167], v65 offset:3072
    ds_read_b64_tr_b16 a[168:169], v65 offset:8
    ds_read_b64_tr_b16 a[170:171], v65 offset:1032
    ds_read_b64_tr_b16 a[172:173], v65 offset:2056
    ds_read_b64_tr_b16 a[174:175], v65 offset:3080
    s_branch L_tr_29
L_tr_31:
    s_cmp_lg_u32 s26, 2
    s_cbranch_scc1 L_tr_32
    ds_read_b64_tr_b16 a[16:17], v65 offset:0
    ds_read_b64_tr_b16 a[18:19], v65 offset:1024
    ds_read_b64_tr_b16 a[20:21], v65 offset:2048
    ds_read_b64_tr_b16 a[22:23], v65 offset:3072
    ds_read_b64_tr_b16 a[24:25], v65 offset:8
    ds_read_b64_tr_b16 a[26:27], v65 offset:1032
    ds_read_b64_tr_b16 a[28:29], v65 offset:2056
    ds_read_b64_tr_b16 a[30:31], v65 offset:3080
    s_branch L_tr_29
L_tr_32:
    ds_read_b64_tr_b16 a[64:65], v65 offset:0
    ds_read_b64_tr_b16 a[66:67], v65 offset:1024
    ds_read_b64_tr_b16 a[68:69], v65 offset:2048
    ds_read_b64_tr_b16 a[70:71], v65 offset:3072
    ds_read_b64_tr_b16 a[72:73], v65 offset:8
    ds_read_b64_tr_b16 a[74:75], v65 offset:1032
    ds_read_b64_tr_b16 a[76:77], v65 offset:2056
    ds_read_b64_tr_b16 a[78:79], v65 offset:3080
L_tr_29:
    s_waitcnt lgkmcnt(0)
    s_waitcnt vmcnt(8)
    s_barrier
    s_add_u32 m0, s63, 98304
    s_add_u32 s56, s92, 393216
    buffer_load_dwordx4 v60, s[80:83], s56 offen offset:0 lds
    s_add_u32 s56, s92, 1440768
    buffer_load_dwordx4 v60, s[80:83], s56 offen offset:1024 lds
    s_add_u32 s56, s92, 456704
    buffer_load_dwordx4 v60, s[80:83], s56 offen offset:2048 lds
    s_add_u32 s56, s92, 1504256
    buffer_load_dwordx4 v60, s[80:83], s56 offen offset:3072 lds
    v_add_u32 v65, 147456, v63
    s_cmp_lg_u32 s26, 0
    s_cbranch_scc1 L_tr_34
    ds_read_b64_tr_b16 a[128:129], v65 offset:0
    ds_read_b64_tr_b16 a[130:131], v65 offset:1024
    ds_read_b64_tr_b16 a[132:133], v65 offset:2048
    ds_read_b64_tr_b16 a[134:135], v65 offset:3072
    ds_read_b64_tr_b16 a[136:137], v65 offset:8
    ds_read_b64_tr_b16 a[138:139], v65 offset:1032
    ds_read_b64_tr_b16 a[140:141], v65 offset:2056
    ds_read_b64_tr_b16 a[142:143], v65 offset:3080
    s_branch L_tr_33
L_tr_34:
    s_cmp_lg_u32 s26, 1
    s_cbranch_scc1 L_tr_35
    ds_read_b64_tr_b16 a[176:177], v65 offset:0
    ds_read_b64_tr_b16 a[178:179], v65 offset:1024
    ds_read_b64_tr_b16 a[180:181], v65 offset:2048
    ds_read_b64_tr_b16 a[182:183], v65 offset:3072
    ds_read_b64_tr_b16 a[184:185], v65 offset:8
    ds_read_b64_tr_b16 a[186:187], v65 offset:1032
    ds_read_b64_tr_b16 a[188:189], v65 offset:2056
    ds_read_b64_tr_b16 a[190:191], v65 offset:3080
    s_branch L_tr_33
L_tr_35:
    s_cmp_lg_u32 s26, 2
    s_cbranch_scc1 L_tr_36
    ds_read_b64_tr_b16 a[32:33], v65 offset:0
    ds_read_b64_tr_b16 a[34:35], v65 offset:1024
    ds_read_b64_tr_b16 a[36:37], v65 offset:2048
    ds_read_b64_tr_b16 a[38:39], v65 offset:3072
    ds_read_b64_tr_b16 a[40:41], v65 offset:8
    ds_read_b64_tr_b16 a[42:43], v65 offset:1032
    ds_read_b64_tr_b16 a[44:45], v65 offset:2056
    ds_read_b64_tr_b16 a[46:47], v65 offset:3080
    s_branch L_tr_33
L_tr_36:
    ds_read_b64_tr_b16 a[80:81], v65 offset:0
    ds_read_b64_tr_b16 a[82:83], v65 offset:1024
    ds_read_b64_tr_b16 a[84:85], v65 offset:2048
    ds_read_b64_tr_b16 a[86:87], v65 offset:3072
    ds_read_b64_tr_b16 a[88:89], v65 offset:8
    ds_read_b64_tr_b16 a[90:91], v65 offset:1032
    ds_read_b64_tr_b16 a[92:93], v65 offset:2056
    ds_read_b64_tr_b16 a[94:95], v65 offset:3080
L_tr_33:
    s_waitcnt lgkmcnt(0)
    s_waitcnt vmcnt(8)
    s_barrier
    s_add_u32 m0, s63, 114688
    s_add_u32 s56, s92, 2097152
    buffer_load_dwordx4 v61, s[84:87], s56 offen offset:0 lds
    s_add_u32 s56, s92, 2112512
    buffer_load_dwordx4 v61, s[84:87], s56 offen offset:1024 lds
    s_add_u32 s56, s92, 2357248
    buffer_load_dwordx4 v61, s[84:87], s56 offen offset:2048 lds
    s_add_u32 s56, s92, 2372608
    buffer_load_dwordx4 v61, s[84:87], s56 offen offset:3072 lds
    v_add_u32 v65, 65536, v63
    s_cmp_lg_u32 s26, 0
    s_cbranch_scc1 L_tr_38
    ds_read_b64_tr_b16 a[144:145], v65 offset:0
    ds_read_b64_tr_b16 a[146:147], v65 offset:1024
    ds_read_b64_tr_b16 a[148:149], v65 offset:2048
    ds_read_b64_tr_b16 a[150:151], v65 offset:3072
    ds_read_b64_tr_b16 a[152:153], v65 offset:8
    ds_read_b64_tr_b16 a[154:155], v65 offset:1032
    ds_read_b64_tr_b16 a[156:157], v65 offset:2056
    ds_read_b64_tr_b16 a[158:159], v65 offset:3080
    s_branch L_tr_37
L_tr_38:
    s_cmp_lg_u32 s26, 1
    s_cbranch_scc1 L_tr_39
    ds_read_b64_tr_b16 a[96:97], v65 offset:0
    ds_read_b64_tr_b16 a[98:99], v65 offset:1024
    ds_read_b64_tr_b16 a[100:101], v65 offset:2048
    ds_read_b64_tr_b16 a[102:103], v65 offset:3072
    ds_read_b64_tr_b16 a[104:105], v65 offset:8
    ds_read_b64_tr_b16 a[106:107], v65 offset:1032
    ds_read_b64_tr_b16 a[108:109], v65 offset:2056
    ds_read_b64_tr_b16 a[110:111], v65 offset:3080
    s_branch L_tr_37
L_tr_39:
    s_cmp_lg_u32 s26, 2
    s_cbranch_scc1 L_tr_40
    ds_read_b64_tr_b16 a[48:49], v65 offset:0
    ds_read_b64_tr_b16 a[50:51], v65 offset:1024
    ds_read_b64_tr_b16 a[52:53], v65 offset:2048
    ds_read_b64_tr_b16 a[54:55], v65 offset:3072
    ds_read_b64_tr_b16 a[56:57], v65 offset:8
    ds_read_b64_tr_b16 a[58:59], v65 offset:1032
    ds_read_b64_tr_b16 a[60:61], v65 offset:2056
    ds_read_b64_tr_b16 a[62:63], v65 offset:3080
    s_branch L_tr_37
L_tr_40:
    ds_read_b64_tr_b16 a[0:1], v65 offset:0
    ds_read_b64_tr_b16 a[2:3], v65 offset:1024
    ds_read_b64_tr_b16 a[4:5], v65 offset:2048
    ds_read_b64_tr_b16 a[6:7], v65 offset:3072
    ds_read_b64_tr_b16 a[8:9], v65 offset:8
    ds_read_b64_tr_b16 a[10:11], v65 offset:1032
    ds_read_b64_tr_b16 a[12:13], v65 offset:2056
    ds_read_b64_tr_b16 a[14:15], v65 offset:3080
L_tr_37:
    s_waitcnt lgkmcnt(0)
    s_or_b32 s99, s26, s98
    s_cbranch_scc1 L_ci_41
    s_lshl_b32 s99, s24, 2
    s_lshl_b32 s95, 1, s25
    s_atomic_or s95, s[96:97], s99 glc
L_ci_41:
    s_waitcnt vmcnt(8)
    s_barrier
    s_cmp_lg_u32 s98, 0
    s_cbranch_scc1 L_cc_42
    v_mov_b32 v254, 32760
    s_cmp_lg_u32 s26, 0
    s_cbranch_scc1 L_ccw_43
    s_waitcnt lgkmcnt(0)
    v_mov_b32 v255, s95
    ds_write_b32 v254, v255
    s_waitcnt lgkmcnt(0)
L_ccw_43:
    s_barrier
    ds_read_b32 v255, v254
    s_waitcnt lgkmcnt(0)
    v_readfirstlane_b32 s99, v255
    s_barrier
    s_bitcmp1_b32 s99, s25
    s_cbranch_scc1 L_reclaim
L_cc_42:
    s_add_u32 m0, s63, 32768
    s_add_u32 s56, s51, 0
    buffer_load_dwordx4 v60, s[76:79], s56 offen offset:0 lds
    s_add_u32 s56, s51, 1047552
    buffer_load_dwordx4 v60, s[76:79], s56 offen offset:1024 lds
    s_add_u32 s56, s51, 63488
    buffer_load_dwordx4 v60, s[76:79], s56 offen offset:2048 lds
    s_add_u32 s56, s51, 1111040
    buffer_load_dwordx4 v60, s[76:79], s56 offen offset:3072 lds
    v_add_u32 v65, 81920, v63
    s_cmp_lg_u32 s26, 0
    s_cbranch_scc1 L_tr_45
    ds_read_b64_tr_b16 a[160:161], v65 offset:0
    ds_read_b64_tr_b16 a[162:163], v65 offset:1024
    ds_read_b64_tr_b16 a[164:165], v65 offset:2048
    ds_read_b64_tr_b16 a[166:167], v65 offset:3072
    ds_read_b64_tr_b16 a[168:169], v65 offset:8
    ds_read_b64_tr_b16 a[170:171], v65 offset:1032
    ds_read_b64_tr_b16 a[172:173], v65 offset:2056
    ds_read_b64_tr_b16 a[174:175], v65 offset:3080
    s_branch L_tr_44
L_tr_45:
    s_cmp_lg_u32 s26, 1
    s_cbranch_scc1 L_tr_46
    ds_read_b64_tr_b16 a[112:113], v65 offset:0
    ds_read_b64_tr_b16 a[114:115], v65 offset:1024
    ds_read_b64_tr_b16 a[116:117], v65 offset:2048
    ds_read_b64_tr_b16 a[118:119], v65 offset:3072
    ds_read_b64_tr_b16 a[120:121], v65 offset:8
    ds_read_b64_tr_b16 a[122:123], v65 offset:1032
    ds_read_b64_tr_b16 a[124:125], v65 offset:2056
    ds_read_b64_tr_b16 a[126:127], v65 offset:3080
    s_branch L_tr_44
L_tr_46:
    s_cmp_lg_u32 s26, 2
    s_cbranch_scc1 L_tr_47
    ds_read_b64_tr_b16 a[64:65], v65 offset:0
    ds_read_b64_tr_b16 a[66:67], v65 offset:1024
    ds_read_b64_tr_b16 a[68:69], v65 offset:2048
    ds_read_b64_tr_b16 a[70:71], v65 offset:3072
    ds_read_b64_tr_b16 a[72:73], v65 offset:8
    ds_read_b64_tr_b16 a[74:75], v65 offset:1032
    ds_read_b64_tr_b16 a[76:77], v65 offset:2056
    ds_read_b64_tr_b16 a[78:79], v65 offset:3080
    s_branch L_tr_44
L_tr_47:
    ds_read_b64_tr_b16 a[16:17], v65 offset:0
    ds_read_b64_tr_b16 a[18:19], v65 offset:1024
    ds_read_b64_tr_b16 a[20:21], v65 offset:2048
    ds_read_b64_tr_b16 a[22:23], v65 offset:3072
    ds_read_b64_tr_b16 a[24:25], v65 offset:8
    ds_read_b64_tr_b16 a[26:27], v65 offset:1032
    ds_read_b64_tr_b16 a[28:29], v65 offset:2056
    ds_read_b64_tr_b16 a[30:31], v65 offset:3080
L_tr_44:
    s_waitcnt lgkmcnt(0)
    s_waitcnt vmcnt(8)
    s_barrier
    s_add_u32 m0, s63, 131072
    s_add_u32 s56, s51, 0
    buffer_load_dwordx4 v60, s[80:83], s56 offen offset:0 lds
    s_add_u32 s56, s51, 1047552
    buffer_load_dwordx4 v60, s[80:83], s56 offen offset:1024 lds
    s_add_u32 s56, s51, 63488
    buffer_load_dwordx4 v60, s[80:83], s56 offen offset:2048 lds
    s_add_u32 s56, s51, 1111040
    buffer_load_dwordx4 v60, s[80:83], s56 offen offset:3072 lds
    v_add_u32 v65, 98304, v63
    s_cmp_lg_u32 s26, 0
    s_cbranch_scc1 L_tr_49
    ds_read_b64_tr_b16 a[176:177], v65 offset:0
    ds_read_b64_tr_b16 a[178:179], v65 offset:1024
    ds_read_b64_tr_b16 a[180:181], v65 offset:2048
    ds_read_b64_tr_b16 a[182:183], v65 offset:3072
    ds_read_b64_tr_b16 a[184:185], v65 offset:8
    ds_read_b64_tr_b16 a[186:187], v65 offset:1032
    ds_read_b64_tr_b16 a[188:189], v65 offset:2056
    ds_read_b64_tr_b16 a[190:191], v65 offset:3080
    s_branch L_tr_48
L_tr_49:
    s_cmp_lg_u32 s26, 1
    s_cbranch_scc1 L_tr_50
    ds_read_b64_tr_b16 a[128:129], v65 offset:0
    ds_read_b64_tr_b16 a[130:131], v65 offset:1024
    ds_read_b64_tr_b16 a[132:133], v65 offset:2048
    ds_read_b64_tr_b16 a[134:135], v65 offset:3072
    ds_read_b64_tr_b16 a[136:137], v65 offset:8
    ds_read_b64_tr_b16 a[138:139], v65 offset:1032
    ds_read_b64_tr_b16 a[140:141], v65 offset:2056
    ds_read_b64_tr_b16 a[142:143], v65 offset:3080
    s_branch L_tr_48
L_tr_50:
    s_cmp_lg_u32 s26, 2
    s_cbranch_scc1 L_tr_51
    ds_read_b64_tr_b16 a[80:81], v65 offset:0
    ds_read_b64_tr_b16 a[82:83], v65 offset:1024
    ds_read_b64_tr_b16 a[84:85], v65 offset:2048
    ds_read_b64_tr_b16 a[86:87], v65 offset:3072
    ds_read_b64_tr_b16 a[88:89], v65 offset:8
    ds_read_b64_tr_b16 a[90:91], v65 offset:1032
    ds_read_b64_tr_b16 a[92:93], v65 offset:2056
    ds_read_b64_tr_b16 a[94:95], v65 offset:3080
    s_branch L_tr_48
L_tr_51:
    ds_read_b64_tr_b16 a[32:33], v65 offset:0
    ds_read_b64_tr_b16 a[34:35], v65 offset:1024
    ds_read_b64_tr_b16 a[36:37], v65 offset:2048
    ds_read_b64_tr_b16 a[38:39], v65 offset:3072
    ds_read_b64_tr_b16 a[40:41], v65 offset:8
    ds_read_b64_tr_b16 a[42:43], v65 offset:1032
    ds_read_b64_tr_b16 a[44:45], v65 offset:2056
    ds_read_b64_tr_b16 a[46:47], v65 offset:3080
L_tr_48:
    s_waitcnt lgkmcnt(0)
    s_waitcnt vmcnt(8)
    s_barrier
    s_add_u32 m0, s63, 147456
    s_add_u32 s56, s51, 131072
    buffer_load_dwordx4 v60, s[76:79], s56 offen offset:0 lds
    s_add_u32 s56, s51, 1178624
    buffer_load_dwordx4 v60, s[76:79], s56 offen offset:1024 lds
    s_add_u32 s56, s51, 194560
    buffer_load_dwordx4 v60, s[76:79], s56 offen offset:2048 lds
    s_add_u32 s56, s51, 1242112
    buffer_load_dwordx4 v60, s[76:79], s56 offen offset:3072 lds
    v_add_u32 v65, 114688, v63
    ds_read_b64_tr_b16 a[192:193], v65 offset:0
    ds_read_b64_tr_b16 a[194:195], v65 offset:1024
    ds_read_b64_tr_b16 a[196:197], v65 offset:2048
    ds_read_b64_tr_b16 a[198:199], v65 offset:3072
    ds_read_b64_tr_b16 a[200:201], v65 offset:8
    ds_read_b64_tr_b16 a[202:203], v65 offset:1032
    ds_read_b64_tr_b16 a[204:205], v65 offset:2056
    ds_read_b64_tr_b16 a[206:207], v65 offset:3080
    s_waitcnt lgkmcnt(0)
    s_waitcnt vmcnt(8)
    s_barrier
    s_add_u32 m0, s63, 65536
    s_add_u32 s56, s51, 131072
    buffer_load_dwordx4 v60, s[80:83], s56 offen offset:0 lds
    s_add_u32 s56, s51, 1178624
    buffer_load_dwordx4 v60, s[80:83], s56 offen offset:1024 lds
    s_add_u32 s56, s51, 194560
    buffer_load_dwordx4 v60, s[80:83], s56 offen offset:2048 lds
    s_add_u32 s56, s51, 1242112
    buffer_load_dwordx4 v60, s[80:83], s56 offen offset:3072 lds
    v_add_u32 v65, 32768, v63
    s_cmp_lg_u32 s26, 0
    s_cbranch_scc1 L_tr_53
    ds_read_b64_tr_b16 a[208:209], v65 offset:0
    ds_read_b64_tr_b16 a[210:211], v65 offset:1024
    ds_read_b64_tr_b16 a[212:213], v65 offset:2048
    ds_read_b64_tr_b16 a[214:215], v65 offset:3072
    ds_read_b64_tr_b16 a[216:217], v65 offset:8
    ds_read_b64_tr_b16 a[218:219], v65 offset:1032
    ds_read_b64_tr_b16 a[220:221], v65 offset:2056
    ds_read_b64_tr_b16 a[222:223], v65 offset:3080
    s_branch L_tr_52
L_tr_53:
    s_cmp_lg_u32 s26, 1
    s_cbranch_scc1 L_tr_54
    ds_read_b64_tr_b16 a[240:241], v65 offset:0
    ds_read_b64_tr_b16 a[242:243], v65 offset:1024
    ds_read_b64_tr_b16 a[244:245], v65 offset:2048
    ds_read_b64_tr_b16 a[246:247], v65 offset:3072
    ds_read_b64_tr_b16 a[248:249], v65 offset:8
    ds_read_b64_tr_b16 a[250:251], v65 offset:1032
    ds_read_b64_tr_b16 a[252:253], v65 offset:2056
    ds_read_b64_tr_b16 a[254:255], v65 offset:3080
    s_branch L_tr_52
L_tr_54:
    s_cmp_lg_u32 s26, 2
    s_cbranch_scc1 L_tr_55
    ds_read_b64_tr_b16 v[144:145], v65 offset:0
    ds_read_b64_tr_b16 v[146:147], v65 offset:1024
    ds_read_b64_tr_b16 v[148:149], v65 offset:2048
    ds_read_b64_tr_b16 v[150:151], v65 offset:3072
    ds_read_b64_tr_b16 v[152:153], v65 offset:8
    ds_read_b64_tr_b16 v[154:155], v65 offset:1032
    ds_read_b64_tr_b16 v[156:157], v65 offset:2056
    ds_read_b64_tr_b16 v[158:159], v65 offset:3080
    s_branch L_tr_52
L_tr_55:
    ds_read_b64_tr_b16 v[176:177], v65 offset:0
    ds_read_b64_tr_b16 v[178:179], v65 offset:1024
    ds_read_b64_tr_b16 v[180:181], v65 offset:2048
    ds_read_b64_tr_b16 v[182:183], v65 offset:3072
    ds_read_b64_tr_b16 v[184:185], v65 offset:8
    ds_read_b64_tr_b16 v[186:187], v65 offset:1032
    ds_read_b64_tr_b16 v[188:189], v65 offset:2056
    ds_read_b64_tr_b16 v[190:191], v65 offset:3080
L_tr_52:
    s_waitcnt lgkmcnt(0)
    s_waitcnt vmcnt(8)
    s_barrier
    s_add_u32 m0, s63, 81920
    s_add_u32 s56, s51, 262144
    buffer_load_dwordx4 v60, s[76:79], s56 offen offset:0 lds
    s_add_u32 s56, s51, 1309696
    buffer_load_dwordx4 v60, s[76:79], s56 offen offset:1024 lds
    s_add_u32 s56, s51, 325632
    buffer_load_dwordx4 v60, s[76:79], s56 offen offset:2048 lds
    s_add_u32 s56, s51, 1373184
    buffer_load_dwordx4 v60, s[76:79], s56 offen offset:3072 lds
    v_add_u32 v65, 131072, v63
    s_cmp_lg_u32 s26, 0
    s_cbranch_scc1 L_tr_57
    ds_read_b64_tr_b16 a[224:225], v65 offset:0
    ds_read_b64_tr_b16 a[226:227], v65 offset:1024
    ds_read_b64_tr_b16 a[228:229], v65 offset:2048
    ds_read_b64_tr_b16 a[230:231], v65 offset:3072
    ds_read_b64_tr_b16 a[232:233], v65 offset:8
    ds_read_b64_tr_b16 a[234:235], v65 offset:1032
    ds_read_b64_tr_b16 a[236:237], v65 offset:2056
    ds_read_b64_tr_b16 a[238:239], v65 offset:3080
    s_branch L_tr_56
L_tr_57:
    s_cmp_lg_u32 s26, 1
    s_cbranch_scc1 L_tr_58
    ds_read_b64_tr_b16 v[128:129], v65 offset:0
    ds_read_b64_tr_b16 v[130:131], v65 offset:1024
    ds_read_b64_tr_b16 v[132:133], v65 offset:2048
    ds_read_b64_tr_b16 v[134:135], v65 offset:3072
    ds_read_b64_tr_b16 v[136:137], v65 offset:8
    ds_read_b64_tr_b16 v[138:139], v65 offset:1032
    ds_read_b64_tr_b16 v[140:141], v65 offset:2056
    ds_read_b64_tr_b16 v[142:143], v65 offset:3080
    s_branch L_tr_56
L_tr_58:
    s_cmp_lg_u32 s26, 2
    s_cbranch_scc1 L_tr_59
    ds_read_b64_tr_b16 v[160:161], v65 offset:0
    ds_read_b64_tr_b16 v[162:163], v65 offset:1024
    ds_read_b64_tr_b16 v[164:165], v65 offset:2048
    ds_read_b64_tr_b16 v[166:167], v65 offset:3072
    ds_read_b64_tr_b16 v[168:169], v65 offset:8
    ds_read_b64_tr_b16 v[170:171], v65 offset:1032
    ds_read_b64_tr_b16 v[172:173], v65 offset:2056
    ds_read_b64_tr_b16 v[174:175], v65 offset:3080
    s_branch L_tr_56
L_tr_59:
    ds_read_b64_tr_b16 v[192:193], v65 offset:0
    ds_read_b64_tr_b16 v[194:195], v65 offset:1024
    ds_read_b64_tr_b16 v[196:197], v65 offset:2048
    ds_read_b64_tr_b16 v[198:199], v65 offset:3072
    ds_read_b64_tr_b16 v[200:201], v65 offset:8
    ds_read_b64_tr_b16 v[202:203], v65 offset:1032
    ds_read_b64_tr_b16 v[204:205], v65 offset:2056
    ds_read_b64_tr_b16 v[206:207], v65 offset:3080
L_tr_56:
    s_waitcnt lgkmcnt(0)
    s_waitcnt vmcnt(8)
    s_barrier
    s_add_u32 m0, s63, 98304
    s_add_u32 s56, s51, 262144
    buffer_load_dwordx4 v60, s[80:83], s56 offen offset:0 lds
    s_add_u32 s56, s51, 1309696
    buffer_load_dwordx4 v60, s[80:83], s56 offen offset:1024 lds
    s_add_u32 s56, s51, 325632
    buffer_load_dwordx4 v60, s[80:83], s56 offen offset:2048 lds
    s_add_u32 s56, s51, 1373184
    buffer_load_dwordx4 v60, s[80:83], s56 offen offset:3072 lds
    v_add_u32 v65, 147456, v63
    s_cmp_lg_u32 s26, 0
    s_cbranch_scc1 L_tr_61
    ds_read_b64_tr_b16 a[240:241], v65 offset:0
    ds_read_b64_tr_b16 a[242:243], v65 offset:1024
    ds_read_b64_tr_b16 a[244:245], v65 offset:2048
    ds_read_b64_tr_b16 a[246:247], v65 offset:3072
    ds_read_b64_tr_b16 a[248:249], v65 offset:8
    ds_read_b64_tr_b16 a[250:251], v65 offset:1032
    ds_read_b64_tr_b16 a[252:253], v65 offset:2056
    ds_read_b64_tr_b16 a[254:255], v65 offset:3080
    s_branch L_tr_60
L_tr_61:
    s_cmp_lg_u32 s26, 1
    s_cbranch_scc1 L_tr_62
    ds_read_b64_tr_b16 a[208:209], v65 offset:0
    ds_read_b64_tr_b16 a[210:211], v65 offset:1024
    ds_read_b64_tr_b16 a[212:213], v65 offset:2048
    ds_read_b64_tr_b16 a[214:215], v65 offset:3072
    ds_read_b64_tr_b16 a[216:217], v65 offset:8
    ds_read_b64_tr_b16 a[218:219], v65 offset:1032
    ds_read_b64_tr_b16 a[220:221], v65 offset:2056
    ds_read_b64_tr_b16 a[222:223], v65 offset:3080
    s_branch L_tr_60
L_tr_62:
    s_cmp_lg_u32 s26, 2
    s_cbranch_scc1 L_tr_63
    ds_read_b64_tr_b16 v[176:177], v65 offset:0
    ds_read_b64_tr_b16 v[178:179], v65 offset:1024
    ds_read_b64_tr_b16 v[180:181], v65 offset:2048
    ds_read_b64_tr_b16 v[182:183], v65 offset:3072
    ds_read_b64_tr_b16 v[184:185], v65 offset:8
    ds_read_b64_tr_b16 v[186:187], v65 offset:1032
    ds_read_b64_tr_b16 v[188:189], v65 offset:2056
    ds_read_b64_tr_b16 v[190:191], v65 offset:3080
    s_branch L_tr_60
L_tr_63:
    ds_read_b64_tr_b16 v[144:145], v65 offset:0
    ds_read_b64_tr_b16 v[146:147], v65 offset:1024
    ds_read_b64_tr_b16 v[148:149], v65 offset:2048
    ds_read_b64_tr_b16 v[150:151], v65 offset:3072
    ds_read_b64_tr_b16 v[152:153], v65 offset:8
    ds_read_b64_tr_b16 v[154:155], v65 offset:1032
    ds_read_b64_tr_b16 v[156:157], v65 offset:2056
    ds_read_b64_tr_b16 v[158:159], v65 offset:3080
L_tr_60:
    s_waitcnt lgkmcnt(0)
    s_waitcnt vmcnt(8)
    s_barrier
    s_add_u32 m0, s63, 114688
    s_add_u32 s56, s51, 393216
    buffer_load_dwordx4 v60, s[76:79], s56 offen offset:0 lds
    s_add_u32 s56, s51, 1440768
    buffer_load_dwordx4 v60, s[76:79], s56 offen offset:1024 lds
    s_add_u32 s56, s51, 456704
    buffer_load_dwordx4 v60, s[76:79], s56 offen offset:2048 lds
    s_add_u32 s56, s51, 1504256
    buffer_load_dwordx4 v60, s[76:79], s56 offen offset:3072 lds
    v_add_u32 v65, 65536, v63
    s_cmp_lg_u32 s26, 0
    s_cbranch_scc1 L_tr_65
    ds_read_b64_tr_b16 v[128:129], v65 offset:0
    ds_read_b64_tr_b16 v[130:131], v65 offset:1024
    ds_read_b64_tr_b16 v[132:133], v65 offset:2048
    ds_read_b64_tr_b16 v[134:135], v65 offset:3072
    ds_read_b64_tr_b16 v[136:137], v65 offset:8
    ds_read_b64_tr_b16 v[138:139], v65 offset:1032
    ds_read_b64_tr_b16 v[140:141], v65 offset:2056
    ds_read_b64_tr_b16 v[142:143], v65 offset:3080
    s_branch L_tr_64
L_tr_65:
    s_cmp_lg_u32 s26, 1
    s_cbranch_scc1 L_tr_66
    ds_read_b64_tr_b16 a[224:225], v65 offset:0
    ds_read_b64_tr_b16 a[226:227], v65 offset:1024
    ds_read_b64_tr_b16 a[228:229], v65 offset:2048
    ds_read_b64_tr_b16 a[230:231], v65 offset:3072
    ds_read_b64_tr_b16 a[232:233], v65 offset:8
    ds_read_b64_tr_b16 a[234:235], v65 offset:1032
    ds_read_b64_tr_b16 a[236:237], v65 offset:2056
    ds_read_b64_tr_b16 a[238:239], v65 offset:3080
    s_branch L_tr_64
L_tr_66:
    s_cmp_lg_u32 s26, 2
    s_cbranch_scc1 L_tr_67
    ds_read_b64_tr_b16 v[192:193], v65 offset:0
    ds_read_b64_tr_b16 v[194:195], v65 offset:1024
    ds_read_b64_tr_b16 v[196:197], v65 offset:2048
    ds_read_b64_tr_b16 v[198:199], v65 offset:3072
    ds_read_b64_tr_b16 v[200:201], v65 offset:8
    ds_read_b64_tr_b16 v[202:203], v65 offset:1032
    ds_read_b64_tr_b16 v[204:205], v65 offset:2056
    ds_read_b64_tr_b16 v[206:207], v65 offset:3080
    s_branch L_tr_64
L_tr_67:
    ds_read_b64_tr_b16 v[160:161], v65 offset:0
    ds_read_b64_tr_b16 v[162:163], v65 offset:1024
    ds_read_b64_tr_b16 v[164:165], v65 offset:2048
    ds_read_b64_tr_b16 v[166:167], v65 offset:3072
    ds_read_b64_tr_b16 v[168:169], v65 offset:8
    ds_read_b64_tr_b16 v[170:171], v65 offset:1032
    ds_read_b64_tr_b16 v[172:173], v65 offset:2056
    ds_read_b64_tr_b16 v[174:175], v65 offset:3080
L_tr_64:
    s_waitcnt lgkmcnt(0)
    s_waitcnt vmcnt(8)
    s_barrier
    s_add_u32 m0, s63, 32768
    s_add_u32 s56, s51, 393216
    buffer_load_dwordx4 v60, s[80:83], s56 offen offset:0 lds
    s_add_u32 s56, s51, 1440768
    buffer_load_dwordx4 v60, s[80:83], s56 offen offset:1024 lds
    s_add_u32 s56, s51, 456704
    buffer_load_dwordx4 v60, s[80:83], s56 offen offset:2048 lds
    s_add_u32 s56, s51, 1504256
    buffer_load_dwordx4 v60, s[80:83], s56 offen offset:3072 lds
    s_mov_b32 s53, 0
    s_cmp_eq_u32 s62, 0
    s_cselect_b32 s53, s53, 0x600000
    s_mov_b32 exec_hi, 0
    buffer_load_dword v84, v72, s[88:91], s53 offen
    s_mov_b32 exec_hi, -1
    v_add_u32 v65, 81920, v63
    s_cmp_lg_u32 s26, 0
    s_cbranch_scc1 L_tr_69
    ds_read_b64_tr_b16 v[144:145], v65 offset:0
    ds_read_b64_tr_b16 v[146:147], v65 offset:1024
    ds_read_b64_tr_b16 v[148:149], v65 offset:2048
    ds_read_b64_tr_b16 v[150:151], v65 offset:3072
    ds_read_b64_tr_b16 v[152:153], v65 offset:8
    ds_read_b64_tr_b16 v[154:155], v65 offset:1032
    ds_read_b64_tr_b16 v[156:157], v65 offset:2056
    ds_read_b64_tr_b16 v[158:159], v65 offset:3080
    s_branch L_tr_68
L_tr_69:
    s_cmp_lg_u32 s26, 1
    s_cbranch_scc1 L_tr_70
    ds_read_b64_tr_b16 v[176:177], v65 offset:0
    ds_read_b64_tr_b16 v[178:179], v65 offset:1024
    ds_read_b64_tr_b16 v[180:181], v65 offset:2048
    ds_read_b64_tr_b16 v[182:183], v65 offset:3072
    ds_read_b64_tr_b16 v[184:185], v65 offset:8
    ds_read_b64_tr_b16 v[186:187], v65 offset:1032
    ds_read_b64_tr_b16 v[188:189], v65 offset:2056
    ds_read_b64_tr_b16 v[190:191], v65 offset:3080
    s_branch L_tr_68
L_tr_70:
    s_cmp_lg_u32 s26, 2
    s_cbranch_scc1 L_tr_71
    ds_read_b64_tr_b16 a[208:209], v65 offset:0
    ds_read_b64_tr_b16 a[210:211], v65 offset:1024
    ds_read_b64_tr_b16 a[212:213], v65 offset:2048
    ds_read_b64_tr_b16 a[214:215], v65 offset:3072
    ds_read_b64_tr_b16 a[216:217], v65 offset:8
    ds_read_b64_tr_b16 a[218:219], v65 offset:1032
    ds_read_b64_tr_b16 a[220:221], v65 offset:2056
    ds_read_b64_tr_b16 a[222:223], v65 offset:3080
    s_branch L_tr_68
L_tr_71:
    ds_read_b64_tr_b16 a[240:241], v65 offset:0
    ds_read_b64_tr_b16 a[242:243], v65 offset:1024
    ds_read_b64_tr_b16 a[244:245], v65 offset:2048
    ds_read_b64_tr_b16 a[246:247], v65 offset:3072
    ds_read_b64_tr_b16 a[248:249], v65 offset:8
    ds_read_b64_tr_b16 a[250:251], v65 offset:1032
    ds_read_b64_tr_b16 a[252:253], v65 offset:2056
    ds_read_b64_tr_b16 a[254:255], v65 offset:3080
L_tr_68:
    s_waitcnt lgkmcnt(0)
    s_waitcnt vmcnt(9)
    s_barrier
    s_add_u32 m0, s63, 131072
    s_mov_b32 s56, 0
    buffer_load_dwordx4 v62, s[88:91], s56 offen offset:0 lds
    s_mov_b32 s56, 1536
    buffer_load_dwordx4 v62, s[88:91], s56 offen offset:1024 lds
    s_mov_b32 s56, 38912
    buffer_load_dwordx4 v62, s[88:91], s56 offen offset:2048 lds
    s_mov_b32 s56, 40448
    buffer_load_dwordx4 v62, s[88:91], s56 offen offset:3072 lds
    s_mov_b32 s53, 128
    s_cmp_eq_u32 s62, 2
    s_cselect_b32 s53, s53, 0x600000
    s_mov_b32 exec_hi, 0
    buffer_load_dword v84, v72, s[88:91], s53 offen
    s_mov_b32 exec_hi, -1
    v_add_u32 v65, 98304, v63
    s_cmp_lg_u32 s26, 0
    s_cbranch_scc1 L_tr_73
    ds_read_b64_tr_b16 v[160:161], v65 offset:0
    ds_read_b64_tr_b16 v[162:163], v65 offset:1024
    ds_read_b64_tr_b16 v[164:165], v65 offset:2048
    ds_read_b64_tr_b16 v[166:167], v65 offset:3072
    ds_read_b64_tr_b16 v[168:169], v65 offset:8
    ds_read_b64_tr_b16 v[170:171], v65 offset:1032
    ds_read_b64_tr_b16 v[172:173], v65 offset:2056
    ds_read_b64_tr_b16 v[174:175], v65 offset:3080
    s_branch L_tr_72
L_tr_73:
    s_cmp_lg_u32 s26, 1
    s_cbranch_scc1 L_tr_74
    ds_read_b64_tr_b16 v[192:193], v65 offset:0
    ds_read_b64_tr_b16 v[194:195], v65 offset:1024
    ds_read_b64_tr_b16 v[196:197], v65 offset:2048
    ds_read_b64_tr_b16 v[198:199], v65 offset:3072
    ds_read_b64_tr_b16 v[200:201], v65 offset:8
    ds_read_b64_tr_b16 v[202:203], v65 offset:1032
    ds_read_b64_tr_b16 v[204:205], v65 offset:2056
    ds_read_b64_tr_b16 v[206:207], v65 offset:3080
    s_branch L_tr_72
L_tr_74:
    s_cmp_lg_u32 s26, 2
    s_cbranch_scc1 L_tr_75
    ds_read_b64_tr_b16 a[224:225], v65 offset:0
    ds_read_b64_tr_b16 a[226:227], v65 offset:1024
    ds_read_b64_tr_b16 a[228:229], v65 offset:2048
    ds_read_b64_tr_b16 a[230:231], v65 offset:3072
    ds_read_b64_tr_b16 a[232:233], v65 offset:8
    ds_read_b64_tr_b16 a[234:235], v65 offset:1032
    ds_read_b64_tr_b16 a[236:237], v65 offset:2056
    ds_read_b64_tr_b16 a[238:239], v65 offset:3080
    s_branch L_tr_72
L_tr_75:
    ds_read_b64_tr_b16 v[128:129], v65 offset:0
    ds_read_b64_tr_b16 v[130:131], v65 offset:1024
    ds_read_b64_tr_b16 v[132:133], v65 offset:2048
    ds_read_b64_tr_b16 v[134:135], v65 offset:3072
    ds_read_b64_tr_b16 v[136:137], v65 offset:8
    ds_read_b64_tr_b16 v[138:139], v65 offset:1032
    ds_read_b64_tr_b16 v[140:141], v65 offset:2056
    ds_read_b64_tr_b16 v[142:143], v65 offset:3080
L_tr_72:
    s_waitcnt lgkmcnt(0)
    s_waitcnt vmcnt(10)
    s_barrier
    s_add_u32 m0, s63, 147456
    s_mov_b32 s56, 128
    buffer_load_dwordx4 v62, s[88:91], s56 offen offset:0 lds
    s_mov_b32 s56, 1664
    buffer_load_dwordx4 v62, s[88:91], s56 offen offset:1024 lds
    s_mov_b32 s56, 39040
    buffer_load_dwordx4 v62, s[88:91], s56 offen offset:2048 lds
    s_mov_b32 s56, 40576
    buffer_load_dwordx4 v62, s[88:91], s56 offen offset:3072 lds
    s_add_u32 s53, s92, 2097152
    s_cmp_eq_u32 s62, 3
    s_cselect_b32 s53, s53, 0x600000
    s_mov_b32 exec_hi, 0
    buffer_load_dword v84, v71, s[76:79], s53 offen
    s_mov_b32 exec_hi, -1
    v_add_u32 v65, 114688, v63
    s_cmp_lg_u32 s26, 0
    s_cbranch_scc1 L_tr_77
    ds_read_b64_tr_b16 v[176:177], v65 offset:0
    ds_read_b64_tr_b16 v[178:179], v65 offset:1024
    ds_read_b64_tr_b16 v[180:181], v65 offset:2048
    ds_read_b64_tr_b16 v[182:183], v65 offset:3072
    ds_read_b64_tr_b16 v[184:185], v65 offset:8
    ds_read_b64_tr_b16 v[186:187], v65 offset:1032
    ds_read_b64_tr_b16 v[188:189], v65 offset:2056
    ds_read_b64_tr_b16 v[190:191], v65 offset:3080
    s_branch L_tr_76
L_tr_77:
    s_cmp_lg_u32 s26, 1
    s_cbranch_scc1 L_tr_78
    ds_read_b64_tr_b16 v[144:145], v65 offset:0
    ds_read_b64_tr_b16 v[146:147], v65 offset:1024
    ds_read_b64_tr_b16 v[148:149], v65 offset:2048
    ds_read_b64_tr_b16 v[150:151], v65 offset:3072
    ds_read_b64_tr_b16 v[152:153], v65 offset:8
    ds_read_b64_tr_b16 v[154:155], v65 offset:1032
    ds_read_b64_tr_b16 v[156:157], v65 offset:2056
    ds_read_b64_tr_b16 v[158:159], v65 offset:3080
    s_branch L_tr_76
L_tr_78:
    s_cmp_lg_u32 s26, 2
    s_cbranch_scc1 L_tr_79
    ds_read_b64_tr_b16 a[240:241], v65 offset:0
    ds_read_b64_tr_b16 a[242:243], v65 offset:1024
    ds_read_b64_tr_b16 a[244:245], v65 offset:2048
    ds_read_b64_tr_b16 a[246:247], v65 offset:3072
    ds_read_b64_tr_b16 a[248:249], v65 offset:8
    ds_read_b64_tr_b16 a[250:251], v65 offset:1032
    ds_read_b64_tr_b16 a[252:253], v65 offset:2056
    ds_read_b64_tr_b16 a[254:255], v65 offset:3080
    s_branch L_tr_76
L_tr_79:
    ds_read_b64_tr_b16 a[208:209], v65 offset:0
    ds_read_b64_tr_b16 a[210:211], v65 offset:1024
    ds_read_b64_tr_b16 a[212:213], v65 offset:2048
    ds_read_b64_tr_b16 a[214:215], v65 offset:3072
    ds_read_b64_tr_b16 a[216:217], v65 offset:8
    ds_read_b64_tr_b16 a[218:219], v65 offset:1032
    ds_read_b64_tr_b16 a[220:221], v65 offset:2056
    ds_read_b64_tr_b16 a[222:223], v65 offset:3080
L_tr_76:
    s_waitcnt lgkmcnt(0)
    s_waitcnt vmcnt(11)
    s_barrier
    s_add_u32 m0, s63, 65536
    s_add_u32 s56, s92, 2097152
    buffer_load_dwordx4 v61, s[76:79], s56 offen offset:0 lds
    s_add_u32 s56, s92, 2112512
    buffer_load_dwordx4 v61, s[76:79], s56 offen offset:1024 lds
    s_add_u32 s56, s92, 2357248
    buffer_load_dwordx4 v61, s[76:79], s56 offen offset:2048 lds
    s_add_u32 s56, s92, 2372608
    buffer_load_dwordx4 v61, s[76:79], s56 offen offset:3072 lds
    s_add_u32 s53, s92, 2097152
    s_cmp_eq_u32 s62, 0
    s_cselect_b32 s53, s53, 0x600000
    s_mov_b32 exec_hi, 0
    buffer_load_dword v84, v71, s[80:83], s53 offen
    s_mov_b32 exec_hi, -1
    v_add_u32 v65, 32768, v63
    s_cmp_lg_u32 s26, 0
    s_cbranch_scc1 L_tr_81
    ds_read_b64_tr_b16 v[192:193], v65 offset:0
    ds_read_b64_tr_b16 v[194:195], v65 offset:1024
    ds_read_b64_tr_b16 v[196:197], v65 offset:2048
    ds_read_b64_tr_b16 v[198:199], v65 offset:3072
    ds_read_b64_tr_b16 v[200:201], v65 offset:8
    ds_read_b64_tr_b16 v[202:203], v65 offset:1032
    ds_read_b64_tr_b16 v[204:205], v65 offset:2056
    ds_read_b64_tr_b16 v[206:207], v65 offset:3080
    s_branch L_tr_80
L_tr_81:
    s_cmp_lg_u32 s26, 1
    s_cbranch_scc1 L_tr_82
    ds_read_b64_tr_b16 v[160:161], v65 offset:0
    ds_read_b64_tr_b16 v[162:163], v65 offset:1024
    ds_read_b64_tr_b16 v[164:165], v65 offset:2048
    ds_read_b64_tr_b16 v[166:167], v65 offset:3072
    ds_read_b64_tr_b16 v[168:169], v65 offset:8
    ds_read_b64_tr_b16 v[170:171], v65 offset:1032
    ds_read_b64_tr_b16 v[172:173], v65 offset:2056
    ds_read_b64_tr_b16 v[174:175], v65 offset:3080
    s_branch L_tr_80
L_tr_82:
    s_cmp_lg_u32 s26, 2
    s_cbranch_scc1 L_tr_83
    ds_read_b64_tr_b16 v[128:129], v65 offset:0
    ds_read_b64_tr_b16 v[130:131], v65 offset:1024
    ds_read_b64_tr_b16 v[132:133], v65 offset:2048
    ds_read_b64_tr_b16 v[134:135], v65 offset:3072
    ds_read_b64_tr_b16 v[136:137], v65 offset:8
    ds_read_b64_tr_b16 v[138:139], v65 offset:1032
    ds_read_b64_tr_b16 v[140:141], v65 offset:2056
    ds_read_b64_tr_b16 v[142:143], v65 offset:3080
    s_branch L_tr_80
L_tr_83:
    ds_read_b64_tr_b16 a[224:225], v65 offset:0
    ds_read_b64_tr_b16 a[226:227], v65 offset:1024
    ds_read_b64_tr_b16 a[228:229], v65 offset:2048
    ds_read_b64_tr_b16 a[230:231], v65 offset:3072
    ds_read_b64_tr_b16 a[232:233], v65 offset:8
    ds_read_b64_tr_b16 a[234:235], v65 offset:1032
    ds_read_b64_tr_b16 a[236:237], v65 offset:2056
    ds_read_b64_tr_b16 a[238:239], v65 offset:3080
L_tr_80:
    s_waitcnt lgkmcnt(0)
    s_waitcnt vmcnt(11)
    s_barrier
    s_add_u32 m0, s63, 81920
    s_add_u32 s56, s92, 2097152
    buffer_load_dwordx4 v61, s[80:83], s56 offen offset:0 lds
    s_add_u32 s56, s92, 2112512
    buffer_load_dwordx4 v61, s[80:83], s56 offen offset:1024 lds
    s_add_u32 s56, s92, 2357248
    buffer_load_dwordx4 v61, s[80:83], s56 offen offset:2048 lds
    s_add_u32 s56, s92, 2372608
    buffer_load_dwordx4 v61, s[80:83], s56 offen offset:3072 lds
    s_add_u32 s53, s51, 2097152
    s_cmp_eq_u32 s62, 2
    s_cselect_b32 s53, s53, 0x600000
    s_mov_b32 exec_hi, 0
    buffer_load_dword v84, v71, s[76:79], s53 offen
    s_mov_b32 exec_hi, -1
    v_add_u32 v65, 131072, v64
    ds_read_b64_tr_b16 v[208:209], v65 offset:0
    ds_read_b64_tr_b16 v[210:211], v65 offset:1024
    ds_read_b64_tr_b16 v[212:213], v65 offset:2048
    ds_read_b64_tr_b16 v[214:215], v65 offset:3072
    ds_read_b64_tr_b16 v[216:217], v65 offset:8192
    ds_read_b64_tr_b16 v[218:219], v65 offset:9216
    ds_read_b64_tr_b16 v[220:221], v65 offset:10240
    ds_read_b64_tr_b16 v[222:223], v65 offset:11264
    s_waitcnt lgkmcnt(0)
    s_waitcnt vmcnt(11)
    s_barrier
    s_add_u32 m0, s63, 98304
    s_add_u32 s56, s51, 2097152
    buffer_load_dwordx4 v61, s[76:79], s56 offen offset:0 lds
    s_add_u32 s56, s51, 2112512
    buffer_load_dwordx4 v61, s[76:79], s56 offen offset:1024 lds
    s_add_u32 s56, s51, 2357248
    buffer_load_dwordx4 v61, s[76:79], s56 offen offset:2048 lds
    s_add_u32 s56, s51, 2372608
    buffer_load_dwordx4 v61, s[76:79], s56 offen offset:3072 lds
    s_add_u32 s53, s51, 2097152
    s_cmp_eq_u32 s62, 3
    s_cselect_b32 s53, s53, 0x600000
    s_mov_b32 exec_hi, 0
    buffer_load_dword v84, v71, s[80:83], s53 offen
    s_mov_b32 exec_hi, -1
    v_add_u32 v65, 147456, v64
    ds_read_b64_tr_b16 v[224:225], v65 offset:0
    ds_read_b64_tr_b16 v[226:227], v65 offset:1024
    ds_read_b64_tr_b16 v[228:229], v65 offset:2048
    ds_read_b64_tr_b16 v[230:231], v65 offset:3072
    ds_read_b64_tr_b16 v[232:233], v65 offset:8192
    ds_read_b64_tr_b16 v[234:235], v65 offset:9216
    ds_read_b64_tr_b16 v[236:237], v65 offset:10240
    ds_read_b64_tr_b16 v[238:239], v65 offset:11264
    s_waitcnt lgkmcnt(0)
    s_waitcnt vmcnt(11)
    s_barrier
    s_add_u32 m0, s63, 114688
    s_add_u32 s56, s51, 2097152
    buffer_load_dwordx4 v61, s[80:83], s56 offen offset:0 lds
    s_add_u32 s56, s51, 2112512
    buffer_load_dwordx4 v61, s[80:83], s56 offen offset:1024 lds
    s_add_u32 s56, s51, 2357248
    buffer_load_dwordx4 v61, s[80:83], s56 offen offset:2048 lds
    s_add_u32 s56, s51, 2372608
    buffer_load_dwordx4 v61, s[80:83], s56 offen offset:3072 lds
    s_mov_b32 s53, 256
    s_cmp_eq_u32 s62, 0
    s_cselect_b32 s53, s53, 0x600000
    s_mov_b32 exec_hi, 0
    buffer_load_dword v84, v72, s[88:91], s53 offen
    s_mov_b32 exec_hi, -1
    v_add_u32 v65, 65536, v63
    ds_read_b64_tr_b16 v[96:97], v65 offset:0
    ds_read_b64_tr_b16 v[98:99], v65 offset:1024
    ds_read_b64_tr_b16 v[100:101], v65 offset:2048
    ds_read_b64_tr_b16 v[102:103], v65 offset:3072
    ds_read_b64_tr_b16 v[104:105], v65 offset:8
    ds_read_b64_tr_b16 v[106:107], v65 offset:1032
    ds_read_b64_tr_b16 v[108:109], v65 offset:2056
    ds_read_b64_tr_b16 v[110:111], v65 offset:3080
    s_waitcnt lgkmcnt(0)
    s_waitcnt vmcnt(11)
    s_barrier
    s_add_u32 m0, s63, 32768
    s_mov_b32 s56, 256
    buffer_load_dwordx4 v62, s[88:91], s56 offen offset:0 lds
    s_mov_b32 s56, 1792
    buffer_load_dwordx4 v62, s[88:91], s56 offen offset:1024 lds
    s_mov_b32 s56, 39168
    buffer_load_dwordx4 v62, s[88:91], s56 offen offset:2048 lds
    s_mov_b32 s56, 40704
    buffer_load_dwordx4 v62, s[88:91], s56 offen offset:3072 lds
    s_mov_b32 s53, 384
    s_cmp_eq_u32 s62, 2
    s_cselect_b32 s53, s53, 0x600000
    s_mov_b32 exec_hi, 0
    buffer_load_dword v84, v72, s[88:91], s53 offen
    s_mov_b32 exec_hi, -1
    ds_write_b128 v18, v[96:99] offset:16384
    ds_write_b128 v18, v[100:103] offset:17408
    ds_write_b128 v18, v[104:107] offset:18432
    ds_write_b128 v18, v[108:111] offset:19456
    v_add_u32 v65, 81920, v63
    ds_read_b64_tr_b16 v[112:113], v65 offset:0
    ds_read_b64_tr_b16 v[114:115], v65 offset:1024
    ds_read_b64_tr_b16 v[116:117], v65 offset:2048
    ds_read_b64_tr_b16 v[118:119], v65 offset:3072
    ds_read_b64_tr_b16 v[120:121], v65 offset:8
    ds_read_b64_tr_b16 v[122:123], v65 offset:1032
    ds_read_b64_tr_b16 v[124:125], v65 offset:2056
    ds_read_b64_tr_b16 v[126:127], v65 offset:3080
    s_waitcnt lgkmcnt(0)
    s_waitcnt vmcnt(11)
    s_barrier
    s_add_u32 m0, s63, 131072
    s_mov_b32 s56, 384
    buffer_load_dwordx4 v62, s[88:91], s56 offen offset:0 lds
    s_mov_b32 s56, 1920
    buffer_load_dwordx4 v62, s[88:91], s56 offen offset:1024 lds
    s_mov_b32 s56, 39296
    buffer_load_dwordx4 v62, s[88:91], s56 offen offset:2048 lds
    s_mov_b32 s56, 40832
    buffer_load_dwordx4 v62, s[88:91], s56 offen offset:3072 lds
    s_mov_b32 s53, 512
    s_cmp_eq_u32 s62, 3
    s_cselect_b32 s53, s53, 0x600000
    s_mov_b32 exec_hi, 0
    buffer_load_dword v84, v72, s[88:91], s53 offen
    s_mov_b32 exec_hi, -1
    ds_write_b128 v18, v[112:115] offset:32768
    ds_write_b128 v18, v[116:119] offset:33792
    ds_write_b128 v18, v[120:123] offset:34816
    ds_write_b128 v18, v[124:127] offset:35840
    v_add_u32 v65, 98304, v63
    ds_read_b64_tr_b16 v[96:97], v65 offset:0
    ds_read_b64_tr_b16 v[98:99], v65 offset:1024
    ds_read_b64_tr_b16 v[100:101], v65 offset:2048
    ds_read_b64_tr_b16 v[102:103], v65 offset:3072
    ds_read_b64_tr_b16 v[104:105], v65 offset:8
    ds_read_b64_tr_b16 v[106:107], v65 offset:1032
    ds_read_b64_tr_b16 v[108:109], v65 offset:2056
    ds_read_b64_tr_b16 v[110:111], v65 offset:3080
    s_waitcnt lgkmcnt(0)
    s_waitcnt vmcnt(11)
    s_barrier
    s_add_u32 m0, s63, 147456
    s_mov_b32 s56, 512
    buffer_load_dwordx4 v62, s[88:91], s56 offen offset:0 lds
    s_mov_b32 s56, 2048
    buffer_load_dwordx4 v62, s[88:91], s56 offen offset:1024 lds
    s_mov_b32 s56, 39424
    buffer_load_dwordx4 v62, s[88:91], s56 offen offset:2048 lds
    s_mov_b32 s56, 40960
    buffer_load_dwordx4 v62, s[88:91], s56 offen offset:3072 lds
    s_lshl_b32 s23, s25, 8
    s_add_u32 s23, s23, 3538944
    s_add_u32 s10, s4, s23
    s_addc_u32 s11, s5, 0
    s_load_dwordx8 s[12:19], s[96:97], 128
    s_load_dword s8, s[96:97], 160
    s_waitcnt lgkmcnt(0)
    s_min_u32 s53, s12, s16
    s_min_u32 s53, s53, s8
    s_min_u32 s53, s53, s17
    s_min_u32 s53, s53, s18
    s_cmp_lg_u32 s53, 0
    s_cbranch_scc1 L_sud_84
    v_mbcnt_lo_u32_b32 v66, -1, 0
    v_lshlrev_b32 v66, 2, v66
    s_mov_b64 exec, 369
L_gs_87:
    global_load_dword v67, v66, s[96:97] offset:128 sc1
    s_waitcnt vmcnt(0)
    v_cmp_eq_u32 vcc, 0, v67
    s_cbranch_vccz L_gsd_88
    s_sleep 2
    s_sub_u32 s31, s31, 1
    s_cbranch_scc1 L_exit
    s_branch L_gs_87
L_gsd_88:
    s_mov_b64 exec, -1
    v_readlane_b32 s12, v67, 0
    v_readlane_b32 s16, v67, 4
    v_readlane_b32 s18, v67, 6
L_sud_84:
    s_cmp_eq_u32 s12, 1
    s_cselect_b32 s3, 1, 0
    s_and_b32 s30, s16, 2
    s_lshl_b32 s30, s30, 12
    s_and_b32 s53, s16, 1
    s_lshl_b32 s53, s53, 13
    s_xor_b32 s53, s53, 0
    s_add_u32 s2, s2, s53
    s_xor_b32 s53, s16, s18
    s_bfe_u32 s53, s53, 0x10001
    s_xor_b32 s53, s53, s27
    s_xor_b32 s53, s53, 0
    s_lshl_b32 s53, s53, 14
    s_lshl_b32 s54, s27, 15
    s_add_u32 s53, s53, s54
    s_add_u32 s53, s53, s30
    s_add_u32 s48, s53, 262144
    s_xor_b32 s47, s48, 49152
    s_lshl_b32 s53, s26, 16
    s_add_u32 s53, s53, s48
    s_xor_b32 s53, s53, 8192
    s_lshl_b32 s54, s25, 8
    s_add_u32 s53, s53, s54
    v_lshlrev_b32 v66, 3, v4
    s_mov_b64 exec, 3
    buffer_load_dword v84, v66, s[4:7], s53 offen sc1
    s_mov_b64 exec, -1
    ds_write_b128 v18, v[96:99] offset:49152
    ds_write_b128 v18, v[100:103] offset:50176
    ds_write_b128 v18, v[104:107] offset:51200
    ds_write_b128 v18, v[108:111] offset:52224
    v_add_u32 v65, 114688, v63
    ds_read_b64_tr_b16 v[112:113], v65 offset:0
    ds_read_b64_tr_b16 v[114:115], v65 offset:1024
    ds_read_b64_tr_b16 v[116:117], v65 offset:2048
    ds_read_b64_tr_b16 v[118:119], v65 offset:3072
    ds_read_b64_tr_b16 v[120:121], v65 offset:8
    ds_read_b64_tr_b16 v[122:123], v65 offset:1032
    ds_read_b64_tr_b16 v[124:125], v65 offset:2056
    ds_read_b64_tr_b16 v[126:127], v65 offset:3080
    s_waitcnt lgkmcnt(0)
    s_load_dword s8, s[10:11], 0 glc
    s_load_dword s9, s[10:11], 8192 glc
    s_waitcnt vmcnt(11)
    s_barrier
L_sv_89:
    s_waitcnt lgkmcnt(0)
    s_min_u32 s22, s8, s9
    s_cmp_lg_u32 s22, 0
    s_cbranch_scc1 L_svd_90
    s_sleep 1
    s_sub_u32 s31, s31, 1
    s_cbranch_scc1 L_exit
    s_load_dword s8, s[10:11], 0 glc
    s_load_dword s9, s[10:11], 8192 glc
    s_branch L_sv_89
L_svd_90:
    s_lshl_b32 s53, s25, 13
    s_add_u32 s44, s53, 33554432
    s_add_u32 s20, s53, 33553664
    s_add_u32 s43, s53, 16775168
    s_add_u32 s21, s53, 16774272
    s_add_u32 m0, s63, 49152
    s_nop 0
    buffer_load_dwordx4 v16, s[4:7], s43 offen offset:2048 sc1 lds
    buffer_load_dwordx4 v16, s[4:7], s21 offen offset:3072 sc1 lds
    buffer_load_dwordx4 v17, s[4:7], s44 offen sc1 lds
    buffer_load_dwordx4 v17, s[4:7], s20 offen offset:1024 sc1 lds
    ds_write_b128 v19, v[112:115] offset:0
    ds_write_b128 v19, v[116:119] offset:1024
    ds_write_b128 v19, v[120:123] offset:2048
    ds_write_b128 v19, v[124:127] offset:3072
    v_add_u32 v65, 32768, v64
    ds_read_b64_tr_b16 v[240:241], v65 offset:0
    ds_read_b64_tr_b16 v[242:243], v65 offset:1024
    ds_read_b64_tr_b16 v[244:245], v65 offset:2048
    ds_read_b64_tr_b16 v[246:247], v65 offset:3072
    ds_read_b64_tr_b16 v[248:249], v65 offset:8192
    ds_read_b64_tr_b16 v[250:251], v65 offset:9216
    ds_read_b64_tr_b16 v[252:253], v65 offset:10240
    ds_read_b64_tr_b16 v[254:255], v65 offset:11264
    s_waitcnt lgkmcnt(0)
    s_waitcnt vmcnt(10)
    s_barrier
    v_add_u32 v65, 131072, v64
    ds_read_b64_tr_b16 v[96:97], v65 offset:0
    ds_read_b64_tr_b16 v[98:99], v65 offset:1024
    ds_read_b64_tr_b16 v[100:101], v65 offset:2048
    ds_read_b64_tr_b16 v[102:103], v65 offset:3072
    ds_read_b64_tr_b16 v[104:105], v65 offset:8192
    ds_read_b64_tr_b16 v[106:107], v65 offset:9216
    ds_read_b64_tr_b16 v[108:109], v65 offset:10240
    ds_read_b64_tr_b16 v[110:111], v65 offset:11264
    s_waitcnt lgkmcnt(0)
    s_load_dword s8, s[10:11], 0 glc
    s_load_dword s9, s[10:11], 8192 glc
    s_waitcnt vmcnt(5)
    s_barrier
    ds_write_b128 v19, v[96:99] offset:16384
    ds_write_b128 v19, v[100:103] offset:17408
    ds_write_b128 v19, v[104:107] offset:18432
    ds_write_b128 v19, v[108:111] offset:19456
    v_add_u32 v65, 147456, v64
    ds_read_b64_tr_b16 v[112:113], v65 offset:0
    ds_read_b64_tr_b16 v[114:115], v65 offset:1024
    ds_read_b64_tr_b16 v[116:117], v65 offset:2048
    ds_read_b64_tr_b16 v[118:119], v65 offset:3072
    ds_read_b64_tr_b16 v[120:121], v65 offset:8192
    ds_read_b64_tr_b16 v[122:123], v65 offset:9216
    ds_read_b64_tr_b16 v[124:125], v65 offset:10240
    ds_read_b64_tr_b16 v[126:127], v65 offset:11264
    s_waitcnt lgkmcnt(0)
    s_waitcnt vmcnt(0)
    s_barrier
    ds_write_b128 v19, v[112:115] offset:32768
    ds_write_b128 v19, v[116:119] offset:33792
    ds_write_b128 v19, v[120:123] offset:34816
    ds_write_b128 v19, v[124:127] offset:35840
    s_lshl_b32 s53, s27, 2
    s_add_u32 s53, s53, s26
    s_lshl_b32 s53, s53, 5
    s_add_u32 s53, s53, s25
    s_mul_i32 s53, s53, 5120
    s_add_u32 s53, s53, 2097152
    v_lshlrev_b32 v66, 3, v4
    s_mov_b32 exec_hi, 0xff
    buffer_load_dword v84, v66, s[4:7], s53 offen sc1
    s_mov_b32 exec_hi, -1
    s_add_u32 m0, s63, 49152
    s_lshl_b32 s53, s27, 5
    s_add_u32 s53, s53, s25
    s_lshl_b32 s53, s53, 14
    s_lshl_b32 s54, s26, 9
    s_add_u32 s53, s53, s54
    s_add_u32 s53, s53, s30
    s_add_u32 s50, s53, 1048576
    s_mul_i32 s53, s27, 655360
    s_add_u32 s52, s53, 2097152
    s_lshl_b32 s53, s25, 12
    s_lshl_b32 s54, s26, 10
    s_add_u32 s53, s53, s54
    s_add_u32 s45, s53, 67108864
    s_lshl_b32 s54, s27, 9
    s_add_u32 s53, s53, s54
    s_add_u32 s16, s53, 75497472
    s_cmp_eq_u32 s27, 0
    s_cselect_b32 s14, -1, 0
    s_cselect_b32 s15, 0, -1
    s_mul_i32 s53, s25, 5120
    s_add_u32 s17, s53, s52
    s_mov_b32 s12, s46
    s_mov_b32 s13, s46
    s_mov_b32 s28, 0
    s_cmp_eq_u32 s26, 3
    s_cselect_b32 s2, s2, 268435456
    s_cmp_lt_i32 s29, 0
    s_cselect_b32 vcc_lo, 1, 0x00ff00ff
    s_mov_b32 vcc_hi, 0
    v_mov_b32 v66, 268435456
    v_cndmask_b32 v15, v66, v15, vcc
    s_lshl_b32 s53, s3, 13
    s_xor_b32 s49, s48, s53
    ds_read_b128 v[96:99], v18 offset:16384
    ds_read_b128 v[100:103], v18 offset:17408
    ds_read_b128 v[104:107], v18 offset:18432
    ds_read_b128 v[108:111], v18 offset:19456
    ds_read_b128 v[112:115], v18 offset:32768
    ds_read_b128 v[116:119], v18 offset:33792
    ds_read_b128 v[120:123], v18 offset:34816
    ds_read_b128 v[124:127], v18 offset:35840
    s_and_b32 s53, s28, 3
    s_xor_b32 s54, s53, 2
    s_mul_i32 s54, s54, 163840
    s_add_u32 s42, s17, s54
    s_mul_i32 s54, s53, 163840
    s_add_u32 s40, s52, s54
    s_lshl_b32 s53, s53, 16
    s_add_u32 s32, s47, s53
    s_add_u32 s33, s48, s53
    s_add_u32 s34, s49, s53
    s_xor_b32 s54, s53, 131072
    s_add_u32 s36, s49, s54
    s_add_u32 s54, s48, s54
    s_cmp_lt_i32 s29, 0
    s_cselect_b32 s57, s2, s54
    s_cselect_b32 s35, s28, -1
    s_add_u32 s18, s28, 2
    s_min_u32 s18, s18, 64
    s_add_u32 s53, s28, s25
    s_and_b32 s53, s53, 3
    s_lshl_b32 s53, s53, 11
    s_add_u32 s37, s50, s53
    s_xor_b32 s38, s37, 524288
    s_xor_b32 s39, s37, 4096
    s_add_u32 s44, s44, 262144
    s_add_u32 s20, s20, 262144
    s_add_u32 s43, s43, 262144
    s_add_u32 s21, s21, 262144
    s_min_u32 s8, s8, s9
    s_max_u32 s22, s22, s8
    s_cmp_lt_u32 s22, s18
    s_cbranch_scc1 L_kre_92
L_kok_91:
    s_cmp_eq_u32 s3, 0
    s_cbranch_scc1 L_in_93
    s_branch L_in_94
L_kre_92:
    v_lshlrev_b32 v20, 9, v4
    s_mov_b64 exec, 3
L_wf_95:
    buffer_load_dword v21, v20, s[4:7], s23 offen sc1
    s_waitcnt vmcnt(0)
    v_cmp_gt_u32 vcc, s18, v21
    s_cbranch_vccz L_wfd_96
    s_sleep 1
    s_sub_u32 s31, s31, 1
    s_cbranch_scc1 L_exit
    s_branch L_wf_95
L_wfd_96:
    s_mov_b64 exec, -1
    v_readlane_b32 s22, v21, 0
    v_readlane_b32 s56, v21, 1
    s_nop 0
    s_min_u32 s22, s22, s56
    s_branch L_kok_91
L_in_94:
L_step_98:
    v_mov_b64 v[52:53], 0
    s_nop 4
    v_mov_b64 v[54:55], 0
    s_nop 4
    v_mov_b64 v[56:57], 0
    s_nop 4
    v_mov_b64 v[58:59], 0
    s_nop 4
    v_mov_b64 v[60:61], 0
    s_nop 4
    v_mov_b64 v[62:63], 0
    s_nop 4
    buffer_load_dwordx4 v[32:35], v5, s[4:7], s34 offen sc1
    buffer_load_dword v26, v6, s[4:7], s34 offen sc1
    v_mov_b64 v[64:65], 0
    s_nop 3
    v_mov_b64 v[66:67], 0
    s_nop 3
    v_mov_b64 v[68:69], 0
    s_nop 3
    v_mov_b64 v[70:71], 0
    s_nop 3
    v_mov_b64 v[72:73], 0
    s_nop 3
    v_mov_b64 v[74:75], 0
    s_nop 3
    v_mov_b32 v92, s35
    s_nop 3
    v_mov_b32 v93, s35
    s_nop 3
    buffer_load_dwordx4 v[28:31], v5, s[4:7], s34 offen sc1
    buffer_load_dword v27, v6, s[4:7], s34 offen sc1
    s_waitcnt vmcnt(2)
    ds_write_b128 v5, v[32:35] offset:5120
    ds_write_b32 v6, v26 offset:5120
    v_max3_u32 v20, v32, v33, v34
    v_max3_u32 v20, v20, v35, v26
    v_cmp_eq_u32 vcc, -1, v20
L_lok_99:
    v_smfmac_f32_16x16x64_bf16 v[68:71], v[32:35], a[0:7], v1
    v_smfmac_f32_16x16x64_bf16 v[72:75], v[32:35], a[8:15], v1
    s_waitcnt lgkmcnt(0)
    s_cbranch_vccnz L_lre_100
    s_barrier
    ds_read_b128 v[48:51], v4 offset:9216
    ds_read_b128 v[36:39], v7 offset:5120
    buffer_load_dwordx4 v[28:31], v5, s[4:7], s32 offen sc1
    v_smfmac_f32_16x16x64_bf16 v[52:55], v[32:35], a[16:23], v1
    ds_read_b128 v[40:43], v8 offset:5120
    ds_read_b128 v[44:47], v0 offset:5120
    v_smfmac_f32_16x16x64_bf16 v[60:63], v[32:35], a[32:39], v1
    buffer_load_dword v27, v6, s[4:7], s32 offen sc1
    v_smfmac_f32_16x16x64_bf16 v[56:59], v[32:35], a[24:31], v1
    v_smfmac_f32_16x16x64_bf16 v[64:67], v[32:35], a[40:47], v1
    s_waitcnt lgkmcnt(0)
    buffer_store_dwordx2 v[92:93], v15, s[4:7], s57 offen sc1
    v_smfmac_f32_16x16x64_bf16 v[68:71], v[48:51], a[192:199], v1
    ds_read_b128 v[84:87], v18 offset:0
    v_smfmac_f32_16x16x64_bf16 v[72:75], v[48:51], a[200:207], v1
    ds_read_b128 v[88:91], v18 offset:1024
    v_smfmac_f32_16x16x64_bf16 v[68:71], v[36:39], a[48:55], v1
    ds_read_b128 v[76:79], v18 offset:2048
    v_smfmac_f32_16x16x64_bf16 v[72:75], v[36:39], a[56:63], v1
    ds_read_b128 v[80:83], v18 offset:3072
    v_smfmac_f32_16x16x64_bf16 v[68:71], v[40:43], a[96:103], v1
    v_smfmac_f32_16x16x64_bf16 v[72:75], v[40:43], a[104:111], v1
    s_waitcnt lgkmcnt(2)
    buffer_load_dwordx4 v17, s[4:7], s44 offen sc1 lds
    v_smfmac_f32_16x16x64_bf16 v[68:71], v[44:47], a[144:151], v1
    buffer_load_dwordx4 v17, s[4:7], s20 offen offset:1024 sc1 lds
    v_smfmac_f32_16x16x64_bf16 v[72:75], v[44:47], a[152:159], v1
    s_nop 0
    v_smfmac_f32_16x16x64_bf16 v[52:55], v[48:51], v[96:103], v1
    s_nop 0
    v_smfmac_f32_16x16x64_bf16 v[60:63], v[48:51], v[112:119], v1
    s_nop 0
    v_smfmac_f32_16x16x64_bf16 v[56:59], v[48:51], v[104:111], v1
    v_add_f32 v68, v68, v70
    v_add_f32 v69, v69, v71
    v_smfmac_f32_16x16x64_bf16 v[64:67], v[48:51], v[120:127], v1
    v_add_f32 v70, v72, v74
    v_add_f32 v71, v73, v75
    v_smfmac_f32_16x16x64_bf16 v[52:55], v[36:39], a[64:71], v1
    v_cvt_pk_bf16_f32 v72, v68, v69
    v_cvt_pk_bf16_f32 v73, v70, v71
    v_smfmac_f32_16x16x64_bf16 v[60:63], v[36:39], a[80:87], v1
    buffer_store_dwordx2 v[72:73], v94, s[4:7], s37 offen sc1
    v_smfmac_f32_16x16x64_bf16 v[56:59], v[36:39], a[72:79], v1
    ds_read_b128 v[96:99], v18 offset:49152
    v_smfmac_f32_16x16x64_bf16 v[64:67], v[36:39], a[88:95], v1
    ds_read_b128 v[100:103], v18 offset:50176
    v_smfmac_f32_16x16x64_bf16 v[52:55], v[40:43], a[112:119], v1
    ds_read_b128 v[112:115], v19 offset:0
    v_smfmac_f32_16x16x64_bf16 v[60:63], v[40:43], a[128:135], v1
    ds_read_b128 v[116:119], v19 offset:1024
    v_smfmac_f32_16x16x64_bf16 v[56:59], v[40:43], a[120:127], v1
    ds_read_b128 v[104:107], v18 offset:51200
    v_smfmac_f32_16x16x64_bf16 v[64:67], v[40:43], a[136:143], v1
    s_waitcnt vmcnt(4)
    ds_write_b128 v5, v[28:31] offset:0
    v_smfmac_f32_16x16x64_bf16 v[52:55], v[44:47], a[160:167], v1
    ds_write_b32 v6, v27 offset:0
    v_max3_u32 v20, v28, v29, v30
    v_smfmac_f32_16x16x64_bf16 v[60:63], v[44:47], a[176:183], v1
    v_max3_u32 v20, v20, v31, v27
    v_cmp_eq_u32 vcc, -1, v20
    v_smfmac_f32_16x16x64_bf16 v[56:59], v[44:47], a[168:175], v1
    v_smfmac_f32_16x16x64_bf16 v[64:67], v[44:47], a[184:191], v1
    s_waitcnt lgkmcnt(0)
    s_cbranch_vccnz L_rre_102
L_rok_101:
    s_barrier
    ds_read_b128 v[48:51], v4 offset:4096
    ds_read_b128 v[36:39], v7 offset:0
    v_smfmac_f32_16x16x64_bf16 v[52:55], v[28:31], a[208:215], v1
    ds_read_b128 v[40:43], v8 offset:0
    ds_read_b128 v[44:47], v0 offset:0
    v_smfmac_f32_16x16x64_bf16 v[60:63], v[28:31], a[224:231], v1
    v_smfmac_f32_16x16x64_bf16 v[56:59], v[28:31], a[216:223], v1
    buffer_load_dwordx4 v16, s[4:7], s43 offen offset:2048 sc1 lds
    v_smfmac_f32_16x16x64_bf16 v[64:67], v[28:31], a[232:239], v1
    s_waitcnt lgkmcnt(0)
    v_smfmac_f32_16x16x64_bf16 v[52:55], v[48:51], v[96:103], v1
    v_smfmac_f32_16x16x64_bf16 v[60:63], v[48:51], v[112:119], v1
    buffer_store_dwordx2 v[72:73], v94, s[4:7], s16 offen sc1
    v_smfmac_f32_16x16x64_bf16 v[52:55], v[36:39], a[240:247], v1
    ds_read_b128 v[108:111], v18 offset:52224
    v_smfmac_f32_16x16x64_bf16 v[60:63], v[36:39], v[128:135], v1
    ds_read_b128 v[120:123], v19 offset:2048
    v_smfmac_f32_16x16x64_bf16 v[52:55], v[40:43], v[144:151], v1
    ds_read_b128 v[124:127], v19 offset:3072
    v_smfmac_f32_16x16x64_bf16 v[60:63], v[40:43], v[160:167], v1
    v_mov_b64 v[68:69], -1
    v_smfmac_f32_16x16x64_bf16 v[52:55], v[44:47], v[176:183], v1
    ds_read_b128 v[96:99], v19 offset:16384
    v_smfmac_f32_16x16x64_bf16 v[60:63], v[44:47], v[192:199], v1
    ds_read_b128 v[100:103], v19 offset:17408
    s_waitcnt lgkmcnt(4)
    v_smfmac_f32_16x16x64_bf16 v[56:59], v[48:51], v[104:111], v1
    ds_read_b128 v[112:115], v19 offset:32768
    s_waitcnt lgkmcnt(3)
    v_smfmac_f32_16x16x64_bf16 v[64:67], v[48:51], v[120:127], v1
    ds_read_b128 v[116:119], v19 offset:33792
    v_smfmac_f32_16x16x64_bf16 v[56:59], v[36:39], a[248:255], v1
    v_add_f32 v52, v52, v54
    v_smfmac_f32_16x16x64_bf16 v[64:67], v[36:39], v[136:143], v1
    v_add_f32 v53, v53, v55
    v_smfmac_f32_16x16x64_bf16 v[56:59], v[40:43], v[152:159], v1
    v_add_f32 v60, v60, v62
    v_smfmac_f32_16x16x64_bf16 v[64:67], v[40:43], v[168:175], v1
    v_add_f32 v61, v61, v63
    v_smfmac_f32_16x16x64_bf16 v[56:59], v[44:47], v[184:191], v1
    v_cvt_pk_bf16_f32 v22, v52, v53
    v_smfmac_f32_16x16x64_bf16 v[64:67], v[44:47], v[200:207], v1
    v_cvt_pk_bf16_f32 v23, v60, v61
    v_bfe_i32 v21, v1, 1, 1
    v_not_b32 v20, v21
    v_mfma_f32_16x16x16_bf16 v[28:31], v[22:23], v[2:3], 0
    buffer_load_dwordx2 v[92:93], v94, s[4:7], s38 offen sc1
    s_nop 0
    v_add_f32 v56, v56, v58
    v_add_f32 v57, v57, v59
    v_cvt_pk_bf16_f32 v24, v56, v57
    v_add_f32 v64, v64, v66
    v_add_f32 v65, v65, v67
    v_cvt_pk_bf16_f32 v25, v64, v65
    ds_read_b128 v[108:111], v19 offset:19456
    v_cvt_pk_bf16_f32 v32, v28, v29
    v_mfma_f32_16x16x16_bf16 v[36:39], v[24:25], v[2:3], 0
    v_cvt_pk_bf16_f32 v33, v30, v31
    v_and_b32 v44, v32, v20
    v_and_b32 v45, v33, v20
    v_and_b32_dpp v48, v32, v21 quad_perm:[0,1,0,1] row_mask:0xf bank_mask:0xf
    v_and_b32_dpp v49, v33, v21 quad_perm:[0,1,0,1] row_mask:0xf bank_mask:0xf
    ds_read_b128 v[120:123], v19 offset:34816
    ds_read_b128 v[124:127], v19 offset:35840
    s_cmp_eq_u32 s28, 63
    v_cvt_pk_bf16_f32 v34, v36, v37
    v_cvt_pk_bf16_f32 v35, v38, v39
    v_and_b32 v46, v34, v20
    v_and_b32 v47, v35, v20
    v_mfma_f32_16x16x32_bf16 v[60:63], v[32:35], v[32:35], 0
    v_and_b32_dpp v50, v34, v21 quad_perm:[0,1,0,1] row_mask:0xf bank_mask:0xf
    v_and_b32_dpp v51, v35, v21 quad_perm:[0,1,0,1] row_mask:0xf bank_mask:0xf
    v_mfma_f32_16x16x32_bf16 v[52:55], v[76:79], v[44:47], 0
    ds_read_b128 v[104:107], v19 offset:18432
    v_mfma_f32_16x16x32_bf16 v[52:55], v[80:83], v[48:51], v[52:55]
    s_cbranch_scc1 L_rdone_97
    v_mov_b32 v74, v73
    s_mov_b64 exec, s[58:59]
    ds_write2_b32 v11, v62, v63 offset0:0 offset1:32
    s_mov_b64 exec, -1
    v_mov_b32 v22, 0x3f803f80
    v_mov_b32 v23, 0x3f803f80
    v_mfma_f32_16x16x4_f32 v[28:31], v95, v95, 0
    ds_write_b128 v10, v[52:55] offset:10240
    v_mfma_f32_16x16x4_f32 v[28:31], v95, v95, 0
    s_mov_b64 exec, s[14:15]
    buffer_store_dwordx4 v[32:35], v4, s[4:7], s45 offen sc1
    s_mov_b64 exec, -1
    buffer_load_dwordx4 v16, s[4:7], s21 offen offset:3072 sc1 lds
    v_mfma_f32_16x16x4_f32 v[28:31], v95, v95, 0
    s_waitcnt lgkmcnt(0)
    s_barrier
    ds_read_b128 v[52:55], v9 offset:10240
    v_mfma_f32_16x16x4_f32 v[28:31], v95, v95, 0
    ds_read_b128 v[56:59], v9 offset:11264
    ds_read_b128 v[60:63], v9 offset:12288
    ds_read_b128 v[64:67], v9 offset:13312
    ds_read_b128 v[36:39], v9 offset:14336
    buffer_store_dwordx2 v[68:69], v94, s[4:7], s39 offen sc1
    v_mov_b32 v24, 0x3f803f80
    v_mov_b32 v25, 0x3f803f80
    v_mov_b32 v42, 1107296256
    s_waitcnt lgkmcnt(3)
    v_pk_add_f32 v[52:53], v[52:53], v[56:57]
    v_pk_add_f32 v[54:55], v[54:55], v[58:59]
    s_waitcnt lgkmcnt(2)
    v_pk_add_f32 v[52:53], v[52:53], v[60:61]
    v_pk_add_f32 v[54:55], v[54:55], v[62:63]
    s_waitcnt lgkmcnt(0)
    v_pk_add_f32 v[52:53], v[52:53], v[64:65]
    v_pk_add_f32 v[36:37], v[36:37], v[38:39]
    v_pk_add_f32 v[54:55], v[54:55], v[66:67]
    v_add_f32 v36, v36, v37
    v_pk_mul_f32 v[48:49], v[52:53], s[12:13]
    v_pk_mul_f32 v[50:51], v[54:55], s[12:13]
    v_mul_f32 v38, s46, v36
    v_max3_f32 v20, |v48|, |v49|, |v50|
    v_max3_f32 v20, v20, |v51|, |v38|
    v_cmp_nlt_f32 vcc, v20, v42
L_sok_103:
    v_exp_f32 v48, v48
    v_exp_f32 v49, v49
    v_exp_f32 v50, v50
    v_exp_f32 v51, v51
    v_cvt_pk_bf16_f32 v44, v48, v49
    v_cvt_pk_bf16_f32 v45, v50, v51
    v_exp_f32 v38, v38
    v_mov_b32_dpp v46, v44 quad_perm:[2,3,2,3] row_mask:0xf bank_mask:0xf
    v_mov_b32_dpp v47, v45 quad_perm:[2,3,2,3] row_mask:0xf bank_mask:0xf
    v_mov_b32_dpp v39, v38 quad_perm:[2,3,2,3] row_mask:0xf bank_mask:0xf
    v_cvt_pk_bf16_f32 v40, v38, v39
    s_cbranch_vccnz L_smx_104
    s_waitcnt vmcnt(3)
L_vok_105:
    v_mfma_f32_16x16x32_bf16 v[76:79], v[84:87], v[44:47], 0
    v_mov_b32 v73, v92
    v_mov_b32 v41, v40
    v_mfma_f32_16x16x32_bf16 v[80:83], v[88:91], v[44:47], 0
    v_mov_b32 v75, v93
    v_max_u32 v20, v92, v93
    v_cmp_eq_u32 vcc, -1, v20
    v_mfma_f32_16x16x16_bf16 v[76:79], v[72:73], v[40:41], v[76:79]
    v_mov_b64 v[52:53], 0
    v_mov_b64 v[54:55], 0
    v_mfma_f32_16x16x16_bf16 v[80:83], v[74:75], v[40:41], v[80:83]
    v_mov_b64 v[68:69], 0
    v_mov_b64 v[70:71], 0
    v_mfma_f32_16x16x16_bf16 v[48:51], v[40:41], v[22:23], 0
    s_cbranch_vccnz L_vre_106
    v_mov_b64 v[32:33], -1
    v_cvt_pk_bf16_f32 v28, v76, v77
    v_cvt_pk_bf16_f32 v29, v78, v79
    v_mov_b64 v[34:35], -1
    v_cvt_pk_bf16_f32 v30, v80, v81
    v_cvt_pk_bf16_f32 v31, v82, v83
    v_mfma_f32_16x16x32_bf16 v[36:39], v[44:47], v[22:25], 0
    s_mov_b64 exec, s[58:59]
    ds_write_b128 v12, v[28:31] offset:15360
    s_mov_b64 exec, -1
    buffer_store_dwordx4 v[32:35], v5, s[4:7], s42 offen
    v_mfma_f32_16x16x4_f32 v[88:91], v95, v95, 0
    s_waitcnt lgkmcnt(0)
    s_barrier
    ds_read_b128 v[76:79], v9 offset:15360
    v_mfma_f32_16x16x16_bf16 v[40:43], v[2:3], v[2:3], 0
    ds_read_b128 v[80:83], v9 offset:16384
    buffer_store_dword v32, v6, s[4:7], s42 offen
    v_fma_f32 v48, v48, 0.5, v36
    v_fma_f32 v49, v49, 0.5, v37
    v_mov_b64 v[56:57], 0
    v_rcp_f32 v20, v48
    v_mov_b64 v[58:59], 0
    v_mov_b64 v[60:61], 0
    v_rcp_f32 v21, v49
    s_waitcnt lgkmcnt(1)
    v_smfmac_f32_16x16x64_bf16 v[68:71], v[76:79], v[112:119], v1
    s_waitcnt lgkmcnt(0)
    v_smfmac_f32_16x16x64_bf16 v[68:71], v[80:83], v[120:127], v1
    ds_read_b128 v[84:87], v4 offset:17408
    v_smfmac_f32_16x16x64_bf16 v[52:55], v[76:79], v[208:215], v1
    v_mov_b64 v[62:63], 0
    v_smfmac_f32_16x16x64_bf16 v[52:55], v[80:83], v[216:223], v1
    v_mov_b64 v[64:65], 0
    v_smfmac_f32_16x16x64_bf16 v[56:59], v[76:79], v[224:231], v1
    v_mov_b64 v[66:67], 0
    v_smfmac_f32_16x16x64_bf16 v[56:59], v[80:83], v[232:239], v1
    v_add_f32 v68, v68, v70
    v_smfmac_f32_16x16x64_bf16 v[60:63], v[76:79], v[240:247], v1
    v_add_f32 v69, v69, v71
    v_smfmac_f32_16x16x64_bf16 v[60:63], v[80:83], v[248:255], v1
    v_mul_f32 v68, v68, v20
    v_smfmac_f32_16x16x64_bf16 v[64:67], v[76:79], v[96:103], v1
    v_mul_f32 v69, v69, v21
    v_smfmac_f32_16x16x64_bf16 v[64:67], v[80:83], v[104:111], v1
    v_cvt_pk_bf16_f32 v26, v68, v69
    v_add_f32 v52, v52, v54
    v_add_f32 v53, v53, v55
    buffer_store_dword v26, v14, s[4:7], s40 offen
    v_pk_add_f32 v[56:57], v[56:57], v[58:59]
    v_pk_add_f32 v[60:61], v[60:61], v[62:63]
    v_pk_mul_f32 v[52:53], v[52:53], v[20:21]
    v_pk_mul_f32 v[56:57], v[56:57], v[20:21]
    v_pk_add_f32 v[64:65], v[64:65], v[66:67]
    v_pk_mul_f32 v[60:61], v[60:61], v[20:21]
    v_pk_mul_f32 v[64:65], v[64:65], v[20:21]
    v_cvt_pk_bf16_f32 v22, v52, v53
    v_cvt_pk_bf16_f32 v23, v56, v57
    v_cvt_pk_bf16_f32 v24, v60, v61
    v_cvt_pk_bf16_f32 v25, v64, v65
    buffer_store_dwordx4 v[22:25], v13, s[4:7], s40 offen
    s_add_u32 s45, s45, 131072
    s_add_u32 s16, s16, 131072
    s_add_u32 s28, s28, 1
    s_lshl_b32 s55, s29, 12
    s_add_u32 s41, s40, s55
    ds_read_b128 v[96:99], v18 offset:16384
    ds_read_b128 v[100:103], v18 offset:17408
    ds_read_b128 v[104:107], v18 offset:18432
    ds_read_b128 v[108:111], v18 offset:19456
    ds_read_b128 v[112:115], v18 offset:32768
    ds_read_b128 v[116:119], v18 offset:33792
    ds_read_b128 v[120:123], v18 offset:34816
    ds_read_b128 v[124:127], v18 offset:35840
    s_and_b32 s53, s28, 3
    s_xor_b32 s54, s53, 2
    s_mul_i32 s54, s54, 163840
    s_add_u32 s42, s17, s54
    s_mul_i32 s54, s53, 163840
    s_add_u32 s40, s52, s54
    s_lshl_b32 s53, s53, 16
    s_add_u32 s32, s47, s53
    s_add_u32 s33, s48, s53
    s_add_u32 s34, s49, s53
    s_xor_b32 s54, s53, 131072
    s_add_u32 s36, s49, s54
    s_add_u32 s54, s48, s54
    s_cmp_lt_i32 s29, 0
    s_cselect_b32 s57, s2, s54
    s_cselect_b32 s35, s28, -1
    s_add_u32 s18, s28, 2
    s_min_u32 s18, s18, 64
    s_add_u32 s53, s28, s25
    s_and_b32 s53, s53, 3
    s_lshl_b32 s53, s53, 11
    s_add_u32 s37, s50, s53
    s_xor_b32 s38, s37, 524288
    s_xor_b32 s39, s37, 4096
    s_add_u32 s44, s44, 262144
    s_add_u32 s20, s20, 262144
    s_add_u32 s43, s43, 262144
    s_add_u32 s21, s21, 262144
    s_min_u32 s8, s8, s9
    s_max_u32 s22, s22, s8
    s_cmp_lt_u32 s22, s18
    s_cbranch_scc1 L_kre_108
L_kok_107:
    s_waitcnt lgkmcnt(0)
    s_add_u32 s53, s28, 5
    s_min_u32 s53, s53, 64
    s_cmp_ge_u32 s22, s53
    s_cbranch_scc1 L_nosl_109
    s_load_dword s8, s[10:11], 0 glc
    s_load_dword s9, s[10:11], 8192 glc
L_nosl_109:
    s_cmp_lt_i32 s29, 0
    s_cbranch_scc1 L_nored_110
    buffer_load_dwordx4 v[32:35], v4, s[4:7], s41 offen offset:0 sc1
    buffer_load_dwordx4 v[36:39], v4, s[4:7], s41 offen offset:1024 sc1
    buffer_load_dwordx4 v[40:43], v4, s[4:7], s41 offen offset:2048 sc1
    buffer_load_dwordx4 v[44:47], v4, s[4:7], s41 offen offset:3072 sc1
    s_nop 15
    s_nop 13
    buffer_load_dwordx4 v[52:55], v4, s[4:7], s41 offen offset:0 sc1
    buffer_load_dwordx4 v[56:59], v4, s[4:7], s41 offen offset:1024 sc1
    buffer_load_dwordx4 v[60:63], v4, s[4:7], s41 offen offset:2048 sc1
    buffer_load_dwordx4 v[64:67], v4, s[4:7], s41 offen offset:3072 sc1
    s_waitcnt vmcnt(7)
    v_mfma_f32_16x16x32_bf16 v[48:51], v[84:87], v[32:35], 0
    v_max3_u32 v20, v32, v33, v34
    s_waitcnt vmcnt(6)
    v_mfma_f32_16x16x32_bf16 v[48:51], v[84:87], v[36:39], v[48:51]
    v_max3_u32 v20, v20, v35, v36
    v_max3_u32 v20, v20, v37, v38
    s_waitcnt vmcnt(5)
    v_mfma_f32_16x16x32_bf16 v[48:51], v[84:87], v[40:43], v[48:51]
    v_max3_u32 v20, v20, v39, v40
    v_max3_u32 v20, v20, v41, v42
    s_waitcnt vmcnt(4)
    v_mfma_f32_16x16x32_bf16 v[48:51], v[84:87], v[44:47], v[48:51]
    v_max3_u32 v20, v20, v43, v44
    v_max3_u32 v20, v20, v45, v46
    v_max_u32 v20, v20, v47
    v_cmp_eq_u32 vcc, -1, v20
    s_nop 3
    v_add_f32_dpp v28, v48, v48 row_ror:8 row_mask:0xf bank_mask:0xf
    v_add_f32_dpp v29, v49, v49 row_ror:8 row_mask:0xf bank_mask:0xf
    v_add_f32_dpp v30, v50, v50 row_ror:8 row_mask:0xf bank_mask:0xf
    v_add_f32_dpp v31, v51, v51 row_ror:8 row_mask:0xf bank_mask:0xf
    v_cvt_pk_bf16_f32 v28, v28, v29
    v_cvt_pk_bf16_f32 v29, v30, v31
    s_cbranch_vccnz L_redr_112
L_red_111:
    buffer_store_dwordx2 v[28:29], v15, s[4:7], s33 offen sc1
    buffer_store_dwordx2 v[28:29], v15, s[4:7], s34 offen
    v_mov_b64 v[30:31], -1
    s_barrier
    buffer_store_dwordx2 v[30:31], v15, s[4:7], s36 offen
    s_waitcnt vmcnt(3)
L_join_113:
    s_branch L_step_98
L_lre_100:
    s_sub_u32 s31, s31, 1
    s_cbranch_scc1 L_exit
    buffer_load_dwordx4 v[22:25], v5, s[4:7], s34 offen sc1
    buffer_load_dword v26, v6, s[4:7], s34 offen sc1
    s_nop 0
    v_mov_b64 v[68:69], 0
    v_mov_b64 v[70:71], 0
    v_mov_b64 v[72:73], 0
    v_mov_b64 v[74:75], 0
    s_waitcnt vmcnt(2)
    ds_write_b128 v5, v[28:31] offset:5120
    ds_write_b32 v6, v27 offset:5120
    v_max3_u32 v20, v28, v29, v30
    v_max3_u32 v20, v20, v31, v27
    v_cmp_eq_u32 vcc, -1, v20
    v_mov_b64 v[32:33], v[28:29]
    v_mov_b64 v[34:35], v[30:31]
    s_nop 0
    s_cbranch_vccz L_lok_99
    buffer_load_dwordx4 v[28:31], v5, s[4:7], s34 offen sc1
    buffer_load_dword v27, v6, s[4:7], s34 offen sc1
    s_waitcnt vmcnt(2)
    ds_write_b128 v5, v[22:25] offset:5120
    ds_write_b32 v6, v26 offset:5120
    v_max3_u32 v20, v22, v23, v24
    v_max3_u32 v20, v20, v25, v26
    v_cmp_eq_u32 vcc, -1, v20
    v_mov_b64 v[32:33], v[22:23]
    v_mov_b64 v[34:35], v[24:25]
    s_nop 0
    s_cbranch_vccz L_lok_99
    s_branch L_lre_100
L_rre_102:
    s_sub_u32 s31, s31, 1
    s_cbranch_scc1 L_exit
    buffer_load_dwordx4 v[28:31], v5, s[4:7], s32 offen sc1
    buffer_load_dword v27, v6, s[4:7], s32 offen sc1
    s_waitcnt vmcnt(0)
    ds_write_b128 v5, v[28:31] offset:0
    ds_write_b32 v6, v27 offset:0
    v_max3_u32 v20, v28, v29, v30
    v_max3_u32 v20, v20, v31, v27
    v_cmp_eq_u32 vcc, -1, v20
    s_waitcnt lgkmcnt(0)
    s_cbranch_vccz L_rok_101
    s_branch L_rre_102
L_smx_104:
    v_max3_f32 v20, v52, v53, v54
    v_max3_f32 v20, v20, v55, v36
    s_nop 1
    v_max_f32_dpp v21, v20, v20 quad_perm:[2,3,0,1] row_mask:0xf bank_mask:0xf
    v_max_f32_dpp v20, v20, v20 quad_perm:[2,3,0,1] row_mask:0xf bank_mask:0xf
    s_nop 1
    v_permlane16_swap_b32 v20, v21
    v_max_f32 v37, v20, v21
    v_max_f32 v20, v20, v21
    s_nop 1
    v_permlane32_swap_b32 v20, v37
    v_max_f32 v20, v20, v37
    v_mul_f32 v20, s46, v20
    v_fma_f32 v48, v52, s46, -v20
    v_fma_f32 v49, v53, s46, -v20
    v_fma_f32 v50, v54, s46, -v20
    v_fma_f32 v51, v55, s46, -v20
    v_fma_f32 v38, v36, s46, -v20
    s_mov_b64 vcc, 0
    s_branch L_sok_103
L_vre_106:
    s_sub_u32 s31, s31, 1
    s_cbranch_scc1 L_exit
    buffer_load_dwordx2 v[92:93], v94, s[4:7], s38 offen sc1
    s_waitcnt vmcnt(0)
    s_branch L_vok_105
L_kre_108:
    v_lshlrev_b32 v20, 9, v4
    s_mov_b64 exec, 3
L_wf_114:
    buffer_load_dword v21, v20, s[4:7], s23 offen sc1
    s_waitcnt vmcnt(0)
    v_cmp_gt_u32 vcc, s18, v21
    s_cbranch_vccz L_wfd_115
    s_sleep 1
    s_sub_u32 s31, s31, 1
    s_cbranch_scc1 L_exit
    s_branch L_wf_114
L_wfd_115:
    s_mov_b64 exec, -1
    v_readlane_b32 s22, v21, 0
    v_readlane_b32 s56, v21, 1
    s_nop 0
    s_min_u32 s22, s22, s56
    s_branch L_kok_107
L_redr_112:
    s_sub_u32 s31, s31, 1
    s_cbranch_scc1 L_exit
    buffer_load_dwordx4 v[32:35], v4, s[4:7], s41 offen offset:0 sc1
    buffer_load_dwordx4 v[36:39], v4, s[4:7], s41 offen offset:1024 sc1
    buffer_load_dwordx4 v[40:43], v4, s[4:7], s41 offen offset:2048 sc1
    buffer_load_dwordx4 v[44:47], v4, s[4:7], s41 offen offset:3072 sc1
    s_waitcnt vmcnt(7)
    v_mfma_f32_16x16x32_bf16 v[48:51], v[84:87], v[52:55], 0
    v_max3_u32 v20, v52, v53, v54
    s_waitcnt vmcnt(6)
    v_mfma_f32_16x16x32_bf16 v[48:51], v[84:87], v[56:59], v[48:51]
    v_max3_u32 v20, v20, v55, v56
    v_max3_u32 v20, v20, v57, v58
    s_waitcnt vmcnt(5)
    v_mfma_f32_16x16x32_bf16 v[48:51], v[84:87], v[60:63], v[48:51]
    v_max3_u32 v20, v20, v59, v60
    v_max3_u32 v20, v20, v61, v62
    s_waitcnt vmcnt(4)
    v_mfma_f32_16x16x32_bf16 v[48:51], v[84:87], v[64:67], v[48:51]
    v_max3_u32 v20, v20, v63, v64
    v_max3_u32 v20, v20, v65, v66
    v_max_u32 v20, v20, v67
    v_cmp_eq_u32 vcc, -1, v20
    s_nop 3
    v_add_f32_dpp v28, v48, v48 row_ror:8 row_mask:0xf bank_mask:0xf
    v_add_f32_dpp v29, v49, v49 row_ror:8 row_mask:0xf bank_mask:0xf
    v_add_f32_dpp v30, v50, v50 row_ror:8 row_mask:0xf bank_mask:0xf
    v_add_f32_dpp v31, v51, v51 row_ror:8 row_mask:0xf bank_mask:0xf
    v_cvt_pk_bf16_f32 v28, v28, v29
    v_cvt_pk_bf16_f32 v29, v30, v31
    s_cbranch_vccz L_red_111
    buffer_load_dwordx4 v[52:55], v4, s[4:7], s41 offen offset:0 sc1
    buffer_load_dwordx4 v[56:59], v4, s[4:7], s41 offen offset:1024 sc1
    buffer_load_dwordx4 v[60:63], v4, s[4:7], s41 offen offset:2048 sc1
    buffer_load_dwordx4 v[64:67], v4, s[4:7], s41 offen offset:3072 sc1
    s_waitcnt vmcnt(7)
    v_mfma_f32_16x16x32_bf16 v[48:51], v[84:87], v[32:35], 0
    v_max3_u32 v20, v32, v33, v34
    s_waitcnt vmcnt(6)
    v_mfma_f32_16x16x32_bf16 v[48:51], v[84:87], v[36:39], v[48:51]
    v_max3_u32 v20, v20, v35, v36
    v_max3_u32 v20, v20, v37, v38
    s_waitcnt vmcnt(5)
    v_mfma_f32_16x16x32_bf16 v[48:51], v[84:87], v[40:43], v[48:51]
    v_max3_u32 v20, v20, v39, v40
    v_max3_u32 v20, v20, v41, v42
    s_waitcnt vmcnt(4)
    v_mfma_f32_16x16x32_bf16 v[48:51], v[84:87], v[44:47], v[48:51]
    v_max3_u32 v20, v20, v43, v44
    v_max3_u32 v20, v20, v45, v46
    v_max_u32 v20, v20, v47
    v_cmp_eq_u32 vcc, -1, v20
    s_nop 3
    v_add_f32_dpp v28, v48, v48 row_ror:8 row_mask:0xf bank_mask:0xf
    v_add_f32_dpp v29, v49, v49 row_ror:8 row_mask:0xf bank_mask:0xf
    v_add_f32_dpp v30, v50, v50 row_ror:8 row_mask:0xf bank_mask:0xf
    v_add_f32_dpp v31, v51, v51 row_ror:8 row_mask:0xf bank_mask:0xf
    v_cvt_pk_bf16_f32 v28, v28, v29
    v_cvt_pk_bf16_f32 v29, v30, v31
    s_cbranch_vccz L_red_111
    s_branch L_redr_112
L_nored_110:
    s_barrier
    s_branch L_join_113
L_rdone_97:
    s_mov_b64 exec, s[14:15]
    buffer_store_dwordx4 v[32:35], v4, s[4:7], s45 offen sc1
    s_mov_b64 exec, -1
    s_waitcnt vmcnt(0)
    s_barrier
    s_mov_b64 exec, 1
    v_mov_b32 v20, 64
    buffer_store_dword v20, off, s[4:7], s2 sc1
    s_mov_b64 exec, -1
    s_branch L_exit
L_in_93:
L_step_117:
    v_mov_b64 v[52:53], 0
    s_nop 4
    v_mov_b64 v[54:55], 0
    s_nop 4
    v_mov_b64 v[56:57], 0
    s_nop 4
    v_mov_b64 v[58:59], 0
    s_nop 4
    v_mov_b64 v[60:61], 0
    s_nop 4
    v_mov_b64 v[62:63], 0
    s_nop 4
    buffer_load_dwordx4 v[32:35], v5, s[4:7], s34 offen sc1
    buffer_load_dword v26, v6, s[4:7], s34 offen sc1
    v_mov_b64 v[64:65], 0
    s_nop 3
    v_mov_b64 v[66:67], 0
    s_nop 3
    v_mov_b64 v[68:69], 0
    s_nop 3
    v_mov_b64 v[70:71], 0
    s_nop 3
    v_mov_b64 v[72:73], 0
    s_nop 3
    v_mov_b64 v[74:75], 0
    s_nop 3
    v_mov_b32 v92, s35
    s_nop 3
    v_mov_b32 v93, s35
    s_nop 3
    buffer_load_dwordx4 v[28:31], v5, s[4:7], s34 offen sc1
    buffer_load_dword v27, v6, s[4:7], s34 offen sc1
    s_waitcnt vmcnt(2)
    ds_write_b128 v5, v[32:35] offset:5120
    ds_write_b32 v6, v26 offset:5120
    v_max3_u32 v20, v32, v33, v34
    v_max3_u32 v20, v20, v35, v26
    v_cmp_eq_u32 vcc, -1, v20
L_lok_118:
    v_smfmac_f32_16x16x64_bf16 v[68:71], v[32:35], a[0:7], v1
    v_smfmac_f32_16x16x64_bf16 v[72:75], v[32:35], a[8:15], v1
    s_waitcnt lgkmcnt(0)
    s_cbranch_vccnz L_lre_119
    s_barrier
    ds_read_b128 v[48:51], v4 offset:9216
    ds_read_b128 v[36:39], v7 offset:5120
    buffer_load_dwordx4 v[28:31], v5, s[4:7], s32 offen sc1
    v_smfmac_f32_16x16x64_bf16 v[52:55], v[32:35], a[16:23], v1
    ds_read_b128 v[40:43], v8 offset:5120
    ds_read_b128 v[44:47], v0 offset:5120
    v_smfmac_f32_16x16x64_bf16 v[60:63], v[32:35], a[32:39], v1
    buffer_load_dword v27, v6, s[4:7], s32 offen sc1
    v_smfmac_f32_16x16x64_bf16 v[56:59], v[32:35], a[24:31], v1
    v_smfmac_f32_16x16x64_bf16 v[64:67], v[32:35], a[40:47], v1
    s_waitcnt lgkmcnt(0)
    buffer_store_dwordx2 v[92:93], v15, s[4:7], s57 offen sc1
    v_smfmac_f32_16x16x64_bf16 v[68:71], v[48:51], a[192:199], v1
    ds_read_b128 v[84:87], v18 offset:0
    v_smfmac_f32_16x16x64_bf16 v[72:75], v[48:51], a[200:207], v1
    ds_read_b128 v[88:91], v18 offset:1024
    v_smfmac_f32_16x16x64_bf16 v[68:71], v[36:39], a[48:55], v1
    ds_read_b128 v[76:79], v18 offset:2048
    v_smfmac_f32_16x16x64_bf16 v[72:75], v[36:39], a[56:63], v1
    ds_read_b128 v[80:83], v18 offset:3072
    v_smfmac_f32_16x16x64_bf16 v[68:71], v[40:43], a[96:103], v1
    v_smfmac_f32_16x16x64_bf16 v[72:75], v[40:43], a[104:111], v1
    s_waitcnt lgkmcnt(2)
    buffer_load_dwordx4 v17, s[4:7], s44 offen sc1 lds
    v_smfmac_f32_16x16x64_bf16 v[68:71], v[44:47], a[144:151], v1
    buffer_load_dwordx4 v17, s[4:7], s20 offen offset:1024 sc1 lds
    v_smfmac_f32_16x16x64_bf16 v[72:75], v[44:47], a[152:159], v1
    s_nop 0
    v_smfmac_f32_16x16x64_bf16 v[52:55], v[48:51], v[96:103], v1
    s_nop 0
    v_smfmac_f32_16x16x64_bf16 v[60:63], v[48:51], v[112:119], v1
    s_nop 0
    v_smfmac_f32_16x16x64_bf16 v[56:59], v[48:51], v[104:111], v1
    v_add_f32 v68, v68, v70
    v_add_f32 v69, v69, v71
    v_smfmac_f32_16x16x64_bf16 v[64:67], v[48:51], v[120:127], v1
    v_add_f32 v70, v72, v74
    v_add_f32 v71, v73, v75
    v_smfmac_f32_16x16x64_bf16 v[52:55], v[36:39], a[64:71], v1
    v_cvt_pk_bf16_f32 v72, v68, v69
    v_cvt_pk_bf16_f32 v73, v70, v71
    v_smfmac_f32_16x16x64_bf16 v[60:63], v[36:39], a[80:87], v1
    buffer_store_dwordx2 v[72:73], v94, s[4:7], s37 offen sc1
    v_smfmac_f32_16x16x64_bf16 v[56:59], v[36:39], a[72:79], v1
    ds_read_b128 v[96:99], v18 offset:49152
    v_smfmac_f32_16x16x64_bf16 v[64:67], v[36:39], a[88:95], v1
    ds_read_b128 v[100:103], v18 offset:50176
    v_smfmac_f32_16x16x64_bf16 v[52:55], v[40:43], a[112:119], v1
    ds_read_b128 v[112:115], v19 offset:0
    v_smfmac_f32_16x16x64_bf16 v[60:63], v[40:43], a[128:135], v1
    ds_read_b128 v[116:119], v19 offset:1024
    v_smfmac_f32_16x16x64_bf16 v[56:59], v[40:43], a[120:127], v1
    ds_read_b128 v[104:107], v18 offset:51200
    v_smfmac_f32_16x16x64_bf16 v[64:67], v[40:43], a[136:143], v1
    s_waitcnt vmcnt(4)
    ds_write_b128 v5, v[28:31] offset:0
    v_smfmac_f32_16x16x64_bf16 v[52:55], v[44:47], a[160:167], v1
    ds_write_b32 v6, v27 offset:0
    v_max3_u32 v20, v28, v29, v30
    v_smfmac_f32_16x16x64_bf16 v[60:63], v[44:47], a[176:183], v1
    v_max3_u32 v20, v20, v31, v27
    v_cmp_eq_u32 vcc, -1, v20
    v_smfmac_f32_16x16x64_bf16 v[56:59], v[44:47], a[168:175], v1
    v_smfmac_f32_16x16x64_bf16 v[64:67], v[44:47], a[184:191], v1
    s_waitcnt lgkmcnt(0)
    s_cbranch_vccnz L_rre_121
L_rok_120:
    s_barrier
    ds_read_b128 v[48:51], v4 offset:4096
    ds_read_b128 v[36:39], v7 offset:0
    v_smfmac_f32_16x16x64_bf16 v[52:55], v[28:31], a[208:215], v1
    ds_read_b128 v[40:43], v8 offset:0
    ds_read_b128 v[44:47], v0 offset:0
    v_smfmac_f32_16x16x64_bf16 v[60:63], v[28:31], a[224:231], v1
    v_smfmac_f32_16x16x64_bf16 v[56:59], v[28:31], a[216:223], v1
    buffer_load_dwordx4 v16, s[4:7], s43 offen offset:2048 sc1 lds
    v_smfmac_f32_16x16x64_bf16 v[64:67], v[28:31], a[232:239], v1
    s_waitcnt lgkmcnt(0)
    v_smfmac_f32_16x16x64_bf16 v[52:55], v[48:51], v[96:103], v1
    v_smfmac_f32_16x16x64_bf16 v[60:63], v[48:51], v[112:119], v1
    buffer_store_dwordx2 v[72:73], v94, s[4:7], s16 offen sc1
    v_smfmac_f32_16x16x64_bf16 v[52:55], v[36:39], a[240:247], v1
    ds_read_b128 v[108:111], v18 offset:52224
    v_smfmac_f32_16x16x64_bf16 v[60:63], v[36:39], v[128:135], v1
    ds_read_b128 v[120:123], v19 offset:2048
    v_smfmac_f32_16x16x64_bf16 v[52:55], v[40:43], v[144:151], v1
    ds_read_b128 v[124:127], v19 offset:3072
    v_smfmac_f32_16x16x64_bf16 v[60:63], v[40:43], v[160:167], v1
    v_mov_b64 v[68:69], -1
    v_smfmac_f32_16x16x64_bf16 v[52:55], v[44:47], v[176:183], v1
    ds_read_b128 v[96:99], v19 offset:16384
    v_smfmac_f32_16x16x64_bf16 v[60:63], v[44:47], v[192:199], v1
    ds_read_b128 v[100:103], v19 offset:17408
    s_waitcnt lgkmcnt(4)
    v_smfmac_f32_16x16x64_bf16 v[56:59], v[48:51], v[104:111], v1
    ds_read_b128 v[112:115], v19 offset:32768
    s_waitcnt lgkmcnt(3)
    v_smfmac_f32_16x16x64_bf16 v[64:67], v[48:51], v[120:127], v1
    ds_read_b128 v[116:119], v19 offset:33792
    v_smfmac_f32_16x16x64_bf16 v[56:59], v[36:39], a[248:255], v1
    v_add_f32 v52, v52, v54
    v_smfmac_f32_16x16x64_bf16 v[64:67], v[36:39], v[136:143], v1
    v_add_f32 v53, v53, v55
    v_smfmac_f32_16x16x64_bf16 v[56:59], v[40:43], v[152:159], v1
    v_add_f32 v60, v60, v62
    v_smfmac_f32_16x16x64_bf16 v[64:67], v[40:43], v[168:175], v1
    v_add_f32 v61, v61, v63
    v_smfmac_f32_16x16x64_bf16 v[56:59], v[44:47], v[184:191], v1
    v_cvt_pk_bf16_f32 v22, v52, v53
    v_smfmac_f32_16x16x64_bf16 v[64:67], v[44:47], v[200:207], v1
    v_cvt_pk_bf16_f32 v23, v60, v61
    v_bfe_i32 v21, v1, 1, 1
    v_not_b32 v20, v21
    v_mfma_f32_16x16x16_bf16 v[28:31], v[22:23], v[2:3], 0
    buffer_load_dwordx2 v[92:93], v94, s[4:7], s38 offen sc1
    s_nop 0
    v_add_f32 v56, v56, v58
    v_add_f32 v57, v57, v59
    v_cvt_pk_bf16_f32 v24, v56, v57
    v_add_f32 v64, v64, v66
    v_add_f32 v65, v65, v67
    v_cvt_pk_bf16_f32 v25, v64, v65
    ds_read_b128 v[108:111], v19 offset:19456
    v_cvt_pk_bf16_f32 v32, v28, v29
    v_mfma_f32_16x16x16_bf16 v[36:39], v[24:25], v[2:3], 0
    v_cvt_pk_bf16_f32 v33, v30, v31
    v_and_b32 v44, v32, v20
    v_and_b32 v45, v33, v20
    v_and_b32_dpp v48, v32, v21 quad_perm:[0,1,0,1] row_mask:0xf bank_mask:0xf
    v_and_b32_dpp v49, v33, v21 quad_perm:[0,1,0,1] row_mask:0xf bank_mask:0xf
    ds_read_b128 v[120:123], v19 offset:34816
    ds_read_b128 v[124:127], v19 offset:35840
    s_cmp_eq_u32 s28, 63
    v_cvt_pk_bf16_f32 v34, v36, v37
    v_cvt_pk_bf16_f32 v35, v38, v39
    v_and_b32 v46, v34, v20
    v_and_b32 v47, v35, v20
    v_mfma_f32_16x16x32_bf16 v[60:63], v[32:35], v[32:35], 0
    v_and_b32_dpp v50, v34, v21 quad_perm:[0,1,0,1] row_mask:0xf bank_mask:0xf
    v_and_b32_dpp v51, v35, v21 quad_perm:[0,1,0,1] row_mask:0xf bank_mask:0xf
    v_mfma_f32_16x16x32_bf16 v[52:55], v[76:79], v[44:47], 0
    ds_read_b128 v[104:107], v19 offset:18432
    v_mfma_f32_16x16x32_bf16 v[52:55], v[80:83], v[48:51], v[52:55]
    s_cbranch_scc1 L_rdone_116
    v_mov_b32 v74, v73
    s_mov_b64 exec, s[58:59]
    ds_write2_b32 v11, v62, v63 offset0:0 offset1:32
    s_mov_b64 exec, -1
    v_mov_b32 v22, 0x3f803f80
    v_mov_b32 v23, 0x3f803f80
    v_mfma_f32_16x16x4_f32 v[28:31], v95, v95, 0
    ds_write_b128 v10, v[52:55] offset:10240
    v_mfma_f32_16x16x4_f32 v[28:31], v95, v95, 0
    s_mov_b64 exec, s[14:15]
    buffer_store_dwordx4 v[32:35], v4, s[4:7], s45 offen sc1
    s_mov_b64 exec, -1
    buffer_load_dwordx4 v16, s[4:7], s21 offen offset:3072 sc1 lds
    v_mfma_f32_16x16x4_f32 v[28:31], v95, v95, 0
    s_waitcnt lgkmcnt(0)
    s_barrier
    ds_read_b128 v[52:55], v9 offset:10240
    v_mfma_f32_16x16x4_f32 v[28:31], v95, v95, 0
    ds_read_b128 v[56:59], v9 offset:11264
    ds_read_b128 v[60:63], v9 offset:12288
    ds_read_b128 v[64:67], v9 offset:13312
    ds_read_b128 v[36:39], v9 offset:14336
    buffer_store_dwordx2 v[68:69], v94, s[4:7], s39 offen sc1
    v_mov_b32 v24, 0x3f803f80
    v_mov_b32 v25, 0x3f803f80
    v_mov_b32 v42, 1107296256
    s_waitcnt lgkmcnt(3)
    v_pk_add_f32 v[52:53], v[52:53], v[56:57]
    v_pk_add_f32 v[54:55], v[54:55], v[58:59]
    s_waitcnt lgkmcnt(2)
    v_pk_add_f32 v[52:53], v[52:53], v[60:61]
    v_pk_add_f32 v[54:55], v[54:55], v[62:63]
    s_waitcnt lgkmcnt(0)
    v_pk_add_f32 v[52:53], v[52:53], v[64:65]
    v_pk_add_f32 v[36:37], v[36:37], v[38:39]
    v_pk_add_f32 v[54:55], v[54:55], v[66:67]
    v_add_f32 v36, v36, v37
    v_pk_mul_f32 v[48:49], v[52:53], s[12:13]
    v_pk_mul_f32 v[50:51], v[54:55], s[12:13]
    v_mul_f32 v38, s46, v36
    v_max3_f32 v20, |v48|, |v49|, |v50|
    v_max3_f32 v20, v20, |v51|, |v38|
    v_cmp_nlt_f32 vcc, v20, v42
L_sok_122:
    v_exp_f32 v48, v48
    v_exp_f32 v49, v49
    v_exp_f32 v50, v50
    v_exp_f32 v51, v51
    v_cvt_pk_bf16_f32 v44, v48, v49
    v_cvt_pk_bf16_f32 v45, v50, v51
    v_exp_f32 v38, v38
    v_mov_b32_dpp v46, v44 quad_perm:[2,3,2,3] row_mask:0xf bank_mask:0xf
    v_mov_b32_dpp v47, v45 quad_perm:[2,3,2,3] row_mask:0xf bank_mask:0xf
    v_mov_b32_dpp v39, v38 quad_perm:[2,3,2,3] row_mask:0xf bank_mask:0xf
    v_cvt_pk_bf16_f32 v40, v38, v39
    s_cbranch_vccnz L_smx_123
    s_waitcnt vmcnt(3)
L_vok_124:
    v_mfma_f32_16x16x32_bf16 v[76:79], v[84:87], v[44:47], 0
    v_mov_b32 v73, v92
    v_mov_b32 v41, v40
    v_mfma_f32_16x16x32_bf16 v[80:83], v[88:91], v[44:47], 0
    v_mov_b32 v75, v93
    v_max_u32 v20, v92, v93
    v_cmp_eq_u32 vcc, -1, v20
    v_mfma_f32_16x16x16_bf16 v[76:79], v[72:73], v[40:41], v[76:79]
    v_mov_b64 v[52:53], 0
    v_mov_b64 v[54:55], 0
    v_mfma_f32_16x16x16_bf16 v[80:83], v[74:75], v[40:41], v[80:83]
    v_mov_b64 v[68:69], 0
    v_mov_b64 v[70:71], 0
    v_mfma_f32_16x16x16_bf16 v[48:51], v[40:41], v[22:23], 0
    s_cbranch_vccnz L_vre_125
    v_mov_b64 v[32:33], -1
    v_cvt_pk_bf16_f32 v28, v76, v77
    v_cvt_pk_bf16_f32 v29, v78, v79
    v_mov_b64 v[34:35], -1
    v_cvt_pk_bf16_f32 v30, v80, v81
    v_cvt_pk_bf16_f32 v31, v82, v83
    v_mfma_f32_16x16x32_bf16 v[36:39], v[44:47], v[22:25], 0
    s_mov_b64 exec, s[58:59]
    ds_write_b128 v12, v[28:31] offset:15360
    s_mov_b64 exec, -1
    buffer_store_dwordx4 v[32:35], v5, s[4:7], s42 offen sc1
    v_mfma_f32_16x16x4_f32 v[88:91], v95, v95, 0
    s_waitcnt lgkmcnt(0)
    s_barrier
    ds_read_b128 v[76:79], v9 offset:15360
    v_mfma_f32_16x16x16_bf16 v[40:43], v[2:3], v[2:3], 0
    ds_read_b128 v[80:83], v9 offset:16384
    buffer_store_dword v32, v6, s[4:7], s42 offen sc1
    v_fma_f32 v48, v48, 0.5, v36
    v_fma_f32 v49, v49, 0.5, v37
    v_mov_b64 v[56:57], 0
    v_rcp_f32 v20, v48
    v_mov_b64 v[58:59], 0
    v_mov_b64 v[60:61], 0
    v_rcp_f32 v21, v49
    s_waitcnt lgkmcnt(1)
    v_smfmac_f32_16x16x64_bf16 v[68:71], v[76:79], v[112:119], v1
    s_waitcnt lgkmcnt(0)
    v_smfmac_f32_16x16x64_bf16 v[68:71], v[80:83], v[120:127], v1
    ds_read_b128 v[84:87], v4 offset:17408
    v_smfmac_f32_16x16x64_bf16 v[52:55], v[76:79], v[208:215], v1
    v_mov_b64 v[62:63], 0
    v_smfmac_f32_16x16x64_bf16 v[52:55], v[80:83], v[216:223], v1
    v_mov_b64 v[64:65], 0
    v_smfmac_f32_16x16x64_bf16 v[56:59], v[76:79], v[224:231], v1
    v_mov_b64 v[66:67], 0
    v_smfmac_f32_16x16x64_bf16 v[56:59], v[80:83], v[232:239], v1
    v_add_f32 v68, v68, v70
    v_smfmac_f32_16x16x64_bf16 v[60:63], v[76:79], v[240:247], v1
    v_add_f32 v69, v69, v71
    v_smfmac_f32_16x16x64_bf16 v[60:63], v[80:83], v[248:255], v1
    v_mul_f32 v68, v68, v20
    v_smfmac_f32_16x16x64_bf16 v[64:67], v[76:79], v[96:103], v1
    v_mul_f32 v69, v69, v21
    v_smfmac_f32_16x16x64_bf16 v[64:67], v[80:83], v[104:111], v1
    v_cvt_pk_bf16_f32 v26, v68, v69
    v_add_f32 v52, v52, v54
    v_add_f32 v53, v53, v55
    buffer_store_dword v26, v14, s[4:7], s40 offen sc1
    v_pk_add_f32 v[56:57], v[56:57], v[58:59]
    v_pk_add_f32 v[60:61], v[60:61], v[62:63]
    v_pk_mul_f32 v[52:53], v[52:53], v[20:21]
    v_pk_mul_f32 v[56:57], v[56:57], v[20:21]
    v_pk_add_f32 v[64:65], v[64:65], v[66:67]
    v_pk_mul_f32 v[60:61], v[60:61], v[20:21]
    v_pk_mul_f32 v[64:65], v[64:65], v[20:21]
    v_cvt_pk_bf16_f32 v22, v52, v53
    v_cvt_pk_bf16_f32 v23, v56, v57
    v_cvt_pk_bf16_f32 v24, v60, v61
    v_cvt_pk_bf16_f32 v25, v64, v65
    buffer_store_dwordx4 v[22:25], v13, s[4:7], s40 offen sc1
    s_add_u32 s45, s45, 131072
    s_add_u32 s16, s16, 131072
    s_add_u32 s28, s28, 1
    s_lshl_b32 s55, s29, 12
    s_add_u32 s41, s40, s55
    ds_read_b128 v[96:99], v18 offset:16384
    ds_read_b128 v[100:103], v18 offset:17408
    ds_read_b128 v[104:107], v18 offset:18432
    ds_read_b128 v[108:111], v18 offset:19456
    ds_read_b128 v[112:115], v18 offset:32768
    ds_read_b128 v[116:119], v18 offset:33792
    ds_read_b128 v[120:123], v18 offset:34816
    ds_read_b128 v[124:127], v18 offset:35840
    s_and_b32 s53, s28, 3
    s_xor_b32 s54, s53, 2
    s_mul_i32 s54, s54, 163840
    s_add_u32 s42, s17, s54
    s_mul_i32 s54, s53, 163840
    s_add_u32 s40, s52, s54
    s_lshl_b32 s53, s53, 16
    s_add_u32 s32, s47, s53
    s_add_u32 s33, s48, s53
    s_add_u32 s34, s49, s53
    s_xor_b32 s54, s53, 131072
    s_add_u32 s36, s49, s54
    s_add_u32 s54, s48, s54
    s_cmp_lt_i32 s29, 0
    s_cselect_b32 s57, s2, s54
    s_cselect_b32 s35, s28, -1
    s_add_u32 s18, s28, 2
    s_min_u32 s18, s18, 64
    s_add_u32 s53, s28, s25
    s_and_b32 s53, s53, 3
    s_lshl_b32 s53, s53, 11
    s_add_u32 s37, s50, s53
    s_xor_b32 s38, s37, 524288
    s_xor_b32 s39, s37, 4096
    s_add_u32 s44, s44, 262144
    s_add_u32 s20, s20, 262144
    s_add_u32 s43, s43, 262144
    s_add_u32 s21, s21, 262144
    s_min_u32 s8, s8, s9
    s_max_u32 s22, s22, s8
    s_cmp_lt_u32 s22, s18
    s_cbranch_scc1 L_kre_127
L_kok_126:
    s_waitcnt lgkmcnt(0)
    s_add_u32 s53, s28, 5
    s_min_u32 s53, s53, 64
    s_cmp_ge_u32 s22, s53
    s_cbranch_scc1 L_nosl_128
    s_load_dword s8, s[10:11], 0 glc
    s_load_dword s9, s[10:11], 8192 glc
L_nosl_128:
    s_cmp_lt_i32 s29, 0
    s_cbranch_scc1 L_nored_129
    buffer_load_dwordx4 v[32:35], v4, s[4:7], s41 offen offset:0 sc1
    buffer_load_dwordx4 v[36:39], v4, s[4:7], s41 offen offset:1024 sc1
    buffer_load_dwordx4 v[40:43], v4, s[4:7], s41 offen offset:2048 sc1
    buffer_load_dwordx4 v[44:47], v4, s[4:7], s41 offen offset:3072 sc1
    s_nop 15
    s_nop 13
    buffer_load_dwordx4 v[52:55], v4, s[4:7], s41 offen offset:0 sc1
    buffer_load_dwordx4 v[56:59], v4, s[4:7], s41 offen offset:1024 sc1
    buffer_load_dwordx4 v[60:63], v4, s[4:7], s41 offen offset:2048 sc1
    buffer_load_dwordx4 v[64:67], v4, s[4:7], s41 offen offset:3072 sc1
    s_waitcnt vmcnt(7)
    v_mfma_f32_16x16x32_bf16 v[48:51], v[84:87], v[32:35], 0
    v_max3_u32 v20, v32, v33, v34
    s_waitcnt vmcnt(6)
    v_mfma_f32_16x16x32_bf16 v[48:51], v[84:87], v[36:39], v[48:51]
    v_max3_u32 v20, v20, v35, v36
    v_max3_u32 v20, v20, v37, v38
    s_waitcnt vmcnt(5)
    v_mfma_f32_16x16x32_bf16 v[48:51], v[84:87], v[40:43], v[48:51]
    v_max3_u32 v20, v20, v39, v40
    v_max3_u32 v20, v20, v41, v42
    s_waitcnt vmcnt(4)
    v_mfma_f32_16x16x32_bf16 v[48:51], v[84:87], v[44:47], v[48:51]
    v_max3_u32 v20, v20, v43, v44
    v_max3_u32 v20, v20, v45, v46
    v_max_u32 v20, v20, v47
    v_cmp_eq_u32 vcc, -1, v20
    s_nop 3
    v_add_f32_dpp v28, v48, v48 row_ror:8 row_mask:0xf bank_mask:0xf
    v_add_f32_dpp v29, v49, v49 row_ror:8 row_mask:0xf bank_mask:0xf
    v_add_f32_dpp v30, v50, v50 row_ror:8 row_mask:0xf bank_mask:0xf
    v_add_f32_dpp v31, v51, v51 row_ror:8 row_mask:0xf bank_mask:0xf
    v_cvt_pk_bf16_f32 v28, v28, v29
    v_cvt_pk_bf16_f32 v29, v30, v31
    s_cbranch_vccnz L_redr_131
L_red_130:
    buffer_store_dwordx2 v[28:29], v15, s[4:7], s33 offen sc1
    s_barrier
    s_waitcnt vmcnt(1)
L_join_132:
    s_branch L_step_117
L_lre_119:
    s_sub_u32 s31, s31, 1
    s_cbranch_scc1 L_exit
    buffer_load_dwordx4 v[22:25], v5, s[4:7], s34 offen sc1
    buffer_load_dword v26, v6, s[4:7], s34 offen sc1
    s_nop 0
    v_mov_b64 v[68:69], 0
    v_mov_b64 v[70:71], 0
    v_mov_b64 v[72:73], 0
    v_mov_b64 v[74:75], 0
    s_waitcnt vmcnt(2)
    ds_write_b128 v5, v[28:31] offset:5120
    ds_write_b32 v6, v27 offset:5120
    v_max3_u32 v20, v28, v29, v30
    v_max3_u32 v20, v20, v31, v27
    v_cmp_eq_u32 vcc, -1, v20
    v_mov_b64 v[32:33], v[28:29]
    v_mov_b64 v[34:35], v[30:31]
    s_nop 0
    s_cbranch_vccz L_lok_118
    buffer_load_dwordx4 v[28:31], v5, s[4:7], s34 offen sc1
    buffer_load_dword v27, v6, s[4:7], s34 offen sc1
    s_waitcnt vmcnt(2)
    ds_write_b128 v5, v[22:25] offset:5120
    ds_write_b32 v6, v26 offset:5120
    v_max3_u32 v20, v22, v23, v24
    v_max3_u32 v20, v20, v25, v26
    v_cmp_eq_u32 vcc, -1, v20
    v_mov_b64 v[32:33], v[22:23]
    v_mov_b64 v[34:35], v[24:25]
    s_nop 0
    s_cbranch_vccz L_lok_118
    s_branch L_lre_119
L_rre_121:
    s_sub_u32 s31, s31, 1
    s_cbranch_scc1 L_exit
    buffer_load_dwordx4 v[28:31], v5, s[4:7], s32 offen sc1
    buffer_load_dword v27, v6, s[4:7], s32 offen sc1
    s_waitcnt vmcnt(0)
    ds_write_b128 v5, v[28:31] offset:0
    ds_write_b32 v6, v27 offset:0
    v_max3_u32 v20, v28, v29, v30
    v_max3_u32 v20, v20, v31, v27
    v_cmp_eq_u32 vcc, -1, v20
    s_waitcnt lgkmcnt(0)
    s_cbranch_vccz L_rok_120
    s_branch L_rre_121
L_smx_123:
    v_max3_f32 v20, v52, v53, v54
    v_max3_f32 v20, v20, v55, v36
    s_nop 1
    v_max_f32_dpp v21, v20, v20 quad_perm:[2,3,0,1] row_mask:0xf bank_mask:0xf
    v_max_f32_dpp v20, v20, v20 quad_perm:[2,3,0,1] row_mask:0xf bank_mask:0xf
    s_nop 1
    v_permlane16_swap_b32 v20, v21
    v_max_f32 v37, v20, v21
    v_max_f32 v20, v20, v21
    s_nop 1
    v_permlane32_swap_b32 v20, v37
    v_max_f32 v20, v20, v37
    v_mul_f32 v20, s46, v20
    v_fma_f32 v48, v52, s46, -v20
    v_fma_f32 v49, v53, s46, -v20
    v_fma_f32 v50, v54, s46, -v20
    v_fma_f32 v51, v55, s46, -v20
    v_fma_f32 v38, v36, s46, -v20
    s_mov_b64 vcc, 0
    s_branch L_sok_122
L_vre_125:
    s_sub_u32 s31, s31, 1
    s_cbranch_scc1 L_exit
    buffer_load_dwordx2 v[92:93], v94, s[4:7], s38 offen sc1
    s_waitcnt vmcnt(0)
    s_branch L_vok_124
L_kre_127:
    v_lshlrev_b32 v20, 9, v4
    s_mov_b64 exec, 3
L_wf_133:
    buffer_load_dword v21, v20, s[4:7], s23 offen sc1
    s_waitcnt vmcnt(0)
    v_cmp_gt_u32 vcc, s18, v21
    s_cbranch_vccz L_wfd_134
    s_sleep 1
    s_sub_u32 s31, s31, 1
    s_cbranch_scc1 L_exit
    s_branch L_wf_133
L_wfd_134:
    s_mov_b64 exec, -1
    v_readlane_b32 s22, v21, 0
    v_readlane_b32 s56, v21, 1
    s_nop 0
    s_min_u32 s22, s22, s56
    s_branch L_kok_126
L_redr_131:
    s_sub_u32 s31, s31, 1
    s_cbranch_scc1 L_exit
    buffer_load_dwordx4 v[32:35], v4, s[4:7], s41 offen offset:0 sc1
    buffer_load_dwordx4 v[36:39], v4, s[4:7], s41 offen offset:1024 sc1
    buffer_load_dwordx4 v[40:43], v4, s[4:7], s41 offen offset:2048 sc1
    buffer_load_dwordx4 v[44:47], v4, s[4:7], s41 offen offset:3072 sc1
    s_waitcnt vmcnt(7)
    v_mfma_f32_16x16x32_bf16 v[48:51], v[84:87], v[52:55], 0
    v_max3_u32 v20, v52, v53, v54
    s_waitcnt vmcnt(6)
    v_mfma_f32_16x16x32_bf16 v[48:51], v[84:87], v[56:59], v[48:51]
    v_max3_u32 v20, v20, v55, v56
    v_max3_u32 v20, v20, v57, v58
    s_waitcnt vmcnt(5)
    v_mfma_f32_16x16x32_bf16 v[48:51], v[84:87], v[60:63], v[48:51]
    v_max3_u32 v20, v20, v59, v60
    v_max3_u32 v20, v20, v61, v62
    s_waitcnt vmcnt(4)
    v_mfma_f32_16x16x32_bf16 v[48:51], v[84:87], v[64:67], v[48:51]
    v_max3_u32 v20, v20, v63, v64
    v_max3_u32 v20, v20, v65, v66
    v_max_u32 v20, v20, v67
    v_cmp_eq_u32 vcc, -1, v20
    s_nop 3
    v_add_f32_dpp v28, v48, v48 row_ror:8 row_mask:0xf bank_mask:0xf
    v_add_f32_dpp v29, v49, v49 row_ror:8 row_mask:0xf bank_mask:0xf
    v_add_f32_dpp v30, v50, v50 row_ror:8 row_mask:0xf bank_mask:0xf
    v_add_f32_dpp v31, v51, v51 row_ror:8 row_mask:0xf bank_mask:0xf
    v_cvt_pk_bf16_f32 v28, v28, v29
    v_cvt_pk_bf16_f32 v29, v30, v31
    s_cbranch_vccz L_red_130
    buffer_load_dwordx4 v[52:55], v4, s[4:7], s41 offen offset:0 sc1
    buffer_load_dwordx4 v[56:59], v4, s[4:7], s41 offen offset:1024 sc1
    buffer_load_dwordx4 v[60:63], v4, s[4:7], s41 offen offset:2048 sc1
    buffer_load_dwordx4 v[64:67], v4, s[4:7], s41 offen offset:3072 sc1
    s_waitcnt vmcnt(7)
    v_mfma_f32_16x16x32_bf16 v[48:51], v[84:87], v[32:35], 0
    v_max3_u32 v20, v32, v33, v34
    s_waitcnt vmcnt(6)
    v_mfma_f32_16x16x32_bf16 v[48:51], v[84:87], v[36:39], v[48:51]
    v_max3_u32 v20, v20, v35, v36
    v_max3_u32 v20, v20, v37, v38
    s_waitcnt vmcnt(5)
    v_mfma_f32_16x16x32_bf16 v[48:51], v[84:87], v[40:43], v[48:51]
    v_max3_u32 v20, v20, v39, v40
    v_max3_u32 v20, v20, v41, v42
    s_waitcnt vmcnt(4)
    v_mfma_f32_16x16x32_bf16 v[48:51], v[84:87], v[44:47], v[48:51]
    v_max3_u32 v20, v20, v43, v44
    v_max3_u32 v20, v20, v45, v46
    v_max_u32 v20, v20, v47
    v_cmp_eq_u32 vcc, -1, v20
    s_nop 3
    v_add_f32_dpp v28, v48, v48 row_ror:8 row_mask:0xf bank_mask:0xf
    v_add_f32_dpp v29, v49, v49 row_ror:8 row_mask:0xf bank_mask:0xf
    v_add_f32_dpp v30, v50, v50 row_ror:8 row_mask:0xf bank_mask:0xf
    v_add_f32_dpp v31, v51, v51 row_ror:8 row_mask:0xf bank_mask:0xf
    v_cvt_pk_bf16_f32 v28, v28, v29
    v_cvt_pk_bf16_f32 v29, v30, v31
    s_cbranch_vccz L_red_130
    s_branch L_redr_131
L_nored_129:
    s_barrier
    s_branch L_join_132
L_rdone_116:
    s_mov_b64 exec, s[14:15]
    buffer_store_dwordx4 v[32:35], v4, s[4:7], s45 offen sc1
    s_mov_b64 exec, -1
    s_waitcnt vmcnt(0)
    s_barrier
    s_mov_b64 exec, 1
    v_mov_b32 v20, 64
    buffer_store_dword v20, off, s[4:7], s2 sc1
    s_mov_b64 exec, -1
    s_branch L_exit
L_reclaim:
    s_waitcnt vmcnt(0)
    s_cmp_lg_u32 s26, 0
    s_cbranch_scc1 L_clw_138
    s_mov_b64 exec, 1
L_cl_135:
    s_ff0_i32_b32 s25, s99
    s_cmp_lt_i32 s25, 0
    s_cbranch_scc0 L_cla_139
    s_add_u32 s24, s24, 1
    s_and_b32 s24, s24, 7
    s_mov_b32 s25, 0
    v_mov_b32 v2, 0
    v_mov_b32 v3, 1
    global_atomic_or v2, v3, s[96:97] offset:32
    s_waitcnt vmcnt(0)
    s_add_u32 s98, s98, 1
    s_cmp_lt_u32 s98, 8
    s_cbranch_scc1 L_cla_139
    s_mov_b32 s24, 8
    s_branch L_cld_136
L_cla_139:
    s_lshl_b32 s99, s24, 2
    v_mov_b32 v2, s99
    s_lshl_b32 s99, 1, s25
    v_mov_b32 v3, s99
    global_atomic_or v3, v2, v3, s[96:97] sc0
    s_waitcnt vmcnt(0)
    v_readfirstlane_b32 s99, v3
    s_nop 0
    s_bitcmp1_b32 s99, s25
    s_cbranch_scc1 L_cl_135
L_cld_136:
    v_mov_b32 v2, s24
    v_mov_b32 v3, s25
    ds_write_b64 v254, v[2:3]
    s_mov_b64 exec, -1
    s_waitcnt lgkmcnt(0)
L_clw_138:
    s_barrier
    ds_read_b64 v[2:3], v254
    s_lshl_b32 s99, s26, 6
    v_mbcnt_lo_u32_b32 v0, -1, 0
    v_mbcnt_hi_u32_b32 v0, -1, v0
    v_add_u32 v0, s99, v0
    s_waitcnt lgkmcnt(0)
    v_readfirstlane_b32 s24, v2
    v_readfirstlane_b32 s25, v3
    s_cmp_ge_u32 s24, 8
    s_cbranch_scc1 L_exit
    s_and_b32 s25, s25, 31
    s_mov_b32 s98, 1
    s_barrier
    s_branch L_dispatch
L_k:
    s_lshl_b32 s33, s25, 8
    s_add_u32 s33, s33, 3538944
    s_load_dwordx2 s[8:9], s[0:1], 24
    v_and_b32 v1, 63, v0
    v_lshlrev_b32 v2, 4, v1
    v_and_b32 v4, 15, v1
    v_lshrrev_b32 v5, 4, v1
    v_lshlrev_b32 v6, 2, v5
    v_xor_b32 v6, v6, v4
    v_lshlrev_b32 v6, 4, v6
    v_lshl_add_u32 v6, v5, 13, v6
    s_lshl_b32 s34, s25, 8
    s_lshl_b32 s35, s26, 17
    s_add_u32 s34, s34, s35
    v_add_u32 v6, s34, v6
    s_lshl_b32 s35, s26, 12
    s_waitcnt lgkmcnt(0)
    s_mov_b32 s10, 5242880
    s_mov_b32 s11, 0x20000
    s_add_u32 m0, s35, 0
    s_mov_b32 s34, 0
    buffer_load_dwordx4 v6, s[8:11], s34 offen offset:0 lds
    s_mov_b32 s34, 31744
    buffer_load_dwordx4 v6, s[8:11], s34 offen offset:1024 lds
    s_mov_b32 s34, 63488
    buffer_load_dwordx4 v6, s[8:11], s34 offen offset:2048 lds
    s_mov_b32 s34, 95232
    buffer_load_dwordx4 v6, s[8:11], s34 offen offset:3072 lds
    s_add_u32 m0, s35, 16384
    s_mov_b32 s34, 524288
    buffer_load_dwordx4 v6, s[8:11], s34 offen offset:0 lds
    s_mov_b32 s34, 556032
    buffer_load_dwordx4 v6, s[8:11], s34 offen offset:1024 lds
    s_mov_b32 s34, 587776
    buffer_load_dwordx4 v6, s[8:11], s34 offen offset:2048 lds
    s_mov_b32 s34, 619520
    buffer_load_dwordx4 v6, s[8:11], s34 offen offset:3072 lds
    s_add_u32 m0, s35, 32768
    s_mov_b32 s34, 1048576
    buffer_load_dwordx4 v6, s[8:11], s34 offen offset:0 lds
    s_mov_b32 s34, 1080320
    buffer_load_dwordx4 v6, s[8:11], s34 offen offset:1024 lds
    s_mov_b32 s34, 1112064
    buffer_load_dwordx4 v6, s[8:11], s34 offen offset:2048 lds
    s_mov_b32 s34, 1143808
    buffer_load_dwordx4 v6, s[8:11], s34 offen offset:3072 lds
    s_add_u32 m0, s35, 49152
    s_mov_b32 s34, 1572864
    buffer_load_dwordx4 v6, s[8:11], s34 offen offset:0 lds
    s_mov_b32 s34, 1604608
    buffer_load_dwordx4 v6, s[8:11], s34 offen offset:1024 lds
    s_mov_b32 s34, 1636352
    buffer_load_dwordx4 v6, s[8:11], s34 offen offset:2048 lds
    s_mov_b32 s34, 1668096
    buffer_load_dwordx4 v6, s[8:11], s34 offen offset:3072 lds
    s_add_u32 m0, s35, 65536
    s_mov_b32 s34, 2097152
    buffer_load_dwordx4 v6, s[8:11], s34 offen offset:0 lds
    s_mov_b32 s34, 2128896
    buffer_load_dwordx4 v6, s[8:11], s34 offen offset:1024 lds
    s_mov_b32 s34, 2160640
    buffer_load_dwordx4 v6, s[8:11], s34 offen offset:2048 lds
    s_mov_b32 s34, 2192384
    buffer_load_dwordx4 v6, s[8:11], s34 offen offset:3072 lds
    s_add_u32 m0, s35, 81920
    s_mov_b32 s34, 2621440
    buffer_load_dwordx4 v6, s[8:11], s34 offen offset:0 lds
    s_mov_b32 s34, 2653184
    buffer_load_dwordx4 v6, s[8:11], s34 offen offset:1024 lds
    s_mov_b32 s34, 2684928
    buffer_load_dwordx4 v6, s[8:11], s34 offen offset:2048 lds
    s_mov_b32 s34, 2716672
    buffer_load_dwordx4 v6, s[8:11], s34 offen offset:3072 lds
    s_add_u32 m0, s35, 98304
    s_mov_b32 s34, 3145728
    buffer_load_dwordx4 v6, s[8:11], s34 offen offset:0 lds
    s_mov_b32 s34, 3177472
    buffer_load_dwordx4 v6, s[8:11], s34 offen offset:1024 lds
    s_mov_b32 s34, 3209216
    buffer_load_dwordx4 v6, s[8:11], s34 offen offset:2048 lds
    s_mov_b32 s34, 3240960
    buffer_load_dwordx4 v6, s[8:11], s34 offen offset:3072 lds
    s_add_u32 m0, s35, 114688
    s_mov_b32 s34, 3670016
    buffer_load_dwordx4 v6, s[8:11], s34 offen offset:0 lds
    s_mov_b32 s34, 3701760
    buffer_load_dwordx4 v6, s[8:11], s34 offen offset:1024 lds
    s_mov_b32 s34, 3733504
    buffer_load_dwordx4 v6, s[8:11], s34 offen offset:2048 lds
    s_mov_b32 s34, 3765248
    buffer_load_dwordx4 v6, s[8:11], s34 offen offset:3072 lds
    s_add_u32 m0, s35, 131072
    s_mov_b32 s34, 4194304
    buffer_load_dwordx4 v6, s[8:11], s34 offen offset:0 lds
    s_mov_b32 s34, 4226048
    buffer_load_dwordx4 v6, s[8:11], s34 offen offset:1024 lds
    s_mov_b32 s34, 4257792
    buffer_load_dwordx4 v6, s[8:11], s34 offen offset:2048 lds
    s_mov_b32 s34, 4289536
    buffer_load_dwordx4 v6, s[8:11], s34 offen offset:3072 lds
    s_add_u32 m0, s35, 147456
    s_mov_b32 s34, 4718592
    buffer_load_dwordx4 v6, s[8:11], s34 offen offset:0 lds
    s_mov_b32 s34, 4750336
    buffer_load_dwordx4 v6, s[8:11], s34 offen offset:1024 lds
    s_mov_b32 s34, 4782080
    buffer_load_dwordx4 v6, s[8:11], s34 offen offset:2048 lds
    s_mov_b32 s34, 4813824
    buffer_load_dwordx4 v6, s[8:11], s34 offen offset:3072 lds
    v_bfe_u32 v7, v1, 2, 2
    v_and_b32 v8, 3, v1
    v_and_b32 v9, 1, v5
    v_lshrrev_b32 v10, 1, v5
    v_and_b32 v11, 1, v8
    v_lshl_add_u32 v11, v9, 1, v11
    v_lshrrev_b32 v12, 1, v8
    v_xor_b32 v13, s26, v7
    v_lshl_add_u32 v11, v13, 2, v11
    v_lshlrev_b32 v11, 4, v11
    v_lshl_add_u32 v11, v12, 3, v11
    v_lshl_add_u32 v11, v7, 8, v11
    v_lshl_add_u32 v11, v10, 11, v11
    s_waitcnt vmcnt(36)
    s_barrier
    v_add_u32 v12, 0, v11
    ds_read_b64_tr_b16 a[0:1], v12 offset:0
    ds_read_b64_tr_b16 a[2:3], v12 offset:1024
    ds_read_b64_tr_b16 a[4:5], v12 offset:4096
    ds_read_b64_tr_b16 a[6:7], v12 offset:5120
    ds_read_b64_tr_b16 a[8:9], v12 offset:8192
    ds_read_b64_tr_b16 a[10:11], v12 offset:9216
    ds_read_b64_tr_b16 a[12:13], v12 offset:12288
    ds_read_b64_tr_b16 a[14:15], v12 offset:13312
    s_waitcnt lgkmcnt(0)
    s_waitcnt vmcnt(32)
    s_barrier
    v_add_u32 v12, 16384, v11
    ds_read_b64_tr_b16 a[16:17], v12 offset:0
    ds_read_b64_tr_b16 a[18:19], v12 offset:1024
    ds_read_b64_tr_b16 a[20:21], v12 offset:4096
    ds_read_b64_tr_b16 a[22:23], v12 offset:5120
    ds_read_b64_tr_b16 a[24:25], v12 offset:8192
    ds_read_b64_tr_b16 a[26:27], v12 offset:9216
    ds_read_b64_tr_b16 a[28:29], v12 offset:12288
    ds_read_b64_tr_b16 a[30:31], v12 offset:13312
    s_waitcnt lgkmcnt(0)
    s_waitcnt vmcnt(28)
    s_barrier
    v_add_u32 v12, 32768, v11
    ds_read_b64_tr_b16 a[32:33], v12 offset:0
    ds_read_b64_tr_b16 a[34:35], v12 offset:1024
    ds_read_b64_tr_b16 a[36:37], v12 offset:4096
    ds_read_b64_tr_b16 a[38:39], v12 offset:5120
    ds_read_b64_tr_b16 a[40:41], v12 offset:8192
    ds_read_b64_tr_b16 a[42:43], v12 offset:9216
    ds_read_b64_tr_b16 a[44:45], v12 offset:12288
    ds_read_b64_tr_b16 a[46:47], v12 offset:13312
    s_waitcnt lgkmcnt(0)
    s_waitcnt vmcnt(24)
    s_barrier
    v_add_u32 v12, 49152, v11
    ds_read_b64_tr_b16 a[48:49], v12 offset:0
    ds_read_b64_tr_b16 a[50:51], v12 offset:1024
    ds_read_b64_tr_b16 a[52:53], v12 offset:4096
    ds_read_b64_tr_b16 a[54:55], v12 offset:5120
    ds_read_b64_tr_b16 a[56:57], v12 offset:8192
    ds_read_b64_tr_b16 a[58:59], v12 offset:9216
    ds_read_b64_tr_b16 a[60:61], v12 offset:12288
    ds_read_b64_tr_b16 a[62:63], v12 offset:13312
    s_waitcnt lgkmcnt(0)
    s_waitcnt vmcnt(20)
    s_barrier
    v_add_u32 v12, 65536, v11
    ds_read_b64_tr_b16 a[64:65], v12 offset:0
    ds_read_b64_tr_b16 a[66:67], v12 offset:1024
    ds_read_b64_tr_b16 a[68:69], v12 offset:4096
    ds_read_b64_tr_b16 a[70:71], v12 offset:5120
    ds_read_b64_tr_b16 a[72:73], v12 offset:8192
    ds_read_b64_tr_b16 a[74:75], v12 offset:9216
    ds_read_b64_tr_b16 a[76:77], v12 offset:12288
    ds_read_b64_tr_b16 a[78:79], v12 offset:13312
    s_waitcnt lgkmcnt(0)
    s_waitcnt vmcnt(16)
    s_barrier
    v_add_u32 v12, 81920, v11
    ds_read_b64_tr_b16 a[80:81], v12 offset:0
    ds_read_b64_tr_b16 a[82:83], v12 offset:1024
    ds_read_b64_tr_b16 a[84:85], v12 offset:4096
    ds_read_b64_tr_b16 a[86:87], v12 offset:5120
    ds_read_b64_tr_b16 a[88:89], v12 offset:8192
    ds_read_b64_tr_b16 a[90:91], v12 offset:9216
    ds_read_b64_tr_b16 a[92:93], v12 offset:12288
    ds_read_b64_tr_b16 a[94:95], v12 offset:13312
    s_waitcnt lgkmcnt(0)
    s_waitcnt vmcnt(12)
    s_barrier
    v_add_u32 v12, 98304, v11
    ds_read_b64_tr_b16 a[96:97], v12 offset:0
    ds_read_b64_tr_b16 a[98:99], v12 offset:1024
    ds_read_b64_tr_b16 a[100:101], v12 offset:4096
    ds_read_b64_tr_b16 a[102:103], v12 offset:5120
    ds_read_b64_tr_b16 a[104:105], v12 offset:8192
    ds_read_b64_tr_b16 a[106:107], v12 offset:9216
    ds_read_b64_tr_b16 a[108:109], v12 offset:12288
    ds_read_b64_tr_b16 a[110:111], v12 offset:13312
    s_waitcnt lgkmcnt(0)
    s_waitcnt vmcnt(8)
    s_barrier
    v_add_u32 v12, 114688, v11
    ds_read_b64_tr_b16 a[112:113], v12 offset:0
    ds_read_b64_tr_b16 a[114:115], v12 offset:1024
    ds_read_b64_tr_b16 a[116:117], v12 offset:4096
    ds_read_b64_tr_b16 a[118:119], v12 offset:5120
    ds_read_b64_tr_b16 a[120:121], v12 offset:8192
    ds_read_b64_tr_b16 a[122:123], v12 offset:9216
    ds_read_b64_tr_b16 a[124:125], v12 offset:12288
    ds_read_b64_tr_b16 a[126:127], v12 offset:13312
    s_waitcnt lgkmcnt(0)
    s_or_b32 s99, s26, s98
    s_cbranch_scc1 L_ci_140
    s_lshl_b32 s99, s24, 2
    s_lshl_b32 s95, 1, s25
    s_atomic_or s95, s[96:97], s99 glc
L_ci_140:
    s_waitcnt vmcnt(4)
    s_barrier
    v_add_u32 v12, 131072, v11
    ds_read_b64_tr_b16 a[128:129], v12 offset:0
    ds_read_b64_tr_b16 a[130:131], v12 offset:1024
    ds_read_b64_tr_b16 a[132:133], v12 offset:4096
    ds_read_b64_tr_b16 a[134:135], v12 offset:5120
    ds_read_b64_tr_b16 a[136:137], v12 offset:8192
    ds_read_b64_tr_b16 a[138:139], v12 offset:9216
    ds_read_b64_tr_b16 a[140:141], v12 offset:12288
    ds_read_b64_tr_b16 a[142:143], v12 offset:13312
    s_waitcnt lgkmcnt(0)
    s_waitcnt vmcnt(0)
    s_barrier
    v_add_u32 v12, 147456, v11
    ds_read_b64_tr_b16 a[144:145], v12 offset:0
    ds_read_b64_tr_b16 a[146:147], v12 offset:1024
    ds_read_b64_tr_b16 a[148:149], v12 offset:4096
    ds_read_b64_tr_b16 a[150:151], v12 offset:5120
    ds_read_b64_tr_b16 a[152:153], v12 offset:8192
    ds_read_b64_tr_b16 a[154:155], v12 offset:9216
    ds_read_b64_tr_b16 a[156:157], v12 offset:12288
    ds_read_b64_tr_b16 a[158:159], v12 offset:13312
    s_waitcnt lgkmcnt(0)
    s_cmp_lg_u32 s98, 0
    s_cbranch_scc1 L_cc_141
    v_mov_b32 v254, 0
    s_cmp_lg_u32 s26, 0
    s_cbranch_scc1 L_ccw_142
    s_waitcnt lgkmcnt(0)
    v_mov_b32 v255, s95
    ds_write_b32 v254, v255
    s_waitcnt lgkmcnt(0)
L_ccw_142:
    s_barrier
    ds_read_b32 v255, v254
    s_waitcnt lgkmcnt(0)
    v_readfirstlane_b32 s99, v255
    s_barrier
    s_bitcmp1_b32 s99, s25
    s_cbranch_scc1 L_reclaim
L_cc_141:
    v_mbcnt_lo_u32_b32 v4, -1, 0
    v_lshlrev_b32 v4, 2, v4
    s_mov_b64 exec, 384
L_gs_143:
    global_load_dword v5, v4, s[96:97] offset:128 sc1
    s_waitcnt vmcnt(0)
    v_cmp_eq_u32 vcc, 0, v5
    s_cbranch_vccz L_gsd_144
    s_sleep 2
    s_sub_u32 s31, s31, 1
    s_cbranch_scc1 L_exit
    s_branch L_gs_143
L_gsd_144:
    s_mov_b64 exec, -1
    s_barrier
    s_mul_i32 s29, s26, 10240
    s_add_u32 s30, s29, 4194304
    s_mov_b32 s28, 0
    s_mov_b32 s36, 0
    s_add_u32 m0, s29, 0
    s_add_u32 s34, s30, 0
    buffer_load_dwordx4 v2, s[4:7], s34 offen offset:0 sc1 lds
    buffer_load_dwordx4 v2, s[4:7], s34 offen offset:1024 sc1 lds
    buffer_load_dwordx4 v2, s[4:7], s34 offen offset:2048 sc1 lds
    buffer_load_dwordx4 v2, s[4:7], s34 offen offset:3072 sc1 lds
    s_add_u32 m0, s29, 4096
    s_add_u32 s34, s30, 4096
    buffer_load_dwordx4 v2, s[4:7], s34 offen offset:0 sc1 lds
    buffer_load_dwordx4 v2, s[4:7], s34 offen offset:1024 sc1 lds
    buffer_load_dwordx4 v2, s[4:7], s34 offen offset:2048 sc1 lds
    buffer_load_dwordx4 v2, s[4:7], s34 offen offset:3072 sc1 lds
    s_add_u32 m0, s29, 8192
    s_add_u32 s34, s30, 8192
    buffer_load_dwordx4 v2, s[4:7], s34 offen offset:0 sc1 lds
    buffer_load_dwordx4 v2, s[4:7], s34 offen offset:1024 sc1 lds
    s_add_u32 s30, s30, 40960
    s_add_u32 s29, s29, 40960
    s_sub_u32 s34, s29, 122880
    s_cselect_b32 s29, s29, s34
    s_add_u32 m0, s29, 0
    s_add_u32 s34, s30, 0
    buffer_load_dwordx4 v2, s[4:7], s34 offen offset:0 sc1 lds
    buffer_load_dwordx4 v2, s[4:7], s34 offen offset:1024 sc1 lds
    buffer_load_dwordx4 v2, s[4:7], s34 offen offset:2048 sc1 lds
    buffer_load_dwordx4 v2, s[4:7], s34 offen offset:3072 sc1 lds
    s_add_u32 m0, s29, 4096
    s_add_u32 s34, s30, 4096
    buffer_load_dwordx4 v2, s[4:7], s34 offen offset:0 sc1 lds
    buffer_load_dwordx4 v2, s[4:7], s34 offen offset:1024 sc1 lds
    buffer_load_dwordx4 v2, s[4:7], s34 offen offset:2048 sc1 lds
    buffer_load_dwordx4 v2, s[4:7], s34 offen offset:3072 sc1 lds
    s_add_u32 m0, s29, 8192
    s_add_u32 s34, s30, 8192
    buffer_load_dwordx4 v2, s[4:7], s34 offen offset:0 sc1 lds
    buffer_load_dwordx4 v2, s[4:7], s34 offen offset:1024 sc1 lds
    s_add_u32 s30, s30, 40960
    s_add_u32 s29, s29, 40960
    s_sub_u32 s34, s29, 122880
    s_cselect_b32 s29, s29, s34
    s_lshl_b32 s32, s25, 13
    s_lshl_b32 s34, s26, 11
    s_add_u32 s32, s32, s34
    s_add_u32 s32, s32, 16777216
    s_waitcnt vmcnt(10)
L_kv_145:
    s_cmp_lg_u32 s28, 4
    s_cbranch_scc1 L_kve_147
    v_mbcnt_lo_u32_b32 v4, -1, 0
    v_lshlrev_b32 v4, 2, v4
    s_mov_b64 exec, 8
L_gs_148:
    global_load_dword v5, v4, s[96:97] offset:128 sc1
    s_waitcnt vmcnt(0)
    v_cmp_eq_u32 vcc, 0, v5
    s_cbranch_vccz L_gsd_149
    s_sleep 2
    s_sub_u32 s31, s31, 1
    s_cbranch_scc1 L_exit
    s_branch L_gs_148
L_gsd_149:
    s_mov_b64 exec, -1
L_kve_147:
    s_barrier
    v_add_u32 v3, s36, v2
    ds_read_b128 v[32:35], v3 offset:0
    ds_read_b128 v[36:39], v3 offset:1024
    ds_read_b128 v[40:43], v3 offset:2048
    ds_read_b128 v[44:47], v3 offset:3072
    ds_read_b128 v[48:51], v3 offset:4096
    s_add_u32 s36, s36, 40960
    s_cmp_eq_u32 s36, 122880
    s_cselect_b32 s36, 0, s36
    ds_read_b128 v[52:55], v3 offset:5120
    s_waitcnt lgkmcnt(5)
    v_mfma_f32_32x32x16_bf16 v[16:31], a[0:3], v[32:35], 0
    s_add_u32 m0, s29, 0
    s_add_u32 s34, s30, 0
    buffer_load_dwordx4 v2, s[4:7], s34 offen offset:0 sc1 lds
    ds_read_b128 v[56:59], v3 offset:6144
    s_waitcnt lgkmcnt(5)
    v_mfma_f32_32x32x16_bf16 v[16:31], a[4:7], v[36:39], v[16:31]
    ds_read_b128 v[32:35], v3 offset:7168
    s_waitcnt lgkmcnt(5)
    v_mfma_f32_32x32x16_bf16 v[16:31], a[8:11], v[40:43], v[16:31]
    ds_read_b128 v[36:39], v3 offset:8192
    s_waitcnt lgkmcnt(5)
    v_mfma_f32_32x32x16_bf16 v[16:31], a[12:15], v[44:47], v[16:31]
    buffer_load_dwordx4 v2, s[4:7], s34 offen offset:1024 sc1 lds
    ds_read_b128 v[40:43], v3 offset:9216
    s_waitcnt lgkmcnt(5)
    v_mfma_f32_32x32x16_bf16 v[16:31], a[16:19], v[48:51], v[16:31]
    ds_read_b128 v[44:47], v3 offset:10240
    s_waitcnt lgkmcnt(5)
    v_mfma_f32_32x32x16_bf16 v[16:31], a[20:23], v[52:55], v[16:31]
    ds_read_b128 v[48:51], v3 offset:11264
    s_waitcnt lgkmcnt(5)
    v_mfma_f32_32x32x16_bf16 v[16:31], a[24:27], v[56:59], v[16:31]
    buffer_load_dwordx4 v2, s[4:7], s34 offen offset:2048 sc1 lds
    ds_read_b128 v[52:55], v3 offset:12288
    s_waitcnt lgkmcnt(5)
    v_mfma_f32_32x32x16_bf16 v[16:31], a[28:31], v[32:35], v[16:31]
    ds_read_b128 v[56:59], v3 offset:13312
    s_waitcnt lgkmcnt(5)
    v_mfma_f32_32x32x16_bf16 v[16:31], a[32:35], v[36:39], v[16:31]
    ds_read_b128 v[32:35], v3 offset:14336
    s_waitcnt lgkmcnt(5)
    v_mfma_f32_32x32x16_bf16 v[16:31], a[36:39], v[40:43], v[16:31]
    buffer_load_dwordx4 v2, s[4:7], s34 offen offset:3072 sc1 lds
    ds_read_b128 v[36:39], v3 offset:15360
    s_waitcnt lgkmcnt(5)
    v_mfma_f32_32x32x16_bf16 v[16:31], a[40:43], v[44:47], v[16:31]
    ds_read_b128 v[40:43], v3 offset:16384
    s_waitcnt lgkmcnt(5)
    v_mfma_f32_32x32x16_bf16 v[16:31], a[44:47], v[48:51], v[16:31]
    ds_read_b128 v[44:47], v3 offset:17408
    s_waitcnt lgkmcnt(5)
    v_mfma_f32_32x32x16_bf16 v[16:31], a[48:51], v[52:55], v[16:31]
    s_add_u32 m0, s29, 4096
    s_add_u32 s34, s30, 4096
    buffer_load_dwordx4 v2, s[4:7], s34 offen offset:0 sc1 lds
    ds_read_b128 v[48:51], v3 offset:18432
    s_waitcnt lgkmcnt(5)
    v_mfma_f32_32x32x16_bf16 v[16:31], a[52:55], v[56:59], v[16:31]
    ds_read_b128 v[52:55], v3 offset:19456
    s_waitcnt lgkmcnt(5)
    v_mfma_f32_32x32x16_bf16 v[16:31], a[56:59], v[32:35], v[16:31]
    ds_read_b128 v[56:59], v3 offset:20480
    s_waitcnt lgkmcnt(5)
    v_mfma_f32_32x32x16_bf16 v[16:31], a[60:63], v[36:39], v[16:31]
    buffer_load_dwordx4 v2, s[4:7], s34 offen offset:1024 sc1 lds
    ds_read_b128 v[32:35], v3 offset:21504
    s_waitcnt lgkmcnt(5)
    v_mfma_f32_32x32x16_bf16 v[16:31], a[64:67], v[40:43], v[16:31]
    ds_read_b128 v[36:39], v3 offset:22528
    s_waitcnt lgkmcnt(5)
    v_mfma_f32_32x32x16_bf16 v[16:31], a[68:71], v[44:47], v[16:31]
    ds_read_b128 v[40:43], v3 offset:23552
    s_waitcnt lgkmcnt(5)
    v_mfma_f32_32x32x16_bf16 v[16:31], a[72:75], v[48:51], v[16:31]
    buffer_load_dwordx4 v2, s[4:7], s34 offen offset:2048 sc1 lds
    ds_read_b128 v[44:47], v3 offset:24576
    s_waitcnt lgkmcnt(5)
    v_mfma_f32_32x32x16_bf16 v[16:31], a[76:79], v[52:55], v[16:31]
    ds_read_b128 v[48:51], v3 offset:25600
    s_waitcnt lgkmcnt(5)
    v_mfma_f32_32x32x16_bf16 v[16:31], a[80:83], v[56:59], v[16:31]
    ds_read_b128 v[52:55], v3 offset:26624
    s_waitcnt lgkmcnt(5)
    v_mfma_f32_32x32x16_bf16 v[16:31], a[84:87], v[32:35], v[16:31]
    s_waitcnt vmcnt(7)
    s_barrier
    s_cmp_lg_u32 s26, 0
    s_cbranch_scc1 L_kvn_146
    s_mov_b64 exec, 1
    v_mov_b32 v1, s28
    buffer_store_dword v1, off, s[4:7], s33 sc1
    s_mov_b64 exec, -1
L_kvn_146:
    ds_read_b128 v[56:59], v3 offset:27648
    s_waitcnt lgkmcnt(5)
    v_mfma_f32_32x32x16_bf16 v[16:31], a[88:91], v[36:39], v[16:31]
    ds_read_b128 v[32:35], v3 offset:28672
    s_waitcnt lgkmcnt(5)
    v_mfma_f32_32x32x16_bf16 v[16:31], a[92:95], v[40:43], v[16:31]
    ds_read_b128 v[36:39], v3 offset:29696
    s_waitcnt lgkmcnt(5)
    v_mfma_f32_32x32x16_bf16 v[16:31], a[96:99], v[44:47], v[16:31]
    buffer_load_dwordx4 v2, s[4:7], s34 offen offset:3072 sc1 lds
    ds_read_b128 v[40:43], v3 offset:30720
    s_waitcnt lgkmcnt(5)
    v_mfma_f32_32x32x16_bf16 v[16:31], a[100:103], v[48:51], v[16:31]
    ds_read_b128 v[44:47], v3 offset:31744
    s_waitcnt lgkmcnt(5)
    v_mfma_f32_32x32x16_bf16 v[16:31], a[104:107], v[52:55], v[16:31]
    ds_read_b128 v[48:51], v3 offset:32768
    s_waitcnt lgkmcnt(5)
    v_mfma_f32_32x32x16_bf16 v[16:31], a[108:111], v[56:59], v[16:31]
    s_add_u32 m0, s29, 8192
    s_add_u32 s34, s30, 8192
    buffer_load_dwordx4 v2, s[4:7], s34 offen offset:0 sc1 lds
    ds_read_b128 v[52:55], v3 offset:33792
    s_waitcnt lgkmcnt(5)
    v_mfma_f32_32x32x16_bf16 v[16:31], a[112:115], v[32:35], v[16:31]
    ds_read_b128 v[56:59], v3 offset:34816
    s_waitcnt lgkmcnt(5)
    v_mfma_f32_32x32x16_bf16 v[16:31], a[116:119], v[36:39], v[16:31]
    ds_read_b128 v[32:35], v3 offset:35840
    s_waitcnt lgkmcnt(5)
    v_mfma_f32_32x32x16_bf16 v[16:31], a[120:123], v[40:43], v[16:31]
    buffer_load_dwordx4 v2, s[4:7], s34 offen offset:1024 sc1 lds
    ds_read_b128 v[36:39], v3 offset:36864
    s_waitcnt lgkmcnt(5)
    v_mfma_f32_32x32x16_bf16 v[16:31], a[124:127], v[44:47], v[16:31]
    ds_read_b128 v[40:43], v3 offset:37888
    s_waitcnt lgkmcnt(5)
    v_mfma_f32_32x32x16_bf16 v[16:31], a[128:131], v[48:51], v[16:31]
    ds_read_b128 v[44:47], v3 offset:38912
    s_waitcnt lgkmcnt(5)
    v_mfma_f32_32x32x16_bf16 v[16:31], a[132:135], v[52:55], v[16:31]
    s_add_u32 s30, s30, 40960
    s_add_u32 s29, s29, 40960
    s_sub_u32 s34, s29, 122880
    s_cselect_b32 s29, s29, s34
    ds_read_b128 v[48:51], v3 offset:39936
    s_waitcnt lgkmcnt(5)
    v_mfma_f32_32x32x16_bf16 v[16:31], a[136:139], v[56:59], v[16:31]
    s_waitcnt lgkmcnt(4)
    v_mfma_f32_32x32x16_bf16 v[16:31], a[140:143], v[32:35], v[16:31]
    s_waitcnt lgkmcnt(3)
    v_mfma_f32_32x32x16_bf16 v[16:31], a[144:147], v[36:39], v[16:31]
    s_waitcnt lgkmcnt(2)
    v_mfma_f32_32x32x16_bf16 v[16:31], a[148:151], v[40:43], v[16:31]
    s_waitcnt lgkmcnt(1)
    v_mfma_f32_32x32x16_bf16 v[16:31], a[152:155], v[44:47], v[16:31]
    s_waitcnt lgkmcnt(0)
    v_mfma_f32_32x32x16_bf16 v[16:31], a[156:159], v[48:51], v[16:31]
    s_nop 11
    v_cvt_pk_bf16_f32 v8, v16, v17
    v_cvt_pk_bf16_f32 v9, v18, v19
    v_cvt_pk_bf16_f32 v10, v20, v21
    v_cvt_pk_bf16_f32 v11, v22, v23
    v_cvt_pk_bf16_f32 v12, v24, v25
    v_cvt_pk_bf16_f32 v13, v26, v27
    v_cvt_pk_bf16_f32 v14, v28, v29
    v_cvt_pk_bf16_f32 v15, v30, v31
    buffer_store_dwordx4 v[8:11], v2, s[4:7], s32 offen sc1
    buffer_store_dwordx4 v[12:15], v2, s[4:7], s32 offen offset:1024 sc1
    s_add_u32 s32, s32, 262144
    s_add_u32 s28, s28, 1
    s_cmp_lt_u32 s28, 64
    s_cbranch_scc1 L_kv_145
    s_waitcnt vmcnt(0)
    s_barrier
    s_mov_b64 exec, 1
    v_mov_b32 v1, 64
    buffer_store_dword v1, off, s[4:7], s33 sc1
    s_mov_b64 exec, -1
    s_mov_b32 s27, 3
    s_branch L_join
L_v:
    s_lshl_b32 s33, s25, 8
    s_add_u32 s33, s33, 3547136
    s_load_dwordx2 s[8:9], s[0:1], 32
    v_and_b32 v1, 63, v0
    v_lshlrev_b32 v2, 4, v1
    v_and_b32 v4, 15, v1
    v_lshrrev_b32 v5, 4, v1
    v_lshlrev_b32 v6, 2, v5
    v_xor_b32 v6, v6, v4
    v_lshlrev_b32 v6, 4, v6
    v_lshl_add_u32 v6, v5, 13, v6
    s_lshl_b32 s34, s25, 8
    s_lshl_b32 s35, s26, 17
    s_add_u32 s34, s34, s35
    v_add_u32 v6, s34, v6
    s_lshl_b32 s35, s26, 12
    s_waitcnt lgkmcnt(0)
    s_mov_b32 s10, 5242880
    s_mov_b32 s11, 0x20000
    s_add_u32 m0, s35, 0
    s_mov_b32 s34, 0
    buffer_load_dwordx4 v6, s[8:11], s34 offen offset:0 lds
    s_mov_b32 s34, 31744
    buffer_load_dwordx4 v6, s[8:11], s34 offen offset:1024 lds
    s_mov_b32 s34, 63488
    buffer_load_dwordx4 v6, s[8:11], s34 offen offset:2048 lds
    s_mov_b32 s34, 95232
    buffer_load_dwordx4 v6, s[8:11], s34 offen offset:3072 lds
    s_add_u32 m0, s35, 16384
    s_mov_b32 s34, 524288
    buffer_load_dwordx4 v6, s[8:11], s34 offen offset:0 lds
    s_mov_b32 s34, 556032
    buffer_load_dwordx4 v6, s[8:11], s34 offen offset:1024 lds
    s_mov_b32 s34, 587776
    buffer_load_dwordx4 v6, s[8:11], s34 offen offset:2048 lds
    s_mov_b32 s34, 619520
    buffer_load_dwordx4 v6, s[8:11], s34 offen offset:3072 lds
    s_add_u32 m0, s35, 32768
    s_mov_b32 s34, 1048576
    buffer_load_dwordx4 v6, s[8:11], s34 offen offset:0 lds
    s_mov_b32 s34, 1080320
    buffer_load_dwordx4 v6, s[8:11], s34 offen offset:1024 lds
    s_mov_b32 s34, 1112064
    buffer_load_dwordx4 v6, s[8:11], s34 offen offset:2048 lds
    s_mov_b32 s34, 1143808
    buffer_load_dwordx4 v6, s[8:11], s34 offen offset:3072 lds
    s_add_u32 m0, s35, 49152
    s_mov_b32 s34, 1572864
    buffer_load_dwordx4 v6, s[8:11], s34 offen offset:0 lds
    s_mov_b32 s34, 1604608
    buffer_load_dwordx4 v6, s[8:11], s34 offen offset:1024 lds
    s_mov_b32 s34, 1636352
    buffer_load_dwordx4 v6, s[8:11], s34 offen offset:2048 lds
    s_mov_b32 s34, 1668096
    buffer_load_dwordx4 v6, s[8:11], s34 offen offset:3072 lds
    s_add_u32 m0, s35, 65536
    s_mov_b32 s34, 2097152
    buffer_load_dwordx4 v6, s[8:11], s34 offen offset:0 lds
    s_mov_b32 s34, 2128896
    buffer_load_dwordx4 v6, s[8:11], s34 offen offset:1024 lds
    s_mov_b32 s34, 2160640
    buffer_load_dwordx4 v6, s[8:11], s34 offen offset:2048 lds
    s_mov_b32 s34, 2192384
    buffer_load_dwordx4 v6, s[8:11], s34 offen offset:3072 lds
    s_add_u32 m0, s35, 81920
    s_mov_b32 s34, 2621440
    buffer_load_dwordx4 v6, s[8:11], s34 offen offset:0 lds
    s_mov_b32 s34, 2653184
    buffer_load_dwordx4 v6, s[8:11], s34 offen offset:1024 lds
    s_mov_b32 s34, 2684928
    buffer_load_dwordx4 v6, s[8:11], s34 offen offset:2048 lds
    s_mov_b32 s34, 2716672
    buffer_load_dwordx4 v6, s[8:11], s34 offen offset:3072 lds
    s_add_u32 m0, s35, 98304
    s_mov_b32 s34, 3145728
    buffer_load_dwordx4 v6, s[8:11], s34 offen offset:0 lds
    s_mov_b32 s34, 3177472
    buffer_load_dwordx4 v6, s[8:11], s34 offen offset:1024 lds
    s_mov_b32 s34, 3209216
    buffer_load_dwordx4 v6, s[8:11], s34 offen offset:2048 lds
    s_mov_b32 s34, 3240960
    buffer_load_dwordx4 v6, s[8:11], s34 offen offset:3072 lds
    s_add_u32 m0, s35, 114688
    s_mov_b32 s34, 3670016
    buffer_load_dwordx4 v6, s[8:11], s34 offen offset:0 lds
    s_mov_b32 s34, 3701760
    buffer_load_dwordx4 v6, s[8:11], s34 offen offset:1024 lds
    s_mov_b32 s34, 3733504
    buffer_load_dwordx4 v6, s[8:11], s34 offen offset:2048 lds
    s_mov_b32 s34, 3765248
    buffer_load_dwordx4 v6, s[8:11], s34 offen offset:3072 lds
    s_add_u32 m0, s35, 131072
    s_mov_b32 s34, 4194304
    buffer_load_dwordx4 v6, s[8:11], s34 offen offset:0 lds
    s_mov_b32 s34, 4226048
    buffer_load_dwordx4 v6, s[8:11], s34 offen offset:1024 lds
    s_mov_b32 s34, 4257792
    buffer_load_dwordx4 v6, s[8:11], s34 offen offset:2048 lds
    s_mov_b32 s34, 4289536
    buffer_load_dwordx4 v6, s[8:11], s34 offen offset:3072 lds
    s_add_u32 m0, s35, 147456
    s_mov_b32 s34, 4718592
    buffer_load_dwordx4 v6, s[8:11], s34 offen offset:0 lds
    s_mov_b32 s34, 4750336
    buffer_load_dwordx4 v6, s[8:11], s34 offen offset:1024 lds
    s_mov_b32 s34, 4782080
    buffer_load_dwordx4 v6, s[8:11], s34 offen offset:2048 lds
    s_mov_b32 s34, 4813824
    buffer_load_dwordx4 v6, s[8:11], s34 offen offset:3072 lds
    v_bfe_u32 v7, v1, 2, 2
    v_and_b32 v8, 3, v1
    v_and_b32 v9, 1, v5
    v_lshrrev_b32 v10, 1, v5
    v_mov_b32 v11, v8
    v_mov_b32 v12, v9
    v_xor_b32 v13, s26, v7
    v_lshl_add_u32 v11, v13, 2, v11
    v_lshlrev_b32 v11, 4, v11
    v_lshl_add_u32 v11, v12, 3, v11
    v_lshl_add_u32 v11, v7, 8, v11
    v_lshl_add_u32 v11, v10, 11, v11
    s_waitcnt vmcnt(36)
    s_barrier
    v_add_u32 v12, 0, v11
    ds_read_b64_tr_b16 a[0:1], v12 offset:0
    ds_read_b64_tr_b16 a[2:3], v12 offset:1024
    ds_read_b64_tr_b16 a[4:5], v12 offset:4096
    ds_read_b64_tr_b16 a[6:7], v12 offset:5120
    ds_read_b64_tr_b16 a[8:9], v12 offset:8192
    ds_read_b64_tr_b16 a[10:11], v12 offset:9216
    ds_read_b64_tr_b16 a[12:13], v12 offset:12288
    ds_read_b64_tr_b16 a[14:15], v12 offset:13312
    s_waitcnt lgkmcnt(0)
    s_waitcnt vmcnt(32)
    s_barrier
    v_add_u32 v12, 16384, v11
    ds_read_b64_tr_b16 a[16:17], v12 offset:0
    ds_read_b64_tr_b16 a[18:19], v12 offset:1024
    ds_read_b64_tr_b16 a[20:21], v12 offset:4096
    ds_read_b64_tr_b16 a[22:23], v12 offset:5120
    ds_read_b64_tr_b16 a[24:25], v12 offset:8192
    ds_read_b64_tr_b16 a[26:27], v12 offset:9216
    ds_read_b64_tr_b16 a[28:29], v12 offset:12288
    ds_read_b64_tr_b16 a[30:31], v12 offset:13312
    s_waitcnt lgkmcnt(0)
    s_waitcnt vmcnt(28)
    s_barrier
    v_add_u32 v12, 32768, v11
    ds_read_b64_tr_b16 a[32:33], v12 offset:0
    ds_read_b64_tr_b16 a[34:35], v12 offset:1024
    ds_read_b64_tr_b16 a[36:37], v12 offset:4096
    ds_read_b64_tr_b16 a[38:39], v12 offset:5120
    ds_read_b64_tr_b16 a[40:41], v12 offset:8192
    ds_read_b64_tr_b16 a[42:43], v12 offset:9216
    ds_read_b64_tr_b16 a[44:45], v12 offset:12288
    ds_read_b64_tr_b16 a[46:47], v12 offset:13312
    s_waitcnt lgkmcnt(0)
    s_waitcnt vmcnt(24)
    s_barrier
    v_add_u32 v12, 49152, v11
    ds_read_b64_tr_b16 a[48:49], v12 offset:0
    ds_read_b64_tr_b16 a[50:51], v12 offset:1024
    ds_read_b64_tr_b16 a[52:53], v12 offset:4096
    ds_read_b64_tr_b16 a[54:55], v12 offset:5120
    ds_read_b64_tr_b16 a[56:57], v12 offset:8192
    ds_read_b64_tr_b16 a[58:59], v12 offset:9216
    ds_read_b64_tr_b16 a[60:61], v12 offset:12288
    ds_read_b64_tr_b16 a[62:63], v12 offset:13312
    s_waitcnt lgkmcnt(0)
    s_waitcnt vmcnt(20)
    s_barrier
    v_add_u32 v12, 65536, v11
    ds_read_b64_tr_b16 a[64:65], v12 offset:0
    ds_read_b64_tr_b16 a[66:67], v12 offset:1024
    ds_read_b64_tr_b16 a[68:69], v12 offset:4096
    ds_read_b64_tr_b16 a[70:71], v12 offset:5120
    ds_read_b64_tr_b16 a[72:73], v12 offset:8192
    ds_read_b64_tr_b16 a[74:75], v12 offset:9216
    ds_read_b64_tr_b16 a[76:77], v12 offset:12288
    ds_read_b64_tr_b16 a[78:79], v12 offset:13312
    s_waitcnt lgkmcnt(0)
    s_waitcnt vmcnt(16)
    s_barrier
    v_add_u32 v12, 81920, v11
    ds_read_b64_tr_b16 a[80:81], v12 offset:0
    ds_read_b64_tr_b16 a[82:83], v12 offset:1024
    ds_read_b64_tr_b16 a[84:85], v12 offset:4096
    ds_read_b64_tr_b16 a[86:87], v12 offset:5120
    ds_read_b64_tr_b16 a[88:89], v12 offset:8192
    ds_read_b64_tr_b16 a[90:91], v12 offset:9216
    ds_read_b64_tr_b16 a[92:93], v12 offset:12288
    ds_read_b64_tr_b16 a[94:95], v12 offset:13312
    s_waitcnt lgkmcnt(0)
    s_waitcnt vmcnt(12)
    s_barrier
    v_add_u32 v12, 98304, v11
    ds_read_b64_tr_b16 a[96:97], v12 offset:0
    ds_read_b64_tr_b16 a[98:99], v12 offset:1024
    ds_read_b64_tr_b16 a[100:101], v12 offset:4096
    ds_read_b64_tr_b16 a[102:103], v12 offset:5120
    ds_read_b64_tr_b16 a[104:105], v12 offset:8192
    ds_read_b64_tr_b16 a[106:107], v12 offset:9216
    ds_read_b64_tr_b16 a[108:109], v12 offset:12288
    ds_read_b64_tr_b16 a[110:111], v12 offset:13312
    s_waitcnt lgkmcnt(0)
    s_waitcnt vmcnt(8)
    s_barrier
    v_add_u32 v12, 114688, v11
    ds_read_b64_tr_b16 a[112:113], v12 offset:0
    ds_read_b64_tr_b16 a[114:115], v12 offset:1024
    ds_read_b64_tr_b16 a[116:117], v12 offset:4096
    ds_read_b64_tr_b16 a[118:119], v12 offset:5120
    ds_read_b64_tr_b16 a[120:121], v12 offset:8192
    ds_read_b64_tr_b16 a[122:123], v12 offset:9216
    ds_read_b64_tr_b16 a[124:125], v12 offset:12288
    ds_read_b64_tr_b16 a[126:127], v12 offset:13312
    s_waitcnt lgkmcnt(0)
    s_or_b32 s99, s26, s98
    s_cbranch_scc1 L_ci_150
    s_lshl_b32 s99, s24, 2
    s_lshl_b32 s95, 1, s25
    s_atomic_or s95, s[96:97], s99 glc
L_ci_150:
    s_waitcnt vmcnt(4)
    s_barrier
    v_add_u32 v12, 131072, v11
    ds_read_b64_tr_b16 a[128:129], v12 offset:0
    ds_read_b64_tr_b16 a[130:131], v12 offset:1024
    ds_read_b64_tr_b16 a[132:133], v12 offset:4096
    ds_read_b64_tr_b16 a[134:135], v12 offset:5120
    ds_read_b64_tr_b16 a[136:137], v12 offset:8192
    ds_read_b64_tr_b16 a[138:139], v12 offset:9216
    ds_read_b64_tr_b16 a[140:141], v12 offset:12288
    ds_read_b64_tr_b16 a[142:143], v12 offset:13312
    s_waitcnt lgkmcnt(0)
    s_waitcnt vmcnt(0)
    s_barrier
    v_add_u32 v12, 147456, v11
    ds_read_b64_tr_b16 a[144:145], v12 offset:0
    ds_read_b64_tr_b16 a[146:147], v12 offset:1024
    ds_read_b64_tr_b16 a[148:149], v12 offset:4096
    ds_read_b64_tr_b16 a[150:151], v12 offset:5120
    ds_read_b64_tr_b16 a[152:153], v12 offset:8192
    ds_read_b64_tr_b16 a[154:155], v12 offset:9216
    ds_read_b64_tr_b16 a[156:157], v12 offset:12288
    ds_read_b64_tr_b16 a[158:159], v12 offset:13312
    s_waitcnt lgkmcnt(0)
    s_cmp_lg_u32 s98, 0
    s_cbranch_scc1 L_cc_151
    v_mov_b32 v254, 0
    s_cmp_lg_u32 s26, 0
    s_cbranch_scc1 L_ccw_152
    s_waitcnt lgkmcnt(0)
    v_mov_b32 v255, s95
    ds_write_b32 v254, v255
    s_waitcnt lgkmcnt(0)
L_ccw_152:
    s_barrier
    ds_read_b32 v255, v254
    s_waitcnt lgkmcnt(0)
    v_readfirstlane_b32 s99, v255
    s_barrier
    s_bitcmp1_b32 s99, s25
    s_cbranch_scc1 L_reclaim
L_cc_151:
    v_mbcnt_lo_u32_b32 v4, -1, 0
    v_lshlrev_b32 v4, 2, v4
    s_mov_b64 exec, 384
L_gs_153:
    global_load_dword v5, v4, s[96:97] offset:128 sc1
    s_waitcnt vmcnt(0)
    v_cmp_eq_u32 vcc, 0, v5
    s_cbranch_vccz L_gsd_154
    s_sleep 2
    s_sub_u32 s31, s31, 1
    s_cbranch_scc1 L_exit
    s_branch L_gs_153
L_gsd_154:
    s_mov_b64 exec, -1
    s_barrier
    s_mul_i32 s29, s26, 10240
    s_add_u32 s30, s29, 4194304
    s_mov_b32 s28, 0
    s_mov_b32 s36, 0
    s_add_u32 m0, s29, 0
    s_add_u32 s34, s30, 0
    buffer_load_dwordx4 v2, s[4:7], s34 offen offset:0 sc1 lds
    buffer_load_dwordx4 v2, s[4:7], s34 offen offset:1024 sc1 lds
    buffer_load_dwordx4 v2, s[4:7], s34 offen offset:2048 sc1 lds
    buffer_load_dwordx4 v2, s[4:7], s34 offen offset:3072 sc1 lds
    s_add_u32 m0, s29, 4096
    s_add_u32 s34, s30, 4096
    buffer_load_dwordx4 v2, s[4:7], s34 offen offset:0 sc1 lds
    buffer_load_dwordx4 v2, s[4:7], s34 offen offset:1024 sc1 lds
    buffer_load_dwordx4 v2, s[4:7], s34 offen offset:2048 sc1 lds
    buffer_load_dwordx4 v2, s[4:7], s34 offen offset:3072 sc1 lds
    s_add_u32 m0, s29, 8192
    s_add_u32 s34, s30, 8192
    buffer_load_dwordx4 v2, s[4:7], s34 offen offset:0 sc1 lds
    buffer_load_dwordx4 v2, s[4:7], s34 offen offset:1024 sc1 lds
    s_add_u32 s30, s30, 40960
    s_add_u32 s29, s29, 40960
    s_sub_u32 s34, s29, 122880
    s_cselect_b32 s29, s29, s34
    s_add_u32 m0, s29, 0
    s_add_u32 s34, s30, 0
    buffer_load_dwordx4 v2, s[4:7], s34 offen offset:0 sc1 lds
    buffer_load_dwordx4 v2, s[4:7], s34 offen offset:1024 sc1 lds
    buffer_load_dwordx4 v2, s[4:7], s34 offen offset:2048 sc1 lds
    buffer_load_dwordx4 v2, s[4:7], s34 offen offset:3072 sc1 lds
    s_add_u32 m0, s29, 4096
    s_add_u32 s34, s30, 4096
    buffer_load_dwordx4 v2, s[4:7], s34 offen offset:0 sc1 lds
    buffer_load_dwordx4 v2, s[4:7], s34 offen offset:1024 sc1 lds
    buffer_load_dwordx4 v2, s[4:7], s34 offen offset:2048 sc1 lds
    buffer_load_dwordx4 v2, s[4:7], s34 offen offset:3072 sc1 lds
    s_add_u32 m0, s29, 8192
    s_add_u32 s34, s30, 8192
    buffer_load_dwordx4 v2, s[4:7], s34 offen offset:0 sc1 lds
    buffer_load_dwordx4 v2, s[4:7], s34 offen offset:1024 sc1 lds
    s_add_u32 s30, s30, 40960
    s_add_u32 s29, s29, 40960
    s_sub_u32 s34, s29, 122880
    s_cselect_b32 s29, s29, s34
    s_lshl_b32 s32, s25, 13
    s_lshl_b32 s34, s26, 11
    s_add_u32 s32, s32, s34
    s_add_u32 s32, s32, 33554432
    s_waitcnt vmcnt(10)
L_kv_155:
    s_cmp_lg_u32 s28, 4
    s_cbranch_scc1 L_kve_157
    v_mbcnt_lo_u32_b32 v4, -1, 0
    v_lshlrev_b32 v4, 2, v4
    s_mov_b64 exec, 8
L_gs_158:
    global_load_dword v5, v4, s[96:97] offset:128 sc1
    s_waitcnt vmcnt(0)
    v_cmp_eq_u32 vcc, 0, v5
    s_cbranch_vccz L_gsd_159
    s_sleep 2
    s_sub_u32 s31, s31, 1
    s_cbranch_scc1 L_exit
    s_branch L_gs_158
L_gsd_159:
    s_mov_b64 exec, -1
L_kve_157:
    s_barrier
    v_add_u32 v3, s36, v2
    ds_read_b128 v[32:35], v3 offset:0
    ds_read_b128 v[36:39], v3 offset:1024
    ds_read_b128 v[40:43], v3 offset:2048
    ds_read_b128 v[44:47], v3 offset:3072
    ds_read_b128 v[48:51], v3 offset:4096
    s_add_u32 s36, s36, 40960
    s_cmp_eq_u32 s36, 122880
    s_cselect_b32 s36, 0, s36
    ds_read_b128 v[52:55], v3 offset:5120
    s_waitcnt lgkmcnt(5)
    v_mfma_f32_32x32x16_bf16 v[16:31], v[32:35], a[0:3], 0
    s_add_u32 m0, s29, 0
    s_add_u32 s34, s30, 0
    buffer_load_dwordx4 v2, s[4:7], s34 offen offset:0 sc1 lds
    ds_read_b128 v[56:59], v3 offset:6144
    s_waitcnt lgkmcnt(5)
    v_mfma_f32_32x32x16_bf16 v[16:31], v[36:39], a[4:7], v[16:31]
    ds_read_b128 v[32:35], v3 offset:7168
    s_waitcnt lgkmcnt(5)
    v_mfma_f32_32x32x16_bf16 v[16:31], v[40:43], a[8:11], v[16:31]
    ds_read_b128 v[36:39], v3 offset:8192
    s_waitcnt lgkmcnt(5)
    v_mfma_f32_32x32x16_bf16 v[16:31], v[44:47], a[12:15], v[16:31]
    buffer_load_dwordx4 v2, s[4:7], s34 offen offset:1024 sc1 lds
    ds_read_b128 v[40:43], v3 offset:9216
    s_waitcnt lgkmcnt(5)
    v_mfma_f32_32x32x16_bf16 v[16:31], v[48:51], a[16:19], v[16:31]
    ds_read_b128 v[44:47], v3 offset:10240
    s_waitcnt lgkmcnt(5)
    v_mfma_f32_32x32x16_bf16 v[16:31], v[52:55], a[20:23], v[16:31]
    ds_read_b128 v[48:51], v3 offset:11264
    s_waitcnt lgkmcnt(5)
    v_mfma_f32_32x32x16_bf16 v[16:31], v[56:59], a[24:27], v[16:31]
    buffer_load_dwordx4 v2, s[4:7], s34 offen offset:2048 sc1 lds
    ds_read_b128 v[52:55], v3 offset:12288
    s_waitcnt lgkmcnt(5)
    v_mfma_f32_32x32x16_bf16 v[16:31], v[32:35], a[28:31], v[16:31]
    ds_read_b128 v[56:59], v3 offset:13312
    s_waitcnt lgkmcnt(5)
    v_mfma_f32_32x32x16_bf16 v[16:31], v[36:39], a[32:35], v[16:31]
    ds_read_b128 v[32:35], v3 offset:14336
    s_waitcnt lgkmcnt(5)
    v_mfma_f32_32x32x16_bf16 v[16:31], v[40:43], a[36:39], v[16:31]
    buffer_load_dwordx4 v2, s[4:7], s34 offen offset:3072 sc1 lds
    ds_read_b128 v[36:39], v3 offset:15360
    s_waitcnt lgkmcnt(5)
    v_mfma_f32_32x32x16_bf16 v[16:31], v[44:47], a[40:43], v[16:31]
    ds_read_b128 v[40:43], v3 offset:16384
    s_waitcnt lgkmcnt(5)
    v_mfma_f32_32x32x16_bf16 v[16:31], v[48:51], a[44:47], v[16:31]
    ds_read_b128 v[44:47], v3 offset:17408
    s_waitcnt lgkmcnt(5)
    v_mfma_f32_32x32x16_bf16 v[16:31], v[52:55], a[48:51], v[16:31]
    s_add_u32 m0, s29, 4096
    s_add_u32 s34, s30, 4096
    buffer_load_dwordx4 v2, s[4:7], s34 offen offset:0 sc1 lds
    ds_read_b128 v[48:51], v3 offset:18432
    s_waitcnt lgkmcnt(5)
    v_mfma_f32_32x32x16_bf16 v[16:31], v[56:59], a[52:55], v[16:31]
    ds_read_b128 v[52:55], v3 offset:19456
    s_waitcnt lgkmcnt(5)
    v_mfma_f32_32x32x16_bf16 v[16:31], v[32:35], a[56:59], v[16:31]
    ds_read_b128 v[56:59], v3 offset:20480
    s_waitcnt lgkmcnt(5)
    v_mfma_f32_32x32x16_bf16 v[16:31], v[36:39], a[60:63], v[16:31]
    buffer_load_dwordx4 v2, s[4:7], s34 offen offset:1024 sc1 lds
    ds_read_b128 v[32:35], v3 offset:21504
    s_waitcnt lgkmcnt(5)
    v_mfma_f32_32x32x16_bf16 v[16:31], v[40:43], a[64:67], v[16:31]
    ds_read_b128 v[36:39], v3 offset:22528
    s_waitcnt lgkmcnt(5)
    v_mfma_f32_32x32x16_bf16 v[16:31], v[44:47], a[68:71], v[16:31]
    ds_read_b128 v[40:43], v3 offset:23552
    s_waitcnt lgkmcnt(5)
    v_mfma_f32_32x32x16_bf16 v[16:31], v[48:51], a[72:75], v[16:31]
    buffer_load_dwordx4 v2, s[4:7], s34 offen offset:2048 sc1 lds
    ds_read_b128 v[44:47], v3 offset:24576
    s_waitcnt lgkmcnt(5)
    v_mfma_f32_32x32x16_bf16 v[16:31], v[52:55], a[76:79], v[16:31]
    ds_read_b128 v[48:51], v3 offset:25600
    s_waitcnt lgkmcnt(5)
    v_mfma_f32_32x32x16_bf16 v[16:31], v[56:59], a[80:83], v[16:31]
    ds_read_b128 v[52:55], v3 offset:26624
    s_waitcnt lgkmcnt(5)
    v_mfma_f32_32x32x16_bf16 v[16:31], v[32:35], a[84:87], v[16:31]
    s_waitcnt vmcnt(7)
    s_barrier
    s_cmp_lg_u32 s26, 0
    s_cbranch_scc1 L_kvn_156
    s_mov_b64 exec, 1
    v_mov_b32 v1, s28
    buffer_store_dword v1, off, s[4:7], s33 sc1
    s_mov_b64 exec, -1
L_kvn_156:
    ds_read_b128 v[56:59], v3 offset:27648
    s_waitcnt lgkmcnt(5)
    v_mfma_f32_32x32x16_bf16 v[16:31], v[36:39], a[88:91], v[16:31]
    ds_read_b128 v[32:35], v3 offset:28672
    s_waitcnt lgkmcnt(5)
    v_mfma_f32_32x32x16_bf16 v[16:31], v[40:43], a[92:95], v[16:31]
    ds_read_b128 v[36:39], v3 offset:29696
    s_waitcnt lgkmcnt(5)
    v_mfma_f32_32x32x16_bf16 v[16:31], v[44:47], a[96:99], v[16:31]
    buffer_load_dwordx4 v2, s[4:7], s34 offen offset:3072 sc1 lds
    ds_read_b128 v[40:43], v3 offset:30720
    s_waitcnt lgkmcnt(5)
    v_mfma_f32_32x32x16_bf16 v[16:31], v[48:51], a[100:103], v[16:31]
    ds_read_b128 v[44:47], v3 offset:31744
    s_waitcnt lgkmcnt(5)
    v_mfma_f32_32x32x16_bf16 v[16:31], v[52:55], a[104:107], v[16:31]
    ds_read_b128 v[48:51], v3 offset:32768
    s_waitcnt lgkmcnt(5)
    v_mfma_f32_32x32x16_bf16 v[16:31], v[56:59], a[108:111], v[16:31]
    s_add_u32 m0, s29, 8192
    s_add_u32 s34, s30, 8192
    buffer_load_dwordx4 v2, s[4:7], s34 offen offset:0 sc1 lds
    ds_read_b128 v[52:55], v3 offset:33792
    s_waitcnt lgkmcnt(5)
    v_mfma_f32_32x32x16_bf16 v[16:31], v[32:35], a[112:115], v[16:31]
    ds_read_b128 v[56:59], v3 offset:34816
    s_waitcnt lgkmcnt(5)
    v_mfma_f32_32x32x16_bf16 v[16:31], v[36:39], a[116:119], v[16:31]
    ds_read_b128 v[32:35], v3 offset:35840
    s_waitcnt lgkmcnt(5)
    v_mfma_f32_32x32x16_bf16 v[16:31], v[40:43], a[120:123], v[16:31]
    buffer_load_dwordx4 v2, s[4:7], s34 offen offset:1024 sc1 lds
    ds_read_b128 v[36:39], v3 offset:36864
    s_waitcnt lgkmcnt(5)
    v_mfma_f32_32x32x16_bf16 v[16:31], v[44:47], a[124:127], v[16:31]
    ds_read_b128 v[40:43], v3 offset:37888
    s_waitcnt lgkmcnt(5)
    v_mfma_f32_32x32x16_bf16 v[16:31], v[48:51], a[128:131], v[16:31]
    ds_read_b128 v[44:47], v3 offset:38912
    s_waitcnt lgkmcnt(5)
    v_mfma_f32_32x32x16_bf16 v[16:31], v[52:55], a[132:135], v[16:31]
    s_add_u32 s30, s30, 40960
    s_add_u32 s29, s29, 40960
    s_sub_u32 s34, s29, 122880
    s_cselect_b32 s29, s29, s34
    ds_read_b128 v[48:51], v3 offset:39936
    s_waitcnt lgkmcnt(5)
    v_mfma_f32_32x32x16_bf16 v[16:31], v[56:59], a[136:139], v[16:31]
    s_waitcnt lgkmcnt(4)
    v_mfma_f32_32x32x16_bf16 v[16:31], v[32:35], a[140:143], v[16:31]
    s_waitcnt lgkmcnt(3)
    v_mfma_f32_32x32x16_bf16 v[16:31], v[36:39], a[144:147], v[16:31]
    s_waitcnt lgkmcnt(2)
    v_mfma_f32_32x32x16_bf16 v[16:31], v[40:43], a[148:151], v[16:31]
    s_waitcnt lgkmcnt(1)
    v_mfma_f32_32x32x16_bf16 v[16:31], v[44:47], a[152:155], v[16:31]
    s_waitcnt lgkmcnt(0)
    v_mfma_f32_32x32x16_bf16 v[16:31], v[48:51], a[156:159], v[16:31]
    s_nop 11
    v_cvt_pk_bf16_f32 v8, v16, v17
    v_cvt_pk_bf16_f32 v9, v18, v19
    v_cvt_pk_bf16_f32 v10, v20, v21
    v_cvt_pk_bf16_f32 v11, v22, v23
    v_cvt_pk_bf16_f32 v12, v24, v25
    v_cvt_pk_bf16_f32 v13, v26, v27
    v_cvt_pk_bf16_f32 v14, v28, v29
    v_cvt_pk_bf16_f32 v15, v30, v31
    buffer_store_dwordx4 v[8:11], v2, s[4:7], s32 offen sc1
    buffer_store_dwordx4 v[12:15], v2, s[4:7], s32 offen offset:1024 sc1
    s_add_u32 s32, s32, 262144
    s_add_u32 s28, s28, 1
    s_cmp_lt_u32 s28, 64
    s_cbranch_scc1 L_kv_155
    s_waitcnt vmcnt(0)
    s_barrier
    s_mov_b64 exec, 1
    v_mov_b32 v1, 64
    buffer_store_dword v1, off, s[4:7], s33 sc1
    s_mov_b64 exec, -1
    s_mov_b32 s27, 4
    s_branch L_join
L_qa:
    s_load_dwordx2 s[12:13], s[0:1], 8
    s_and_b32 s36, s26, 1
    s_mul_i32 s37, s36, 640
    v_and_b32 v20, 7, v0
    v_bfe_u32 v21, v0, 4, 1
    s_waitcnt lgkmcnt(0)
    s_mov_b32 s14, 10240
    s_mov_b32 s15, 0x20000
    v_lshrrev_b32 v27, 2, v20
    v_lshl_add_u32 v22, v27, 1, v21
    v_mul_u32_u24 v22, 1280, v22
    v_and_b32 v23, 3, v20
    s_and_b32 s34, s25, 1
    s_mul_i32 s34, s34, 5120
    s_add_u32 s34, s34, s37
    s_cmp_ge_u32 s26, 2
    s_cbranch_scc1 L_m0b_160
    s_mov_b32 s38, s25
    s_and_b32 s34, s25, 3
    s_mul_i32 s34, s34, 2560
    s_lshr_b32 s35, s25, 2
    s_lshl_b32 s35, s35, 4
    s_add_u32 s34, s34, s35
    s_add_u32 s34, s34, s37
    v_mul_u32_u24 v22, 1280, v21
    v_lshl_add_u32 v22, v20, 1, v22
    buffer_load_ushort v23, v22, s[12:15], s34 offen
    buffer_load_ushort v24, v22, s[12:15], s34 offen offset:128
    buffer_load_ushort v25, v22, s[12:15], s34 offen offset:256
    buffer_load_ushort v26, v22, s[12:15], s34 offen offset:384
    s_waitcnt vmcnt(0)
    v_lshl_or_b32 v24, v24, 16, v23
    v_lshl_or_b32 v25, v26, 16, v25
    s_branch L_m0c_161
L_m0b_160:
    s_and_b32 s38, s25, 7
    s_lshr_b32 s35, s38, 1
    s_lshl_b32 s35, s35, 5
    s_add_u32 s34, s34, s35
    s_add_u32 s34, s34, 512
    s_add_u32 s38, s38, 32
    v_lshl_add_u32 v22, v23, 3, v22
    buffer_load_dwordx2 v[24:25], v22, s[12:15], s34 offen
    s_waitcnt vmcnt(0)
L_m0c_161:
    v_min_u32 v24, -2, v24
    v_min_u32 v25, -2, v25
    v_and_b32 v22, 1, v20
    v_lshlrev_b32 v22, 3, v22
    v_lshl_add_u32 v22, v21, 4, v22
    v_bfe_u32 v23, v20, 1, 1
    v_lshl_add_u32 v22, v23, 5, v22
    v_lshl_add_u32 v22, v27, 6, v22
    s_lshl_b32 s38, s38, 7
    s_lshl_b32 s36, s36, 15
    s_add_u32 s38, s38, s36
    s_add_u32 s38, s38, 262144
    s_or_b32 s99, s26, s98
    s_cbranch_scc1 L_ci_162
    s_lshl_b32 s99, s24, 2
    s_lshl_b32 s95, 1, s25
    s_atomic_or s95, s[96:97], s99 glc
L_ci_162:
    s_cmp_lg_u32 s98, 0
    s_cbranch_scc1 L_cc_163
    v_mov_b32 v254, 163832
    s_cmp_lg_u32 s26, 0
    s_cbranch_scc1 L_ccw_164
    s_waitcnt lgkmcnt(0)
    v_mov_b32 v255, s95
    ds_write_b32 v254, v255
    s_waitcnt lgkmcnt(0)
L_ccw_164:
    s_barrier
    ds_read_b32 v255, v254
    s_waitcnt lgkmcnt(0)
    v_readfirstlane_b32 s99, v255
    s_barrier
    s_bitcmp1_b32 s99, s25
    s_cbranch_scc1 L_reclaim
L_cc_163:
    v_mov_b64 v[8:9], -1
    v_mov_b64 v[10:11], -1
    v_mov_b64 v[12:13], 0
    v_lshlrev_b32 v6, 4, v0
    v_lshlrev_b32 v7, 3, v0
    s_max_u32 s34, s25, 8
    s_lshl_b32 s34, s34, 11
    s_add_u32 s34, s34, 3538944
    buffer_store_dwordx2 v[12:13], v7, s[4:7], s34 offen sc1
    v_mov_b64 v[14:15], 0
    s_lshl_b32 s34, s25, 12
    s_add_u32 s34, s34, 32768
    buffer_store_dwordx4 v[12:15], v6, s[4:7], s34 offen sc1
    s_max_u32 s34, s25, 8
    s_lshl_b32 s34, s34, 13
    s_add_u32 s34, s34, 262144
    buffer_store_dwordx4 v[8:11], v6, s[4:7], s34 offen sc1
    s_add_u32 s34, s34, 4096
    buffer_store_dwordx4 v[8:11], v6, s[4:7], s34 offen sc1
    s_mul_i32 s34, s25, 73728
    s_add_u32 s34, s34, 1048576
    buffer_store_dwordx4 v[8:11], v6, s[4:7], s34 offen sc1
    s_add_u32 s34, s34, 4096
    buffer_store_dwordx4 v[8:11], v6, s[4:7], s34 offen sc1
    s_add_u32 s34, s34, 4096
    buffer_store_dwordx4 v[8:11], v6, s[4:7], s34 offen sc1
    s_add_u32 s34, s34, 4096
    buffer_store_dwordx4 v[8:11], v6, s[4:7], s34 offen sc1
    s_add_u32 s34, s34, 4096
    buffer_store_dwordx4 v[8:11], v6, s[4:7], s34 offen sc1
    s_add_u32 s34, s34, 4096
    buffer_store_dwordx4 v[8:11], v6, s[4:7], s34 offen sc1
    s_add_u32 s34, s34, 4096
    buffer_store_dwordx4 v[8:11], v6, s[4:7], s34 offen sc1
    s_add_u32 s34, s34, 4096
    buffer_store_dwordx4 v[8:11], v6, s[4:7], s34 offen sc1
    s_add_u32 s34, s34, 4096
    buffer_store_dwordx4 v[8:11], v6, s[4:7], s34 offen sc1
    s_add_u32 s34, s34, 4096
    buffer_store_dwordx4 v[8:11], v6, s[4:7], s34 offen sc1
    s_add_u32 s34, s34, 4096
    buffer_store_dwordx4 v[8:11], v6, s[4:7], s34 offen sc1
    s_add_u32 s34, s34, 4096
    buffer_store_dwordx4 v[8:11], v6, s[4:7], s34 offen sc1
    s_add_u32 s34, s34, 4096
    buffer_store_dwordx4 v[8:11], v6, s[4:7], s34 offen sc1
    s_add_u32 s34, s34, 4096
    buffer_store_dwordx4 v[8:11], v6, s[4:7], s34 offen sc1
    s_add_u32 s34, s34, 4096
    buffer_store_dwordx4 v[8:11], v6, s[4:7], s34 offen sc1
    s_add_u32 s34, s34, 4096
    buffer_store_dwordx4 v[8:11], v6, s[4:7], s34 offen sc1
    s_add_u32 s34, s34, 4096
    buffer_store_dwordx4 v[8:11], v6, s[4:7], s34 offen sc1
    s_add_u32 s34, s34, 4096
    buffer_store_dwordx4 v[8:11], v6, s[4:7], s34 offen sc1
    s_add_u32 s34, s34, 4096
    s_mov_b64 exec, 0x00ff00ff
    buffer_store_dwordx2 v[24:25], v22, s[4:7], s38 offen sc1
    s_add_u32 s38, s38, 8192
    buffer_store_dwordx2 v[24:25], v22, s[4:7], s38 offen sc1
    s_add_u32 s38, s38, 8192
    buffer_store_dwordx2 v[24:25], v22, s[4:7], s38 offen sc1
    s_add_u32 s38, s38, 8192
    buffer_store_dwordx2 v[24:25], v22, s[4:7], s38 offen sc1
    s_add_u32 s38, s38, 8192
    s_mov_b64 exec, -1
    s_waitcnt vmcnt(0)
    s_barrier
    s_cmp_lg_u32 s26, 0
    s_cbranch_scc1 L_arm_165
    s_mov_b64 exec, 1
    v_mov_b32 v8, 0
    v_mov_b32 v9, 1
    global_atomic_add v10, v8, v9, s[96:97] offset:48 sc0
    s_waitcnt vmcnt(0)
    v_cmp_ne_u32 vcc, 31, v10
    s_cbranch_vccnz L_ci_166
    global_store_dword v8, v9, s[96:97] offset:148 sc1
L_ci_166:
    s_mov_b64 exec, -1
L_arm_165:
    s_load_dwordx2 s[8:9], s[0:1], 16
    v_and_b32 v1, 63, v0
    v_lshlrev_b32 v2, 4, v1
    v_and_b32 v4, 15, v1
    v_lshrrev_b32 v5, 4, v1
    v_lshlrev_b32 v6, 2, v5
    v_xor_b32 v6, v6, v4
    v_lshlrev_b32 v6, 4, v6
    v_lshl_add_u32 v6, v5, 13, v6
    s_lshl_b32 s34, s25, 8
    s_lshl_b32 s35, s26, 17
    s_add_u32 s34, s34, s35
    v_add_u32 v6, s34, v6
    s_lshl_b32 s35, s26, 12
    s_waitcnt lgkmcnt(0)
    s_mov_b32 s10, 5242880
    s_mov_b32 s11, 0x20000
    s_add_u32 m0, s35, 0
    s_mov_b32 s34, 0
    buffer_load_dwordx4 v6, s[8:11], s34 offen offset:0 lds
    s_mov_b32 s34, 31744
    buffer_load_dwordx4 v6, s[8:11], s34 offen offset:1024 lds
    s_mov_b32 s34, 63488
    buffer_load_dwordx4 v6, s[8:11], s34 offen offset:2048 lds
    s_mov_b32 s34, 95232
    buffer_load_dwordx4 v6, s[8:11], s34 offen offset:3072 lds
    s_add_u32 m0, s35, 16384
    s_mov_b32 s34, 524288
    buffer_load_dwordx4 v6, s[8:11], s34 offen offset:0 lds
    s_mov_b32 s34, 556032
    buffer_load_dwordx4 v6, s[8:11], s34 offen offset:1024 lds
    s_mov_b32 s34, 587776
    buffer_load_dwordx4 v6, s[8:11], s34 offen offset:2048 lds
    s_mov_b32 s34, 619520
    buffer_load_dwordx4 v6, s[8:11], s34 offen offset:3072 lds
    s_add_u32 m0, s35, 32768
    s_mov_b32 s34, 1048576
    buffer_load_dwordx4 v6, s[8:11], s34 offen offset:0 lds
    s_mov_b32 s34, 1080320
    buffer_load_dwordx4 v6, s[8:11], s34 offen offset:1024 lds
    s_mov_b32 s34, 1112064
    buffer_load_dwordx4 v6, s[8:11], s34 offen offset:2048 lds
    s_mov_b32 s34, 1143808
    buffer_load_dwordx4 v6, s[8:11], s34 offen offset:3072 lds
    s_add_u32 m0, s35, 49152
    s_mov_b32 s34, 1572864
    buffer_load_dwordx4 v6, s[8:11], s34 offen offset:0 lds
    s_mov_b32 s34, 1604608
    buffer_load_dwordx4 v6, s[8:11], s34 offen offset:1024 lds
    s_mov_b32 s34, 1636352
    buffer_load_dwordx4 v6, s[8:11], s34 offen offset:2048 lds
    s_mov_b32 s34, 1668096
    buffer_load_dwordx4 v6, s[8:11], s34 offen offset:3072 lds
    s_add_u32 m0, s35, 65536
    s_mov_b32 s34, 2097152
    buffer_load_dwordx4 v6, s[8:11], s34 offen offset:0 lds
    s_mov_b32 s34, 2128896
    buffer_load_dwordx4 v6, s[8:11], s34 offen offset:1024 lds
    s_mov_b32 s34, 2160640
    buffer_load_dwordx4 v6, s[8:11], s34 offen offset:2048 lds
    s_mov_b32 s34, 2192384
    buffer_load_dwordx4 v6, s[8:11], s34 offen offset:3072 lds
    s_add_u32 m0, s35, 81920
    s_mov_b32 s34, 2621440
    buffer_load_dwordx4 v6, s[8:11], s34 offen offset:0 lds
    s_mov_b32 s34, 2653184
    buffer_load_dwordx4 v6, s[8:11], s34 offen offset:1024 lds
    s_mov_b32 s34, 2684928
    buffer_load_dwordx4 v6, s[8:11], s34 offen offset:2048 lds
    s_mov_b32 s34, 2716672
    buffer_load_dwordx4 v6, s[8:11], s34 offen offset:3072 lds
    s_add_u32 m0, s35, 98304
    s_mov_b32 s34, 3145728
    buffer_load_dwordx4 v6, s[8:11], s34 offen offset:0 lds
    s_mov_b32 s34, 3177472
    buffer_load_dwordx4 v6, s[8:11], s34 offen offset:1024 lds
    s_mov_b32 s34, 3209216
    buffer_load_dwordx4 v6, s[8:11], s34 offen offset:2048 lds
    s_mov_b32 s34, 3240960
    buffer_load_dwordx4 v6, s[8:11], s34 offen offset:3072 lds
    s_add_u32 m0, s35, 114688
    s_mov_b32 s34, 3670016
    buffer_load_dwordx4 v6, s[8:11], s34 offen offset:0 lds
    s_mov_b32 s34, 3701760
    buffer_load_dwordx4 v6, s[8:11], s34 offen offset:1024 lds
    s_mov_b32 s34, 3733504
    buffer_load_dwordx4 v6, s[8:11], s34 offen offset:2048 lds
    s_mov_b32 s34, 3765248
    buffer_load_dwordx4 v6, s[8:11], s34 offen offset:3072 lds
    s_add_u32 m0, s35, 131072
    s_mov_b32 s34, 4194304
    buffer_load_dwordx4 v6, s[8:11], s34 offen offset:0 lds
    s_mov_b32 s34, 4226048
    buffer_load_dwordx4 v6, s[8:11], s34 offen offset:1024 lds
    s_mov_b32 s34, 4257792
    buffer_load_dwordx4 v6, s[8:11], s34 offen offset:2048 lds
    s_mov_b32 s34, 4289536
    buffer_load_dwordx4 v6, s[8:11], s34 offen offset:3072 lds
    s_add_u32 m0, s35, 147456
    s_mov_b32 s34, 4718592
    buffer_load_dwordx4 v6, s[8:11], s34 offen offset:0 lds
    s_mov_b32 s34, 4750336
    buffer_load_dwordx4 v6, s[8:11], s34 offen offset:1024 lds
    s_mov_b32 s34, 4782080
    buffer_load_dwordx4 v6, s[8:11], s34 offen offset:2048 lds
    s_mov_b32 s34, 4813824
    buffer_load_dwordx4 v6, s[8:11], s34 offen offset:3072 lds
    v_bfe_u32 v7, v1, 2, 2
    v_and_b32 v8, 3, v1
    v_and_b32 v9, 1, v5
    v_lshrrev_b32 v10, 1, v5
    v_and_b32 v11, 1, v8
    v_lshl_add_u32 v11, v9, 1, v11
    v_lshrrev_b32 v12, 1, v8
    v_xor_b32 v13, s26, v7
    v_lshl_add_u32 v11, v13, 2, v11
    v_lshlrev_b32 v11, 4, v11
    v_lshl_add_u32 v11, v12, 3, v11
    v_lshl_add_u32 v11, v7, 8, v11
    v_lshl_add_u32 v11, v10, 11, v11
    s_waitcnt vmcnt(36)
    s_barrier
    v_add_u32 v12, 0, v11
    ds_read_b64_tr_b16 a[0:1], v12 offset:0
    ds_read_b64_tr_b16 a[2:3], v12 offset:1024
    ds_read_b64_tr_b16 a[4:5], v12 offset:4096
    ds_read_b64_tr_b16 a[6:7], v12 offset:5120
    ds_read_b64_tr_b16 a[8:9], v12 offset:8192
    ds_read_b64_tr_b16 a[10:11], v12 offset:9216
    ds_read_b64_tr_b16 a[12:13], v12 offset:12288
    ds_read_b64_tr_b16 a[14:15], v12 offset:13312
    s_waitcnt lgkmcnt(0)
    s_waitcnt vmcnt(32)
    s_barrier
    v_add_u32 v12, 16384, v11
    ds_read_b64_tr_b16 a[16:17], v12 offset:0
    ds_read_b64_tr_b16 a[18:19], v12 offset:1024
    ds_read_b64_tr_b16 a[20:21], v12 offset:4096
    ds_read_b64_tr_b16 a[22:23], v12 offset:5120
    ds_read_b64_tr_b16 a[24:25], v12 offset:8192
    ds_read_b64_tr_b16 a[26:27], v12 offset:9216
    ds_read_b64_tr_b16 a[28:29], v12 offset:12288
    ds_read_b64_tr_b16 a[30:31], v12 offset:13312
    s_waitcnt lgkmcnt(0)
    s_waitcnt vmcnt(28)
    s_barrier
    v_add_u32 v12, 32768, v11
    ds_read_b64_tr_b16 a[32:33], v12 offset:0
    ds_read_b64_tr_b16 a[34:35], v12 offset:1024
    ds_read_b64_tr_b16 a[36:37], v12 offset:4096
    ds_read_b64_tr_b16 a[38:39], v12 offset:5120
    ds_read_b64_tr_b16 a[40:41], v12 offset:8192
    ds_read_b64_tr_b16 a[42:43], v12 offset:9216
    ds_read_b64_tr_b16 a[44:45], v12 offset:12288
    ds_read_b64_tr_b16 a[46:47], v12 offset:13312
    s_waitcnt lgkmcnt(0)
    s_waitcnt vmcnt(24)
    s_barrier
    v_add_u32 v12, 49152, v11
    ds_read_b64_tr_b16 a[48:49], v12 offset:0
    ds_read_b64_tr_b16 a[50:51], v12 offset:1024
    ds_read_b64_tr_b16 a[52:53], v12 offset:4096
    ds_read_b64_tr_b16 a[54:55], v12 offset:5120
    ds_read_b64_tr_b16 a[56:57], v12 offset:8192
    ds_read_b64_tr_b16 a[58:59], v12 offset:9216
    ds_read_b64_tr_b16 a[60:61], v12 offset:12288
    ds_read_b64_tr_b16 a[62:63], v12 offset:13312
    s_waitcnt lgkmcnt(0)
    s_waitcnt vmcnt(20)
    s_barrier
    v_add_u32 v12, 65536, v11
    ds_read_b64_tr_b16 a[64:65], v12 offset:0
    ds_read_b64_tr_b16 a[66:67], v12 offset:1024
    ds_read_b64_tr_b16 a[68:69], v12 offset:4096
    ds_read_b64_tr_b16 a[70:71], v12 offset:5120
    ds_read_b64_tr_b16 a[72:73], v12 offset:8192
    ds_read_b64_tr_b16 a[74:75], v12 offset:9216
    ds_read_b64_tr_b16 a[76:77], v12 offset:12288
    ds_read_b64_tr_b16 a[78:79], v12 offset:13312
    s_waitcnt lgkmcnt(0)
    s_waitcnt vmcnt(16)
    s_barrier
    v_add_u32 v12, 81920, v11
    ds_read_b64_tr_b16 a[80:81], v12 offset:0
    ds_read_b64_tr_b16 a[82:83], v12 offset:1024
    ds_read_b64_tr_b16 a[84:85], v12 offset:4096
    ds_read_b64_tr_b16 a[86:87], v12 offset:5120
    ds_read_b64_tr_b16 a[88:89], v12 offset:8192
    ds_read_b64_tr_b16 a[90:91], v12 offset:9216
    ds_read_b64_tr_b16 a[92:93], v12 offset:12288
    ds_read_b64_tr_b16 a[94:95], v12 offset:13312
    s_waitcnt lgkmcnt(0)
    s_waitcnt vmcnt(12)
    s_barrier
    v_add_u32 v12, 98304, v11
    ds_read_b64_tr_b16 a[96:97], v12 offset:0
    ds_read_b64_tr_b16 a[98:99], v12 offset:1024
    ds_read_b64_tr_b16 a[100:101], v12 offset:4096
    ds_read_b64_tr_b16 a[102:103], v12 offset:5120
    ds_read_b64_tr_b16 a[104:105], v12 offset:8192
    ds_read_b64_tr_b16 a[106:107], v12 offset:9216
    ds_read_b64_tr_b16 a[108:109], v12 offset:12288
    ds_read_b64_tr_b16 a[110:111], v12 offset:13312
    s_waitcnt lgkmcnt(0)
    s_waitcnt vmcnt(8)
    s_barrier
    v_add_u32 v12, 114688, v11
    ds_read_b64_tr_b16 a[112:113], v12 offset:0
    ds_read_b64_tr_b16 a[114:115], v12 offset:1024
    ds_read_b64_tr_b16 a[116:117], v12 offset:4096
    ds_read_b64_tr_b16 a[118:119], v12 offset:5120
    ds_read_b64_tr_b16 a[120:121], v12 offset:8192
    ds_read_b64_tr_b16 a[122:123], v12 offset:9216
    ds_read_b64_tr_b16 a[124:125], v12 offset:12288
    ds_read_b64_tr_b16 a[126:127], v12 offset:13312
    s_waitcnt lgkmcnt(0)
    s_waitcnt vmcnt(4)
    s_barrier
    v_add_u32 v12, 131072, v11
    ds_read_b64_tr_b16 a[128:129], v12 offset:0
    ds_read_b64_tr_b16 a[130:131], v12 offset:1024
    ds_read_b64_tr_b16 a[132:133], v12 offset:4096
    ds_read_b64_tr_b16 a[134:135], v12 offset:5120
    ds_read_b64_tr_b16 a[136:137], v12 offset:8192
    ds_read_b64_tr_b16 a[138:139], v12 offset:9216
    ds_read_b64_tr_b16 a[140:141], v12 offset:12288
    ds_read_b64_tr_b16 a[142:143], v12 offset:13312
    s_waitcnt lgkmcnt(0)
    s_waitcnt vmcnt(0)
    s_barrier
    v_add_u32 v12, 147456, v11
    ds_read_b64_tr_b16 a[144:145], v12 offset:0
    ds_read_b64_tr_b16 a[146:147], v12 offset:1024
    ds_read_b64_tr_b16 a[148:149], v12 offset:4096
    ds_read_b64_tr_b16 a[150:151], v12 offset:5120
    ds_read_b64_tr_b16 a[152:153], v12 offset:8192
    ds_read_b64_tr_b16 a[154:155], v12 offset:9216
    ds_read_b64_tr_b16 a[156:157], v12 offset:12288
    ds_read_b64_tr_b16 a[158:159], v12 offset:13312
    s_waitcnt lgkmcnt(0)
    v_mbcnt_lo_u32_b32 v4, -1, 0
    v_lshlrev_b32 v4, 2, v4
    s_mov_b64 exec, 312
L_gs_167:
    global_load_dword v5, v4, s[96:97] offset:128 sc1
    s_waitcnt vmcnt(0)
    v_cmp_eq_u32 vcc, 0, v5
    s_cbranch_vccz L_gsd_168
    s_sleep 2
    s_sub_u32 s31, s31, 1
    s_cbranch_scc1 L_exit
    s_branch L_gs_167
L_gsd_168:
    s_mov_b64 exec, -1
    s_barrier
    s_mul_i32 s29, s26, 10240
    s_add_u32 s30, s29, 6651904
    s_mov_b32 s28, 0
    s_mov_b32 s36, 0
    s_add_u32 m0, s29, 0
    s_add_u32 s34, s30, 0
    buffer_load_dwordx4 v2, s[4:7], s34 offen offset:0 sc1 lds
    buffer_load_dwordx4 v2, s[4:7], s34 offen offset:1024 sc1 lds
    buffer_load_dwordx4 v2, s[4:7], s34 offen offset:2048 sc1 lds
    buffer_load_dwordx4 v2, s[4:7], s34 offen offset:3072 sc1 lds
    s_add_u32 m0, s29, 4096
    s_add_u32 s34, s30, 4096
    buffer_load_dwordx4 v2, s[4:7], s34 offen offset:0 sc1 lds
    buffer_load_dwordx4 v2, s[4:7], s34 offen offset:1024 sc1 lds
    buffer_load_dwordx4 v2, s[4:7], s34 offen offset:2048 sc1 lds
    buffer_load_dwordx4 v2, s[4:7], s34 offen offset:3072 sc1 lds
    s_add_u32 m0, s29, 8192
    s_add_u32 s34, s30, 8192
    buffer_load_dwordx4 v2, s[4:7], s34 offen offset:0 sc1 lds
    buffer_load_dwordx4 v2, s[4:7], s34 offen offset:1024 sc1 lds
    s_add_u32 s30, s30, 40960
    s_add_u32 s29, s29, 40960
    s_sub_u32 s34, s29, 122880
    s_cselect_b32 s29, s29, s34
    s_add_u32 m0, s29, 0
    s_add_u32 s34, s30, 0
    buffer_load_dwordx4 v2, s[4:7], s34 offen offset:0 sc1 lds
    buffer_load_dwordx4 v2, s[4:7], s34 offen offset:1024 sc1 lds
    buffer_load_dwordx4 v2, s[4:7], s34 offen offset:2048 sc1 lds
    buffer_load_dwordx4 v2, s[4:7], s34 offen offset:3072 sc1 lds
    s_add_u32 m0, s29, 4096
    s_add_u32 s34, s30, 4096
    buffer_load_dwordx4 v2, s[4:7], s34 offen offset:0 sc1 lds
    buffer_load_dwordx4 v2, s[4:7], s34 offen offset:1024 sc1 lds
    buffer_load_dwordx4 v2, s[4:7], s34 offen offset:2048 sc1 lds
    buffer_load_dwordx4 v2, s[4:7], s34 offen offset:3072 sc1 lds
    s_add_u32 m0, s29, 8192
    s_add_u32 s34, s30, 8192
    buffer_load_dwordx4 v2, s[4:7], s34 offen offset:0 sc1 lds
    buffer_load_dwordx4 v2, s[4:7], s34 offen offset:1024 sc1 lds
    s_add_u32 s30, s30, 40960
    s_add_u32 s29, s29, 40960
    s_sub_u32 s34, s29, 122880
    s_cselect_b32 s29, s29, s34
    v_readlane_b32 s51, v5, 4
    s_nop 0
    s_and_b32 s51, s51, 1
    s_lshl_b32 s51, s51, 13
    s_lshl_b32 s33, s25, 8
    s_add_u32 s33, s33, s51
    s_add_u32 s33, s33, 65536
    s_mov_b32 s52, 2454267026
    s_mov_b32 s53, 1246925988
    s_mov_b32 s54, 613566756
    s_mov_b32 s55, 2355304649
    s_mov_b32 s56, 0
    s_mov_b32 s57, 277094656
    v_and_b32 v20, 15, v1
    v_lshrrev_b32 v21, 4, v1
    s_and_b32 s34, s26, 1
    s_lshr_b32 s35, s26, 1
    s_lshl_b32 s42, s26, 11
    s_add_u32 s42, s42, 122880
    v_add_u32 v4, s42, v2
    v_lshlrev_b32 v22, 9, v21
    v_lshl_add_u32 v23, v20, 4, v22
    s_lshl_b32 s42, s34, 8
    s_add_u32 s42, s42, 122880
    v_add_u32 v5, s42, v23
    s_lshl_b32 s42, s26, 11
    v_add_u32 v7, s42, v23
    v_add_u32 v22, s42, v22
    s_lshl_b32 s47, s26, 10
    s_lshl_b32 s48, s26, 12
    s_mov_b32 s49, s47
    v_add_u32 v170, 131328, v2
    s_lshl_b32 s42, s35, 13
    v_add_u32 v171, s42, v170
    v_lshrrev_b32 v24, 3, v20
    v_lshl_add_u32 v24, v24, 8, v22
    v_and_b32 v25, 7, v20
    v_lshl_add_u32 v6, v25, 4, v24
    s_lshl_b32 s42, s35, 11
    v_lshl_add_u32 v10, v1, 3, s42
    s_lshl_b32 s32, s34, 17
    s_lshl_b32 s42, s25, 12
    s_add_u32 s32, s32, s42
    s_add_u32 s38, s42, 67108864
    s_add_u32 s39, s42, 75497472
    s_lshl_b32 s42, s35, 11
    s_add_u32 s32, s32, s42
    s_add_u32 s32, s32, 50331648
    s_lshl_b32 s37, s25, 13
    s_add_u32 s37, s37, 16777216
    s_mov_b32 s40, 1040356334
    s_lshl_b32 s42, s34, 4
    v_add_u32 v20, s42, v20
    v_lshrrev_b32 v22, 1, v21
    v_and_b32 v23, 1, v21
    v_lshlrev_b32 v23, 2, v23
    v_lshl_add_u32 v22, v22, 4, v23
    v_mov_b32 v24, 4048155338
    v_add_u32 v23, 0, v22
    v_cmp_gt_u32 vcc, v23, v20
    s_nop 1
    v_cndmask_b32 v12, 0, v24, vcc
    v_add_u32 v23, 1, v22
    v_cmp_gt_u32 vcc, v23, v20
    s_nop 1
    v_cndmask_b32 v13, 0, v24, vcc
    v_add_u32 v23, 2, v22
    v_cmp_gt_u32 vcc, v23, v20
    s_nop 1
    v_cndmask_b32 v14, 0, v24, vcc
    v_add_u32 v23, 3, v22
    v_cmp_gt_u32 vcc, v23, v20
    s_nop 1
    v_cndmask_b32 v15, 0, v24, vcc
    v_add_u32 v23, 8, v22
    v_cmp_gt_u32 vcc, v23, v20
    s_nop 1
    v_cndmask_b32 v16, 0, v24, vcc
    v_add_u32 v23, 9, v22
    v_cmp_gt_u32 vcc, v23, v20
    s_nop 1
    v_cndmask_b32 v17, 0, v24, vcc
    v_add_u32 v23, 10, v22
    v_cmp_gt_u32 vcc, v23, v20
    s_nop 1
    v_cndmask_b32 v18, 0, v24, vcc
    v_add_u32 v23, 11, v22
    v_cmp_gt_u32 vcc, v23, v20
    s_nop 1
    v_cndmask_b32 v19, 0, v24, vcc
    v_lshlrev_b32 v8, 13, v1
    v_add_u32 v8, 3538944, v8
    v_lshlrev_b32 v20, 14, v1
    s_xor_b32 s51, s51, 0
    s_add_u32 s51, s51, 0
    v_add_u32 v20, s51, v20
    v_cmp_gt_u32 vcc, 2, v1
    s_nop 1
    v_cndmask_b32 v8, v20, v8, vcc
    s_lshl_b32 s43, s25, 8
    v_mov_b32 v172, 0x3f803f80
    v_mov_b32 v173, 0x3f803f80
    v_mov_b32 v174, 0x3f803f80
    v_mov_b32 v175, 0x3f803f80
    v_mov_b32 v196, 0x3f803f80
    v_mov_b32 v197, 0
    v_lshlrev_b32 v11, 2, v1
    v_add_u32 v11, 131072, v11
    v_mov_b32 v9, 0
    ds_write_b32 v11, v9
    s_waitcnt vmcnt(10)
    s_barrier
    v_add_u32 v3, s36, v2
    ds_read_b128 v[36:39], v3 offset:0
    ds_read_b128 v[40:43], v3 offset:1024
    ds_read_b128 v[44:47], v3 offset:2048
    ds_read_b128 v[48:51], v3 offset:3072
    ds_read_b128 v[52:55], v3 offset:4096
    s_add_u32 s36, s36, 40960
    s_cmp_eq_u32 s36, 122880
    s_cselect_b32 s36, 0, s36
    ds_read_b128 v[56:59], v3 offset:5120
    s_waitcnt lgkmcnt(5)
    v_mfma_f32_32x32x16_bf16 v[20:35], a[0:3], v[36:39], 0
    s_add_u32 m0, s29, 0
    s_add_u32 s34, s30, 0
    buffer_load_dwordx4 v2, s[4:7], s34 offen offset:0 sc1 lds
    ds_read_b128 v[60:63], v3 offset:6144
    s_waitcnt lgkmcnt(5)
    v_mfma_f32_32x32x16_bf16 v[20:35], a[4:7], v[40:43], v[20:35]
    ds_read_b128 v[36:39], v3 offset:7168
    s_waitcnt lgkmcnt(5)
    v_mfma_f32_32x32x16_bf16 v[20:35], a[8:11], v[44:47], v[20:35]
    ds_read_b128 v[40:43], v3 offset:8192
    s_waitcnt lgkmcnt(5)
    v_mfma_f32_32x32x16_bf16 v[20:35], a[12:15], v[48:51], v[20:35]
    buffer_load_dwordx4 v2, s[4:7], s34 offen offset:1024 sc1 lds
    ds_read_b128 v[44:47], v3 offset:9216
    s_waitcnt lgkmcnt(5)
    v_mfma_f32_32x32x16_bf16 v[20:35], a[16:19], v[52:55], v[20:35]
    ds_read_b128 v[48:51], v3 offset:10240
    s_waitcnt lgkmcnt(5)
    v_mfma_f32_32x32x16_bf16 v[20:35], a[20:23], v[56:59], v[20:35]
    ds_read_b128 v[52:55], v3 offset:11264
    s_waitcnt lgkmcnt(5)
    v_mfma_f32_32x32x16_bf16 v[20:35], a[24:27], v[60:63], v[20:35]
    buffer_load_dwordx4 v2, s[4:7], s34 offen offset:2048 sc1 lds
    ds_read_b128 v[56:59], v3 offset:12288
    s_waitcnt lgkmcnt(5)
    v_mfma_f32_32x32x16_bf16 v[20:35], a[28:31], v[36:39], v[20:35]
    ds_read_b128 v[60:63], v3 offset:13312
    s_waitcnt lgkmcnt(5)
    v_mfma_f32_32x32x16_bf16 v[20:35], a[32:35], v[40:43], v[20:35]
    ds_read_b128 v[36:39], v3 offset:14336
    s_waitcnt lgkmcnt(5)
    v_mfma_f32_32x32x16_bf16 v[20:35], a[36:39], v[44:47], v[20:35]
    buffer_load_dwordx4 v2, s[4:7], s34 offen offset:3072 sc1 lds
    ds_read_b128 v[40:43], v3 offset:15360
    s_waitcnt lgkmcnt(5)
    v_mfma_f32_32x32x16_bf16 v[20:35], a[40:43], v[48:51], v[20:35]
    ds_read_b128 v[44:47], v3 offset:16384
    s_waitcnt lgkmcnt(5)
    v_mfma_f32_32x32x16_bf16 v[20:35], a[44:47], v[52:55], v[20:35]
    ds_read_b128 v[48:51], v3 offset:17408
    s_waitcnt lgkmcnt(5)
    v_mfma_f32_32x32x16_bf16 v[20:35], a[48:51], v[56:59], v[20:35]
    s_add_u32 m0, s29, 4096
    s_add_u32 s34, s30, 4096
    buffer_load_dwordx4 v2, s[4:7], s34 offen offset:0 sc1 lds
    ds_read_b128 v[52:55], v3 offset:18432
    s_waitcnt lgkmcnt(5)
    v_mfma_f32_32x32x16_bf16 v[20:35], a[52:55], v[60:63], v[20:35]
    ds_read_b128 v[56:59], v3 offset:19456
    s_waitcnt lgkmcnt(5)
    v_mfma_f32_32x32x16_bf16 v[20:35], a[56:59], v[36:39], v[20:35]
    ds_read_b128 v[60:63], v3 offset:20480
    s_waitcnt lgkmcnt(5)
    v_mfma_f32_32x32x16_bf16 v[20:35], a[60:63], v[40:43], v[20:35]
    buffer_load_dwordx4 v2, s[4:7], s34 offen offset:1024 sc1 lds
    ds_read_b128 v[36:39], v3 offset:21504
    s_waitcnt lgkmcnt(5)
    v_mfma_f32_32x32x16_bf16 v[20:35], a[64:67], v[44:47], v[20:35]
    ds_read_b128 v[40:43], v3 offset:22528
    s_waitcnt lgkmcnt(5)
    v_mfma_f32_32x32x16_bf16 v[20:35], a[68:71], v[48:51], v[20:35]
    ds_read_b128 v[44:47], v3 offset:23552
    s_waitcnt lgkmcnt(5)
    v_mfma_f32_32x32x16_bf16 v[20:35], a[72:75], v[52:55], v[20:35]
    buffer_load_dwordx4 v2, s[4:7], s34 offen offset:2048 sc1 lds
    ds_read_b128 v[48:51], v3 offset:24576
    s_waitcnt lgkmcnt(5)
    v_mfma_f32_32x32x16_bf16 v[20:35], a[76:79], v[56:59], v[20:35]
    ds_read_b128 v[52:55], v3 offset:25600
    s_waitcnt lgkmcnt(5)
    v_mfma_f32_32x32x16_bf16 v[20:35], a[80:83], v[60:63], v[20:35]
    ds_read_b128 v[56:59], v3 offset:26624
    s_waitcnt lgkmcnt(5)
    v_mfma_f32_32x32x16_bf16 v[20:35], a[84:87], v[36:39], v[20:35]
    buffer_load_dwordx4 v2, s[4:7], s34 offen offset:3072 sc1 lds
    ds_read_b128 v[60:63], v3 offset:27648
    s_waitcnt lgkmcnt(5)
    v_mfma_f32_32x32x16_bf16 v[20:35], a[88:91], v[40:43], v[20:35]
    ds_read_b128 v[36:39], v3 offset:28672
    s_waitcnt lgkmcnt(5)
    v_mfma_f32_32x32x16_bf16 v[20:35], a[92:95], v[44:47], v[20:35]
    ds_read_b128 v[40:43], v3 offset:29696
    s_waitcnt lgkmcnt(5)
    v_mfma_f32_32x32x16_bf16 v[20:35], a[96:99], v[48:51], v[20:35]
    s_add_u32 m0, s29, 8192
    s_add_u32 s34, s30, 8192
    buffer_load_dwordx4 v2, s[4:7], s34 offen offset:0 sc1 lds
    ds_read_b128 v[44:47], v3 offset:30720
    s_waitcnt lgkmcnt(5)
    v_mfma_f32_32x32x16_bf16 v[20:35], a[100:103], v[52:55], v[20:35]
    ds_read_b128 v[48:51], v3 offset:31744
    s_waitcnt lgkmcnt(5)
    v_mfma_f32_32x32x16_bf16 v[20:35], a[104:107], v[56:59], v[20:35]
    ds_read_b128 v[52:55], v3 offset:32768
    s_waitcnt lgkmcnt(5)
    v_mfma_f32_32x32x16_bf16 v[20:35], a[108:111], v[60:63], v[20:35]
    buffer_load_dwordx4 v2, s[4:7], s34 offen offset:1024 sc1 lds
    ds_read_b128 v[56:59], v3 offset:33792
    s_waitcnt lgkmcnt(5)
    v_mfma_f32_32x32x16_bf16 v[20:35], a[112:115], v[36:39], v[20:35]
    ds_read_b128 v[60:63], v3 offset:34816
    s_waitcnt lgkmcnt(5)
    v_mfma_f32_32x32x16_bf16 v[20:35], a[116:119], v[40:43], v[20:35]
    ds_read_b128 v[36:39], v3 offset:35840
    s_waitcnt lgkmcnt(5)
    v_mfma_f32_32x32x16_bf16 v[20:35], a[120:123], v[44:47], v[20:35]
    s_add_u32 s30, s30, 40960
    s_add_u32 s29, s29, 40960
    s_sub_u32 s34, s29, 122880
    s_cselect_b32 s29, s29, s34
    ds_read_b128 v[40:43], v3 offset:36864
    s_waitcnt lgkmcnt(5)
    v_mfma_f32_32x32x16_bf16 v[20:35], a[124:127], v[48:51], v[20:35]
    ds_read_b128 v[44:47], v3 offset:37888
    s_waitcnt lgkmcnt(5)
    v_mfma_f32_32x32x16_bf16 v[20:35], a[128:131], v[52:55], v[20:35]
    ds_read_b128 v[48:51], v3 offset:38912
    s_waitcnt lgkmcnt(5)
    v_mfma_f32_32x32x16_bf16 v[20:35], a[132:135], v[56:59], v[20:35]
    ds_read_b128 v[52:55], v3 offset:39936
    s_waitcnt lgkmcnt(5)
    v_mfma_f32_32x32x16_bf16 v[20:35], a[136:139], v[60:63], v[20:35]
    s_waitcnt lgkmcnt(4)
    v_mfma_f32_32x32x16_bf16 v[20:35], a[140:143], v[36:39], v[20:35]
    s_waitcnt lgkmcnt(3)
    v_mfma_f32_32x32x16_bf16 v[20:35], a[144:147], v[40:43], v[20:35]
    s_waitcnt lgkmcnt(2)
    v_mfma_f32_32x32x16_bf16 v[20:35], a[148:151], v[44:47], v[20:35]
    s_waitcnt lgkmcnt(1)
    v_mfma_f32_32x32x16_bf16 v[20:35], a[152:155], v[48:51], v[20:35]
    s_waitcnt lgkmcnt(0)
    v_mfma_f32_32x32x16_bf16 v[20:35], a[156:159], v[52:55], v[20:35]
    s_nop 11
    v_cvt_pk_bf16_f32 v36, v20, v21
    v_cvt_pk_bf16_f32 v37, v22, v23
    v_cvt_pk_bf16_f32 v38, v24, v25
    v_cvt_pk_bf16_f32 v39, v26, v27
    v_cvt_pk_bf16_f32 v40, v28, v29
    v_cvt_pk_bf16_f32 v41, v30, v31
    v_cvt_pk_bf16_f32 v42, v32, v33
    v_cvt_pk_bf16_f32 v43, v34, v35
    ds_write_b128 v4, v[36:39]
    ds_write_b128 v4, v[40:43] offset:1024
    s_waitcnt vmcnt(10) lgkmcnt(0)
    s_barrier
    ds_read_b128 a[160:163], v5 offset:0
    ds_read_b128 a[164:167], v5 offset:2048
    ds_read_b128 a[168:171], v5 offset:4096
    ds_read_b128 a[172:175], v5 offset:6144
    s_waitcnt lgkmcnt(0)
    s_barrier
    v_add_u32 v3, s36, v2
    ds_read_b128 v[36:39], v3 offset:0
    ds_read_b128 v[40:43], v3 offset:1024
    ds_read_b128 v[44:47], v3 offset:2048
    ds_read_b128 v[48:51], v3 offset:3072
    ds_read_b128 v[52:55], v3 offset:4096
    s_add_u32 s36, s36, 40960
    s_cmp_eq_u32 s36, 122880
    s_cselect_b32 s36, 0, s36
    ds_read_b128 v[56:59], v3 offset:5120
    s_waitcnt lgkmcnt(5)
    v_mfma_f32_32x32x16_bf16 v[20:35], a[0:3], v[36:39], 0
    s_add_u32 m0, s29, 0
    s_add_u32 s34, s30, 0
    buffer_load_dwordx4 v2, s[4:7], s34 offen offset:0 sc1 lds
    ds_read_b128 v[60:63], v3 offset:6144
    s_waitcnt lgkmcnt(5)
    v_mfma_f32_32x32x16_bf16 v[20:35], a[4:7], v[40:43], v[20:35]
    ds_read_b128 v[36:39], v3 offset:7168
    s_waitcnt lgkmcnt(5)
    v_mfma_f32_32x32x16_bf16 v[20:35], a[8:11], v[44:47], v[20:35]
    ds_read_b128 v[40:43], v3 offset:8192
    s_waitcnt lgkmcnt(5)
    v_mfma_f32_32x32x16_bf16 v[20:35], a[12:15], v[48:51], v[20:35]
    buffer_load_dwordx4 v2, s[4:7], s34 offen offset:1024 sc1 lds
    ds_read_b128 v[44:47], v3 offset:9216
    s_waitcnt lgkmcnt(5)
    v_mfma_f32_32x32x16_bf16 v[20:35], a[16:19], v[52:55], v[20:35]
    ds_read_b128 v[48:51], v3 offset:10240
    s_waitcnt lgkmcnt(5)
    v_mfma_f32_32x32x16_bf16 v[20:35], a[20:23], v[56:59], v[20:35]
    ds_read_b128 v[52:55], v3 offset:11264
    s_waitcnt lgkmcnt(5)
    v_mfma_f32_32x32x16_bf16 v[20:35], a[24:27], v[60:63], v[20:35]
    buffer_load_dwordx4 v2, s[4:7], s34 offen offset:2048 sc1 lds
    ds_read_b128 v[56:59], v3 offset:12288
    s_waitcnt lgkmcnt(5)
    v_mfma_f32_32x32x16_bf16 v[20:35], a[28:31], v[36:39], v[20:35]
    ds_read_b128 v[60:63], v3 offset:13312
    s_waitcnt lgkmcnt(5)
    v_mfma_f32_32x32x16_bf16 v[20:35], a[32:35], v[40:43], v[20:35]
    ds_read_b128 v[36:39], v3 offset:14336
    s_waitcnt lgkmcnt(5)
    v_mfma_f32_32x32x16_bf16 v[20:35], a[36:39], v[44:47], v[20:35]
    buffer_load_dwordx4 v2, s[4:7], s34 offen offset:3072 sc1 lds
    ds_read_b128 v[40:43], v3 offset:15360
    s_waitcnt lgkmcnt(5)
    v_mfma_f32_32x32x16_bf16 v[20:35], a[40:43], v[48:51], v[20:35]
    ds_read_b128 v[44:47], v3 offset:16384
    s_waitcnt lgkmcnt(5)
    v_mfma_f32_32x32x16_bf16 v[20:35], a[44:47], v[52:55], v[20:35]
    ds_read_b128 v[48:51], v3 offset:17408
    s_waitcnt lgkmcnt(5)
    v_mfma_f32_32x32x16_bf16 v[20:35], a[48:51], v[56:59], v[20:35]
    s_add_u32 m0, s29, 4096
    s_add_u32 s34, s30, 4096
    buffer_load_dwordx4 v2, s[4:7], s34 offen offset:0 sc1 lds
    ds_read_b128 v[52:55], v3 offset:18432
    s_waitcnt lgkmcnt(5)
    v_mfma_f32_32x32x16_bf16 v[20:35], a[52:55], v[60:63], v[20:35]
    ds_read_b128 v[56:59], v3 offset:19456
    s_waitcnt lgkmcnt(5)
    v_mfma_f32_32x32x16_bf16 v[20:35], a[56:59], v[36:39], v[20:35]
    ds_read_b128 v[60:63], v3 offset:20480
    s_waitcnt lgkmcnt(5)
    v_mfma_f32_32x32x16_bf16 v[20:35], a[60:63], v[40:43], v[20:35]
    buffer_load_dwordx4 v2, s[4:7], s34 offen offset:1024 sc1 lds
    ds_read_b128 v[36:39], v3 offset:21504
    s_waitcnt lgkmcnt(5)
    v_mfma_f32_32x32x16_bf16 v[20:35], a[64:67], v[44:47], v[20:35]
    ds_read_b128 v[40:43], v3 offset:22528
    s_waitcnt lgkmcnt(5)
    v_mfma_f32_32x32x16_bf16 v[20:35], a[68:71], v[48:51], v[20:35]
    ds_read_b128 v[44:47], v3 offset:23552
    s_waitcnt lgkmcnt(5)
    v_mfma_f32_32x32x16_bf16 v[20:35], a[72:75], v[52:55], v[20:35]
    buffer_load_dwordx4 v2, s[4:7], s34 offen offset:2048 sc1 lds
    ds_read_b128 v[48:51], v3 offset:24576
    s_waitcnt lgkmcnt(5)
    v_mfma_f32_32x32x16_bf16 v[20:35], a[76:79], v[56:59], v[20:35]
    ds_read_b128 v[52:55], v3 offset:25600
    s_waitcnt lgkmcnt(5)
    v_mfma_f32_32x32x16_bf16 v[20:35], a[80:83], v[60:63], v[20:35]
    ds_read_b128 v[56:59], v3 offset:26624
    s_waitcnt lgkmcnt(5)
    v_mfma_f32_32x32x16_bf16 v[20:35], a[84:87], v[36:39], v[20:35]
    buffer_load_dwordx4 v2, s[4:7], s34 offen offset:3072 sc1 lds
    ds_read_b128 v[60:63], v3 offset:27648
    s_waitcnt lgkmcnt(5)
    v_mfma_f32_32x32x16_bf16 v[20:35], a[88:91], v[40:43], v[20:35]
    ds_read_b128 v[36:39], v3 offset:28672
    s_waitcnt lgkmcnt(5)
    v_mfma_f32_32x32x16_bf16 v[20:35], a[92:95], v[44:47], v[20:35]
    ds_read_b128 v[40:43], v3 offset:29696
    s_waitcnt lgkmcnt(5)
    v_mfma_f32_32x32x16_bf16 v[20:35], a[96:99], v[48:51], v[20:35]
    s_add_u32 m0, s29, 8192
    s_add_u32 s34, s30, 8192
    buffer_load_dwordx4 v2, s[4:7], s34 offen offset:0 sc1 lds
    ds_read_b128 v[44:47], v3 offset:30720
    s_waitcnt lgkmcnt(5)
    v_mfma_f32_32x32x16_bf16 v[20:35], a[100:103], v[52:55], v[20:35]
    ds_read_b128 v[48:51], v3 offset:31744
    s_waitcnt lgkmcnt(5)
    v_mfma_f32_32x32x16_bf16 v[20:35], a[104:107], v[56:59], v[20:35]
    ds_read_b128 v[52:55], v3 offset:32768
    s_waitcnt lgkmcnt(5)
    v_mfma_f32_32x32x16_bf16 v[20:35], a[108:111], v[60:63], v[20:35]
    buffer_load_dwordx4 v2, s[4:7], s34 offen offset:1024 sc1 lds
    ds_read_b128 v[56:59], v3 offset:33792
    s_waitcnt lgkmcnt(5)
    v_mfma_f32_32x32x16_bf16 v[20:35], a[112:115], v[36:39], v[20:35]
    ds_read_b128 v[60:63], v3 offset:34816
    s_waitcnt lgkmcnt(5)
    v_mfma_f32_32x32x16_bf16 v[20:35], a[116:119], v[40:43], v[20:35]
    ds_read_b128 v[36:39], v3 offset:35840
    s_waitcnt lgkmcnt(5)
    v_mfma_f32_32x32x16_bf16 v[20:35], a[120:123], v[44:47], v[20:35]
    s_add_u32 s30, s30, 40960
    s_add_u32 s29, s29, 40960
    s_sub_u32 s34, s29, 122880
    s_cselect_b32 s29, s29, s34
    ds_read_b128 v[40:43], v3 offset:36864
    s_waitcnt lgkmcnt(5)
    v_mfma_f32_32x32x16_bf16 v[20:35], a[124:127], v[48:51], v[20:35]
    ds_read_b128 v[44:47], v3 offset:37888
    s_waitcnt lgkmcnt(5)
    v_mfma_f32_32x32x16_bf16 v[20:35], a[128:131], v[52:55], v[20:35]
    ds_read_b128 v[48:51], v3 offset:38912
    s_waitcnt lgkmcnt(5)
    v_mfma_f32_32x32x16_bf16 v[20:35], a[132:135], v[56:59], v[20:35]
    ds_read_b128 v[52:55], v3 offset:39936
    s_waitcnt lgkmcnt(5)
    v_mfma_f32_32x32x16_bf16 v[20:35], a[136:139], v[60:63], v[20:35]
    s_waitcnt lgkmcnt(4)
    v_mfma_f32_32x32x16_bf16 v[20:35], a[140:143], v[36:39], v[20:35]
    s_waitcnt lgkmcnt(3)
    v_mfma_f32_32x32x16_bf16 v[20:35], a[144:147], v[40:43], v[20:35]
    s_waitcnt lgkmcnt(2)
    v_mfma_f32_32x32x16_bf16 v[20:35], a[148:151], v[44:47], v[20:35]
    s_waitcnt lgkmcnt(1)
    v_mfma_f32_32x32x16_bf16 v[20:35], a[152:155], v[48:51], v[20:35]
    s_waitcnt lgkmcnt(0)
    v_mfma_f32_32x32x16_bf16 v[20:35], a[156:159], v[52:55], v[20:35]
    s_nop 11
    v_cvt_pk_bf16_f32 v36, v20, v21
    v_cvt_pk_bf16_f32 v37, v22, v23
    v_cvt_pk_bf16_f32 v38, v24, v25
    v_cvt_pk_bf16_f32 v39, v26, v27
    v_cvt_pk_bf16_f32 v40, v28, v29
    v_cvt_pk_bf16_f32 v41, v30, v31
    v_cvt_pk_bf16_f32 v42, v32, v33
    v_cvt_pk_bf16_f32 v43, v34, v35
    ds_write_b128 v4, v[36:39]
    ds_write_b128 v4, v[40:43] offset:1024
    s_waitcnt vmcnt(10) lgkmcnt(0)
    s_barrier
    ds_read_b128 a[176:179], v5 offset:0
    ds_read_b128 a[180:183], v5 offset:2048
    ds_read_b128 a[184:187], v5 offset:4096
    ds_read_b128 a[188:191], v5 offset:6144
    s_waitcnt lgkmcnt(0)
    s_barrier
    s_sub_u32 s30, s30, 2621440
    v_add_u32 v3, s36, v2
    ds_read_b128 v[36:39], v3 offset:0
    ds_read_b128 v[40:43], v3 offset:1024
    ds_read_b128 v[44:47], v3 offset:2048
    ds_read_b128 v[48:51], v3 offset:3072
    ds_read_b128 v[52:55], v3 offset:4096
    s_add_u32 s36, s36, 40960
    s_cmp_eq_u32 s36, 122880
    s_cselect_b32 s36, 0, s36
    ds_read_b128 v[56:59], v3 offset:5120
    s_waitcnt lgkmcnt(5)
    v_mfma_f32_32x32x16_bf16 v[20:35], a[0:3], v[36:39], 0
    s_add_u32 m0, s29, 0
    s_add_u32 s34, s30, 0
    buffer_load_dwordx4 v2, s[4:7], s34 offen offset:0 sc1 lds
    ds_read_b128 v[60:63], v3 offset:6144
    s_waitcnt lgkmcnt(5)
    v_mfma_f32_32x32x16_bf16 v[20:35], a[4:7], v[40:43], v[20:35]
    ds_read_b128 v[36:39], v3 offset:7168
    s_waitcnt lgkmcnt(5)
    v_mfma_f32_32x32x16_bf16 v[20:35], a[8:11], v[44:47], v[20:35]
    ds_read_b128 v[40:43], v3 offset:8192
    s_waitcnt lgkmcnt(5)
    v_mfma_f32_32x32x16_bf16 v[20:35], a[12:15], v[48:51], v[20:35]
    buffer_load_dwordx4 v2, s[4:7], s34 offen offset:1024 sc1 lds
    ds_read_b128 v[44:47], v3 offset:9216
    s_waitcnt lgkmcnt(5)
    v_mfma_f32_32x32x16_bf16 v[20:35], a[16:19], v[52:55], v[20:35]
    ds_read_b128 v[48:51], v3 offset:10240
    s_waitcnt lgkmcnt(5)
    v_mfma_f32_32x32x16_bf16 v[20:35], a[20:23], v[56:59], v[20:35]
    ds_read_b128 v[52:55], v3 offset:11264
    s_waitcnt lgkmcnt(5)
    v_mfma_f32_32x32x16_bf16 v[20:35], a[24:27], v[60:63], v[20:35]
    buffer_load_dwordx4 v2, s[4:7], s34 offen offset:2048 sc1 lds
    ds_read_b128 v[56:59], v3 offset:12288
    s_waitcnt lgkmcnt(5)
    v_mfma_f32_32x32x16_bf16 v[20:35], a[28:31], v[36:39], v[20:35]
    ds_read_b128 v[60:63], v3 offset:13312
    s_waitcnt lgkmcnt(5)
    v_mfma_f32_32x32x16_bf16 v[20:35], a[32:35], v[40:43], v[20:35]
    ds_read_b128 v[36:39], v3 offset:14336
    s_waitcnt lgkmcnt(5)
    v_mfma_f32_32x32x16_bf16 v[20:35], a[36:39], v[44:47], v[20:35]
    buffer_load_dwordx4 v2, s[4:7], s34 offen offset:3072 sc1 lds
    ds_read_b128 v[40:43], v3 offset:15360
    s_waitcnt lgkmcnt(5)
    v_mfma_f32_32x32x16_bf16 v[20:35], a[40:43], v[48:51], v[20:35]
    ds_read_b128 v[44:47], v3 offset:16384
    s_waitcnt lgkmcnt(5)
    v_mfma_f32_32x32x16_bf16 v[20:35], a[44:47], v[52:55], v[20:35]
    ds_read_b128 v[48:51], v3 offset:17408
    s_waitcnt lgkmcnt(5)
    v_mfma_f32_32x32x16_bf16 v[20:35], a[48:51], v[56:59], v[20:35]
    s_add_u32 m0, s29, 4096
    s_add_u32 s34, s30, 4096
    buffer_load_dwordx4 v2, s[4:7], s34 offen offset:0 sc1 lds
    ds_read_b128 v[52:55], v3 offset:18432
    s_waitcnt lgkmcnt(5)
    v_mfma_f32_32x32x16_bf16 v[20:35], a[52:55], v[60:63], v[20:35]
    ds_read_b128 v[56:59], v3 offset:19456
    s_waitcnt lgkmcnt(5)
    v_mfma_f32_32x32x16_bf16 v[20:35], a[56:59], v[36:39], v[20:35]
    ds_read_b128 v[60:63], v3 offset:20480
    s_waitcnt lgkmcnt(5)
    v_mfma_f32_32x32x16_bf16 v[20:35], a[60:63], v[40:43], v[20:35]
    buffer_load_dwordx4 v2, s[4:7], s34 offen offset:1024 sc1 lds
    ds_read_b128 v[36:39], v3 offset:21504
    s_waitcnt lgkmcnt(5)
    v_mfma_f32_32x32x16_bf16 v[20:35], a[64:67], v[44:47], v[20:35]
    ds_read_b128 v[40:43], v3 offset:22528
    s_waitcnt lgkmcnt(5)
    v_mfma_f32_32x32x16_bf16 v[20:35], a[68:71], v[48:51], v[20:35]
    ds_read_b128 v[44:47], v3 offset:23552
    s_waitcnt lgkmcnt(5)
    v_mfma_f32_32x32x16_bf16 v[20:35], a[72:75], v[52:55], v[20:35]
    buffer_load_dwordx4 v2, s[4:7], s34 offen offset:2048 sc1 lds
    ds_read_b128 v[48:51], v3 offset:24576
    s_waitcnt lgkmcnt(5)
    v_mfma_f32_32x32x16_bf16 v[20:35], a[76:79], v[56:59], v[20:35]
    ds_read_b128 v[52:55], v3 offset:25600
    s_waitcnt lgkmcnt(5)
    v_mfma_f32_32x32x16_bf16 v[20:35], a[80:83], v[60:63], v[20:35]
    ds_read_b128 v[56:59], v3 offset:26624
    s_waitcnt lgkmcnt(5)
    v_mfma_f32_32x32x16_bf16 v[20:35], a[84:87], v[36:39], v[20:35]
    buffer_load_dwordx4 v2, s[4:7], s34 offen offset:3072 sc1 lds
    ds_read_b128 v[60:63], v3 offset:27648
    s_waitcnt lgkmcnt(5)
    v_mfma_f32_32x32x16_bf16 v[20:35], a[88:91], v[40:43], v[20:35]
    ds_read_b128 v[36:39], v3 offset:28672
    s_waitcnt lgkmcnt(5)
    v_mfma_f32_32x32x16_bf16 v[20:35], a[92:95], v[44:47], v[20:35]
    ds_read_b128 v[40:43], v3 offset:29696
    s_waitcnt lgkmcnt(5)
    v_mfma_f32_32x32x16_bf16 v[20:35], a[96:99], v[48:51], v[20:35]
    s_add_u32 m0, s29, 8192
    s_add_u32 s34, s30, 8192
    buffer_load_dwordx4 v2, s[4:7], s34 offen offset:0 sc1 lds
    ds_read_b128 v[44:47], v3 offset:30720
    s_waitcnt lgkmcnt(5)
    v_mfma_f32_32x32x16_bf16 v[20:35], a[100:103], v[52:55], v[20:35]
    ds_read_b128 v[48:51], v3 offset:31744
    s_waitcnt lgkmcnt(5)
    v_mfma_f32_32x32x16_bf16 v[20:35], a[104:107], v[56:59], v[20:35]
    ds_read_b128 v[52:55], v3 offset:32768
    s_waitcnt lgkmcnt(5)
    v_mfma_f32_32x32x16_bf16 v[20:35], a[108:111], v[60:63], v[20:35]
    buffer_load_dwordx4 v2, s[4:7], s34 offen offset:1024 sc1 lds
    ds_read_b128 v[56:59], v3 offset:33792
    s_waitcnt lgkmcnt(5)
    v_mfma_f32_32x32x16_bf16 v[20:35], a[112:115], v[36:39], v[20:35]
    ds_read_b128 v[60:63], v3 offset:34816
    s_waitcnt lgkmcnt(5)
    v_mfma_f32_32x32x16_bf16 v[20:35], a[116:119], v[40:43], v[20:35]
    ds_read_b128 v[36:39], v3 offset:35840
    s_waitcnt lgkmcnt(5)
    v_mfma_f32_32x32x16_bf16 v[20:35], a[120:123], v[44:47], v[20:35]
    s_add_u32 s30, s30, 40960
    s_add_u32 s29, s29, 40960
    s_sub_u32 s34, s29, 122880
    s_cselect_b32 s29, s29, s34
    ds_read_b128 v[40:43], v3 offset:36864
    s_waitcnt lgkmcnt(5)
    v_mfma_f32_32x32x16_bf16 v[20:35], a[124:127], v[48:51], v[20:35]
    ds_read_b128 v[44:47], v3 offset:37888
    s_waitcnt lgkmcnt(5)
    v_mfma_f32_32x32x16_bf16 v[20:35], a[128:131], v[52:55], v[20:35]
    ds_read_b128 v[48:51], v3 offset:38912
    s_waitcnt lgkmcnt(5)
    v_mfma_f32_32x32x16_bf16 v[20:35], a[132:135], v[56:59], v[20:35]
    ds_read_b128 v[52:55], v3 offset:39936
    s_waitcnt lgkmcnt(5)
    v_mfma_f32_32x32x16_bf16 v[20:35], a[136:139], v[60:63], v[20:35]
    s_waitcnt lgkmcnt(4)
    v_mfma_f32_32x32x16_bf16 v[20:35], a[140:143], v[36:39], v[20:35]
    s_waitcnt lgkmcnt(3)
    v_mfma_f32_32x32x16_bf16 v[20:35], a[144:147], v[40:43], v[20:35]
    s_waitcnt lgkmcnt(2)
    v_mfma_f32_32x32x16_bf16 v[20:35], a[148:151], v[44:47], v[20:35]
    s_waitcnt lgkmcnt(1)
    v_mfma_f32_32x32x16_bf16 v[20:35], a[152:155], v[48:51], v[20:35]
    s_waitcnt lgkmcnt(0)
    v_mfma_f32_32x32x16_bf16 v[20:35], a[156:159], v[52:55], v[20:35]
    s_nop 11
    v_cvt_pk_bf16_f32 v36, v20, v21
    v_cvt_pk_bf16_f32 v37, v22, v23
    v_cvt_pk_bf16_f32 v38, v24, v25
    v_cvt_pk_bf16_f32 v39, v26, v27
    v_cvt_pk_bf16_f32 v40, v28, v29
    v_cvt_pk_bf16_f32 v41, v30, v31
    v_cvt_pk_bf16_f32 v42, v32, v33
    v_cvt_pk_bf16_f32 v43, v34, v35
    ds_write_b128 v4, v[36:39]
    ds_write_b128 v4, v[40:43] offset:1024
    s_waitcnt vmcnt(10) lgkmcnt(0)
    s_barrier
    ds_read_b128 a[192:195], v5 offset:0
    ds_read_b128 a[196:199], v5 offset:2048
    ds_read_b128 a[200:203], v5 offset:4096
    ds_read_b128 a[204:207], v5 offset:6144
    s_waitcnt lgkmcnt(0)
    s_barrier
    v_add_u32 v3, s36, v2
    ds_read_b128 v[36:39], v3 offset:0
    ds_read_b128 v[40:43], v3 offset:1024
    ds_read_b128 v[44:47], v3 offset:2048
    ds_read_b128 v[48:51], v3 offset:3072
    ds_read_b128 v[52:55], v3 offset:4096
    s_add_u32 s36, s36, 40960
    s_cmp_eq_u32 s36, 122880
    s_cselect_b32 s36, 0, s36
    ds_read_b128 v[56:59], v3 offset:5120
    s_waitcnt lgkmcnt(5)
    v_mfma_f32_32x32x16_bf16 v[20:35], a[0:3], v[36:39], 0
    s_add_u32 m0, s29, 0
    s_add_u32 s34, s30, 0
    buffer_load_dwordx4 v2, s[4:7], s34 offen offset:0 sc1 lds
    ds_read_b128 v[60:63], v3 offset:6144
    s_waitcnt lgkmcnt(5)
    v_mfma_f32_32x32x16_bf16 v[20:35], a[4:7], v[40:43], v[20:35]
    ds_read_b128 v[36:39], v3 offset:7168
    s_waitcnt lgkmcnt(5)
    v_mfma_f32_32x32x16_bf16 v[20:35], a[8:11], v[44:47], v[20:35]
    ds_read_b128 v[40:43], v3 offset:8192
    s_waitcnt lgkmcnt(5)
    v_mfma_f32_32x32x16_bf16 v[20:35], a[12:15], v[48:51], v[20:35]
    buffer_load_dwordx4 v2, s[4:7], s34 offen offset:1024 sc1 lds
    ds_read_b128 v[44:47], v3 offset:9216
    s_waitcnt lgkmcnt(5)
    v_mfma_f32_32x32x16_bf16 v[20:35], a[16:19], v[52:55], v[20:35]
    ds_read_b128 v[48:51], v3 offset:10240
    s_waitcnt lgkmcnt(5)
    v_mfma_f32_32x32x16_bf16 v[20:35], a[20:23], v[56:59], v[20:35]
    ds_read_b128 v[52:55], v3 offset:11264
    s_waitcnt lgkmcnt(5)
    v_mfma_f32_32x32x16_bf16 v[20:35], a[24:27], v[60:63], v[20:35]
    buffer_load_dwordx4 v2, s[4:7], s34 offen offset:2048 sc1 lds
    ds_read_b128 v[56:59], v3 offset:12288
    s_waitcnt lgkmcnt(5)
    v_mfma_f32_32x32x16_bf16 v[20:35], a[28:31], v[36:39], v[20:35]
    ds_read_b128 v[60:63], v3 offset:13312
    s_waitcnt lgkmcnt(5)
    v_mfma_f32_32x32x16_bf16 v[20:35], a[32:35], v[40:43], v[20:35]
    ds_read_b128 v[36:39], v3 offset:14336
    s_waitcnt lgkmcnt(5)
    v_mfma_f32_32x32x16_bf16 v[20:35], a[36:39], v[44:47], v[20:35]
    buffer_load_dwordx4 v2, s[4:7], s34 offen offset:3072 sc1 lds
    ds_read_b128 v[40:43], v3 offset:15360
    s_waitcnt lgkmcnt(5)
    v_mfma_f32_32x32x16_bf16 v[20:35], a[40:43], v[48:51], v[20:35]
    ds_read_b128 v[44:47], v3 offset:16384
    s_waitcnt lgkmcnt(5)
    v_mfma_f32_32x32x16_bf16 v[20:35], a[44:47], v[52:55], v[20:35]
    ds_read_b128 v[48:51], v3 offset:17408
    s_waitcnt lgkmcnt(5)
    v_mfma_f32_32x32x16_bf16 v[20:35], a[48:51], v[56:59], v[20:35]
    s_add_u32 m0, s29, 4096
    s_add_u32 s34, s30, 4096
    buffer_load_dwordx4 v2, s[4:7], s34 offen offset:0 sc1 lds
    ds_read_b128 v[52:55], v3 offset:18432
    s_waitcnt lgkmcnt(5)
    v_mfma_f32_32x32x16_bf16 v[20:35], a[52:55], v[60:63], v[20:35]
    ds_read_b128 v[56:59], v3 offset:19456
    s_waitcnt lgkmcnt(5)
    v_mfma_f32_32x32x16_bf16 v[20:35], a[56:59], v[36:39], v[20:35]
    ds_read_b128 v[60:63], v3 offset:20480
    s_waitcnt lgkmcnt(5)
    v_mfma_f32_32x32x16_bf16 v[20:35], a[60:63], v[40:43], v[20:35]
    buffer_load_dwordx4 v2, s[4:7], s34 offen offset:1024 sc1 lds
    ds_read_b128 v[36:39], v3 offset:21504
    s_waitcnt lgkmcnt(5)
    v_mfma_f32_32x32x16_bf16 v[20:35], a[64:67], v[44:47], v[20:35]
    ds_read_b128 v[40:43], v3 offset:22528
    s_waitcnt lgkmcnt(5)
    v_mfma_f32_32x32x16_bf16 v[20:35], a[68:71], v[48:51], v[20:35]
    ds_read_b128 v[44:47], v3 offset:23552
    s_waitcnt lgkmcnt(5)
    v_mfma_f32_32x32x16_bf16 v[20:35], a[72:75], v[52:55], v[20:35]
    buffer_load_dwordx4 v2, s[4:7], s34 offen offset:2048 sc1 lds
    ds_read_b128 v[48:51], v3 offset:24576
    s_waitcnt lgkmcnt(5)
    v_mfma_f32_32x32x16_bf16 v[20:35], a[76:79], v[56:59], v[20:35]
    ds_read_b128 v[52:55], v3 offset:25600
    s_waitcnt lgkmcnt(5)
    v_mfma_f32_32x32x16_bf16 v[20:35], a[80:83], v[60:63], v[20:35]
    ds_read_b128 v[56:59], v3 offset:26624
    s_waitcnt lgkmcnt(5)
    v_mfma_f32_32x32x16_bf16 v[20:35], a[84:87], v[36:39], v[20:35]
    buffer_load_dwordx4 v2, s[4:7], s34 offen offset:3072 sc1 lds
    ds_read_b128 v[60:63], v3 offset:27648
    s_waitcnt lgkmcnt(5)
    v_mfma_f32_32x32x16_bf16 v[20:35], a[88:91], v[40:43], v[20:35]
    ds_read_b128 v[36:39], v3 offset:28672
    s_waitcnt lgkmcnt(5)
    v_mfma_f32_32x32x16_bf16 v[20:35], a[92:95], v[44:47], v[20:35]
    ds_read_b128 v[40:43], v3 offset:29696
    s_waitcnt lgkmcnt(5)
    v_mfma_f32_32x32x16_bf16 v[20:35], a[96:99], v[48:51], v[20:35]
    s_add_u32 m0, s29, 8192
    s_add_u32 s34, s30, 8192
    buffer_load_dwordx4 v2, s[4:7], s34 offen offset:0 sc1 lds
    ds_read_b128 v[44:47], v3 offset:30720
    s_waitcnt lgkmcnt(5)
    v_mfma_f32_32x32x16_bf16 v[20:35], a[100:103], v[52:55], v[20:35]
    ds_read_b128 v[48:51], v3 offset:31744
    s_waitcnt lgkmcnt(5)
    v_mfma_f32_32x32x16_bf16 v[20:35], a[104:107], v[56:59], v[20:35]
    ds_read_b128 v[52:55], v3 offset:32768
    s_waitcnt lgkmcnt(5)
    v_mfma_f32_32x32x16_bf16 v[20:35], a[108:111], v[60:63], v[20:35]
    buffer_load_dwordx4 v2, s[4:7], s34 offen offset:1024 sc1 lds
    ds_read_b128 v[56:59], v3 offset:33792
    s_waitcnt lgkmcnt(5)
    v_mfma_f32_32x32x16_bf16 v[20:35], a[112:115], v[36:39], v[20:35]
    ds_read_b128 v[60:63], v3 offset:34816
    s_waitcnt lgkmcnt(5)
    v_mfma_f32_32x32x16_bf16 v[20:35], a[116:119], v[40:43], v[20:35]
    ds_read_b128 v[36:39], v3 offset:35840
    s_waitcnt lgkmcnt(5)
    v_mfma_f32_32x32x16_bf16 v[20:35], a[120:123], v[44:47], v[20:35]
    s_add_u32 s30, s30, 40960
    s_add_u32 s29, s29, 40960
    s_sub_u32 s34, s29, 122880
    s_cselect_b32 s29, s29, s34
    ds_read_b128 v[40:43], v3 offset:36864
    s_waitcnt lgkmcnt(5)
    v_mfma_f32_32x32x16_bf16 v[20:35], a[124:127], v[48:51], v[20:35]
    ds_read_b128 v[44:47], v3 offset:37888
    s_waitcnt lgkmcnt(5)
    v_mfma_f32_32x32x16_bf16 v[20:35], a[128:131], v[52:55], v[20:35]
    ds_read_b128 v[48:51], v3 offset:38912
    s_waitcnt lgkmcnt(5)
    v_mfma_f32_32x32x16_bf16 v[20:35], a[132:135], v[56:59], v[20:35]
    ds_read_b128 v[52:55], v3 offset:39936
    s_waitcnt lgkmcnt(5)
    v_mfma_f32_32x32x16_bf16 v[20:35], a[136:139], v[60:63], v[20:35]
    s_waitcnt lgkmcnt(4)
    v_mfma_f32_32x32x16_bf16 v[20:35], a[140:143], v[36:39], v[20:35]
    s_waitcnt lgkmcnt(3)
    v_mfma_f32_32x32x16_bf16 v[20:35], a[144:147], v[40:43], v[20:35]
    s_waitcnt lgkmcnt(2)
    v_mfma_f32_32x32x16_bf16 v[20:35], a[148:151], v[44:47], v[20:35]
    s_waitcnt lgkmcnt(1)
    v_mfma_f32_32x32x16_bf16 v[20:35], a[152:155], v[48:51], v[20:35]
    s_waitcnt lgkmcnt(0)
    v_mfma_f32_32x32x16_bf16 v[20:35], a[156:159], v[52:55], v[20:35]
    s_nop 11
    v_cvt_pk_bf16_f32 v36, v20, v21
    v_cvt_pk_bf16_f32 v37, v22, v23
    v_cvt_pk_bf16_f32 v38, v24, v25
    v_cvt_pk_bf16_f32 v39, v26, v27
    v_cvt_pk_bf16_f32 v40, v28, v29
    v_cvt_pk_bf16_f32 v41, v30, v31
    v_cvt_pk_bf16_f32 v42, v32, v33
    v_cvt_pk_bf16_f32 v43, v34, v35
    ds_write_b128 v4, v[36:39]
    ds_write_b128 v4, v[40:43] offset:1024
    s_waitcnt vmcnt(10) lgkmcnt(0)
    s_barrier
    ds_read_b128 a[208:211], v5 offset:0
    ds_read_b128 a[212:215], v5 offset:2048
    ds_read_b128 a[216:219], v5 offset:4096
    ds_read_b128 a[220:223], v5 offset:6144
    s_waitcnt lgkmcnt(0)
    s_barrier
    v_add_u32 v3, s36, v2
    ds_read_b128 v[36:39], v3 offset:0
    ds_read_b128 v[40:43], v3 offset:1024
    ds_read_b128 v[44:47], v3 offset:2048
    ds_read_b128 v[48:51], v3 offset:3072
    ds_read_b128 v[52:55], v3 offset:4096
    s_add_u32 s36, s36, 40960
    s_cmp_eq_u32 s36, 122880
    s_cselect_b32 s36, 0, s36
    ds_read_b128 v[56:59], v3 offset:5120
    s_waitcnt lgkmcnt(5)
    v_mfma_f32_32x32x16_bf16 v[20:35], a[0:3], v[36:39], 0
    s_add_u32 m0, s29, 0
    s_add_u32 s34, s30, 0
    buffer_load_dwordx4 v2, s[4:7], s34 offen offset:0 sc1 lds
    ds_read_b128 v[60:63], v3 offset:6144
    s_waitcnt lgkmcnt(5)
    v_mfma_f32_32x32x16_bf16 v[20:35], a[4:7], v[40:43], v[20:35]
    ds_read_b128 v[36:39], v3 offset:7168
    s_waitcnt lgkmcnt(5)
    v_mfma_f32_32x32x16_bf16 v[20:35], a[8:11], v[44:47], v[20:35]
    ds_read_b128 v[40:43], v3 offset:8192
    s_waitcnt lgkmcnt(5)
    v_mfma_f32_32x32x16_bf16 v[20:35], a[12:15], v[48:51], v[20:35]
    buffer_load_dwordx4 v2, s[4:7], s34 offen offset:1024 sc1 lds
    ds_read_b128 v[44:47], v3 offset:9216
    s_waitcnt lgkmcnt(5)
    v_mfma_f32_32x32x16_bf16 v[20:35], a[16:19], v[52:55], v[20:35]
    ds_read_b128 v[48:51], v3 offset:10240
    s_waitcnt lgkmcnt(5)
    v_mfma_f32_32x32x16_bf16 v[20:35], a[20:23], v[56:59], v[20:35]
    ds_read_b128 v[52:55], v3 offset:11264
    s_waitcnt lgkmcnt(5)
    v_mfma_f32_32x32x16_bf16 v[20:35], a[24:27], v[60:63], v[20:35]
    buffer_load_dwordx4 v2, s[4:7], s34 offen offset:2048 sc1 lds
    ds_read_b128 v[56:59], v3 offset:12288
    s_waitcnt lgkmcnt(5)
    v_mfma_f32_32x32x16_bf16 v[20:35], a[28:31], v[36:39], v[20:35]
    ds_read_b128 v[60:63], v3 offset:13312
    s_waitcnt lgkmcnt(5)
    v_mfma_f32_32x32x16_bf16 v[20:35], a[32:35], v[40:43], v[20:35]
    ds_read_b128 v[36:39], v3 offset:14336
    s_waitcnt lgkmcnt(5)
    v_mfma_f32_32x32x16_bf16 v[20:35], a[36:39], v[44:47], v[20:35]
    buffer_load_dwordx4 v2, s[4:7], s34 offen offset:3072 sc1 lds
    ds_read_b128 v[40:43], v3 offset:15360
    s_waitcnt lgkmcnt(5)
    v_mfma_f32_32x32x16_bf16 v[20:35], a[40:43], v[48:51], v[20:35]
    ds_read_b128 v[44:47], v3 offset:16384
    s_waitcnt lgkmcnt(5)
    v_mfma_f32_32x32x16_bf16 v[20:35], a[44:47], v[52:55], v[20:35]
    ds_read_b128 v[48:51], v3 offset:17408
    s_waitcnt lgkmcnt(5)
    v_mfma_f32_32x32x16_bf16 v[20:35], a[48:51], v[56:59], v[20:35]
    s_add_u32 m0, s29, 4096
    s_add_u32 s34, s30, 4096
    buffer_load_dwordx4 v2, s[4:7], s34 offen offset:0 sc1 lds
    ds_read_b128 v[52:55], v3 offset:18432
    s_waitcnt lgkmcnt(5)
    v_mfma_f32_32x32x16_bf16 v[20:35], a[52:55], v[60:63], v[20:35]
    ds_read_b128 v[56:59], v3 offset:19456
    s_waitcnt lgkmcnt(5)
    v_mfma_f32_32x32x16_bf16 v[20:35], a[56:59], v[36:39], v[20:35]
    ds_read_b128 v[60:63], v3 offset:20480
    s_waitcnt lgkmcnt(5)
    v_mfma_f32_32x32x16_bf16 v[20:35], a[60:63], v[40:43], v[20:35]
    buffer_load_dwordx4 v2, s[4:7], s34 offen offset:1024 sc1 lds
    ds_read_b128 v[36:39], v3 offset:21504
    s_waitcnt lgkmcnt(5)
    v_mfma_f32_32x32x16_bf16 v[20:35], a[64:67], v[44:47], v[20:35]
    ds_read_b128 v[40:43], v3 offset:22528
    s_waitcnt lgkmcnt(5)
    v_mfma_f32_32x32x16_bf16 v[20:35], a[68:71], v[48:51], v[20:35]
    ds_read_b128 v[44:47], v3 offset:23552
    s_waitcnt lgkmcnt(5)
    v_mfma_f32_32x32x16_bf16 v[20:35], a[72:75], v[52:55], v[20:35]
    buffer_load_dwordx4 v2, s[4:7], s34 offen offset:2048 sc1 lds
    ds_read_b128 v[48:51], v3 offset:24576
    s_waitcnt lgkmcnt(5)
    v_mfma_f32_32x32x16_bf16 v[20:35], a[76:79], v[56:59], v[20:35]
    ds_read_b128 v[52:55], v3 offset:25600
    s_waitcnt lgkmcnt(5)
    v_mfma_f32_32x32x16_bf16 v[20:35], a[80:83], v[60:63], v[20:35]
    ds_read_b128 v[56:59], v3 offset:26624
    s_waitcnt lgkmcnt(5)
    v_mfma_f32_32x32x16_bf16 v[20:35], a[84:87], v[36:39], v[20:35]
    buffer_load_dwordx4 v2, s[4:7], s34 offen offset:3072 sc1 lds
    ds_read_b128 v[60:63], v3 offset:27648
    s_waitcnt lgkmcnt(5)
    v_mfma_f32_32x32x16_bf16 v[20:35], a[88:91], v[40:43], v[20:35]
    ds_read_b128 v[36:39], v3 offset:28672
    s_waitcnt lgkmcnt(5)
    v_mfma_f32_32x32x16_bf16 v[20:35], a[92:95], v[44:47], v[20:35]
    ds_read_b128 v[40:43], v3 offset:29696
    s_waitcnt lgkmcnt(5)
    v_mfma_f32_32x32x16_bf16 v[20:35], a[96:99], v[48:51], v[20:35]
    s_add_u32 m0, s29, 8192
    s_add_u32 s34, s30, 8192
    buffer_load_dwordx4 v2, s[4:7], s34 offen offset:0 sc1 lds
    ds_read_b128 v[44:47], v3 offset:30720
    s_waitcnt lgkmcnt(5)
    v_mfma_f32_32x32x16_bf16 v[20:35], a[100:103], v[52:55], v[20:35]
    ds_read_b128 v[48:51], v3 offset:31744
    s_waitcnt lgkmcnt(5)
    v_mfma_f32_32x32x16_bf16 v[20:35], a[104:107], v[56:59], v[20:35]
    ds_read_b128 v[52:55], v3 offset:32768
    s_waitcnt lgkmcnt(5)
    v_mfma_f32_32x32x16_bf16 v[20:35], a[108:111], v[60:63], v[20:35]
    buffer_load_dwordx4 v2, s[4:7], s34 offen offset:1024 sc1 lds
    ds_read_b128 v[56:59], v3 offset:33792
    s_waitcnt lgkmcnt(5)
    v_mfma_f32_32x32x16_bf16 v[20:35], a[112:115], v[36:39], v[20:35]
    ds_read_b128 v[60:63], v3 offset:34816
    s_waitcnt lgkmcnt(5)
    v_mfma_f32_32x32x16_bf16 v[20:35], a[116:119], v[40:43], v[20:35]
    ds_read_b128 v[36:39], v3 offset:35840
    s_waitcnt lgkmcnt(5)
    v_mfma_f32_32x32x16_bf16 v[20:35], a[120:123], v[44:47], v[20:35]
    s_add_u32 s30, s30, 40960
    s_add_u32 s29, s29, 40960
    s_sub_u32 s34, s29, 122880
    s_cselect_b32 s29, s29, s34
    ds_read_b128 v[40:43], v3 offset:36864
    s_waitcnt lgkmcnt(5)
    v_mfma_f32_32x32x16_bf16 v[20:35], a[124:127], v[48:51], v[20:35]
    ds_read_b128 v[44:47], v3 offset:37888
    s_waitcnt lgkmcnt(5)
    v_mfma_f32_32x32x16_bf16 v[20:35], a[128:131], v[52:55], v[20:35]
    ds_read_b128 v[48:51], v3 offset:38912
    s_waitcnt lgkmcnt(5)
    v_mfma_f32_32x32x16_bf16 v[20:35], a[132:135], v[56:59], v[20:35]
    ds_read_b128 v[52:55], v3 offset:39936
    s_waitcnt lgkmcnt(5)
    v_mfma_f32_32x32x16_bf16 v[20:35], a[136:139], v[60:63], v[20:35]
    s_waitcnt lgkmcnt(4)
    v_mfma_f32_32x32x16_bf16 v[20:35], a[140:143], v[36:39], v[20:35]
    s_waitcnt lgkmcnt(3)
    v_mfma_f32_32x32x16_bf16 v[20:35], a[144:147], v[40:43], v[20:35]
    s_waitcnt lgkmcnt(2)
    v_mfma_f32_32x32x16_bf16 v[20:35], a[148:151], v[44:47], v[20:35]
    s_waitcnt lgkmcnt(1)
    v_mfma_f32_32x32x16_bf16 v[20:35], a[152:155], v[48:51], v[20:35]
    s_waitcnt lgkmcnt(0)
    v_mfma_f32_32x32x16_bf16 v[20:35], a[156:159], v[52:55], v[20:35]
    s_nop 11
    v_cvt_pk_bf16_f32 v36, v20, v21
    v_cvt_pk_bf16_f32 v37, v22, v23
    v_cvt_pk_bf16_f32 v38, v24, v25
    v_cvt_pk_bf16_f32 v39, v26, v27
    v_cvt_pk_bf16_f32 v40, v28, v29
    v_cvt_pk_bf16_f32 v41, v30, v31
    v_cvt_pk_bf16_f32 v42, v32, v33
    v_cvt_pk_bf16_f32 v43, v34, v35
    ds_write_b128 v4, v[36:39]
    ds_write_b128 v4, v[40:43] offset:1024
    s_waitcnt vmcnt(10) lgkmcnt(0)
    s_barrier
    ds_read_b128 v[136:139], v5 offset:0
    ds_read_b128 v[140:143], v5 offset:2048
    ds_read_b128 v[144:147], v5 offset:4096
    ds_read_b128 v[148:151], v5 offset:6144
    s_mov_b64 exec, 3
L_wf_169:
    buffer_load_dword v9, v8, s[4:7], s43 offen sc1
    s_waitcnt vmcnt(0)
    v_cmp_gt_u32 vcc, 1, v9
    s_cbranch_vccz L_wfd_170
    s_sleep 1
    s_sub_u32 s31, s31, 1
    s_cbranch_scc1 L_exit
    s_branch L_wf_169
L_wfd_170:
    s_mov_b64 exec, -1
    s_add_u32 m0, s48, 131328
    s_sub_u32 s45, s37, 896
    buffer_load_dwordx4 v6, s[4:7], s37 offen sc1 lds
    buffer_load_dwordx4 v6, s[4:7], s45 offen offset:1024 sc1 lds
    s_add_u32 s45, s37, 16775168
    buffer_load_dwordx4 v7, s[4:7], s45 offen offset:2048 sc1 lds
    s_add_u32 s45, s37, 16774400
    buffer_load_dwordx4 v7, s[4:7], s45 offen offset:3072 sc1 lds
    v_cmp_gt_u32 vcc, 2, v1
    s_nop 1
    v_cndmask_b32 v198, 1, 2, vcc
    s_waitcnt lgkmcnt(0)
L_qa_171:
    s_cmp_eq_u32 s28, 59
    s_cbranch_scc1 L_qaz_175
    s_add_u32 s41, s28, 1
    s_cbranch_vccz L_qag_172
    s_waitcnt vmcnt(0)
    s_barrier
    s_cmp_lg_u32 s26, 0
    s_cbranch_scc1 L_qan_173
    s_sub_u32 s58, s28, 1
    s_bitcmp1_b64 s[56:57], s58
    s_cselect_b32 s59, 1, 0
    s_bitcmp1_b64 s[54:55], s58
    s_addc_u32 s59, s59, s59
    s_bitcmp1_b64 s[52:53], s58
    s_addc_u32 s59, s59, s59
    s_lshl_b32 s59, s59, 14
    s_add_u32 s59, s59, s33
    s_mov_b64 exec, 1
    v_mov_b32 v9, s28
    buffer_store_dword v9, off, s[4:7], s59 sc1
    s_mov_b64 exec, -1
    s_mov_b64 exec, 15
L_wf_176:
    buffer_load_dword v9, v8, s[4:7], s43 offen sc1
    s_waitcnt vmcnt(0)
    v_cmp_gt_u32 vcc, v198, v9
    s_cbranch_vccz L_wfd_177
    s_sleep 1
    s_sub_u32 s31, s31, 1
    s_cbranch_scc1 L_exit
    s_branch L_wf_176
L_wfd_177:
    s_mov_b64 exec, -1
L_qan_173:
    s_barrier
L_qag_172:
    v_add_u32 v198, 1, v198
    v_add_u32 v3, s36, v2
    ds_read_b128 v[36:39], v3 offset:0
    ds_read_b128 v[40:43], v3 offset:1024
    ds_read_b128 v[44:47], v3 offset:2048
    ds_read_b128 v[48:51], v3 offset:3072
    ds_read_b128 v[52:55], v3 offset:4096
    s_add_u32 s36, s36, 40960
    s_cmp_eq_u32 s36, 122880
    s_cselect_b32 s36, 0, s36
    ds_read_b128 v[56:59], v3 offset:5120
    s_waitcnt lgkmcnt(5)
    v_mfma_f32_32x32x16_bf16 v[20:35], a[0:3], v[36:39], 0
    s_add_u32 m0, s49, 147712
    s_add_u32 s45, s38, s47
    buffer_load_dwordx4 v2, s[4:7], s45 offen sc1 lds
    ds_read_b128 v[60:63], v3 offset:6144
    s_waitcnt lgkmcnt(5)
    v_mfma_f32_32x32x16_bf16 v[20:35], a[4:7], v[40:43], v[20:35]
    ds_read_b128 v[36:39], v3 offset:7168
    s_waitcnt lgkmcnt(5)
    v_mfma_f32_32x32x16_bf16 v[20:35], a[8:11], v[44:47], v[20:35]
    buffer_load_dwordx2 v[128:129], v10, s[4:7], s39 offen offset:0 sc1
    buffer_load_dwordx2 v[130:131], v10, s[4:7], s39 offen offset:512 sc1
    ds_read_b128 v[40:43], v3 offset:8192
    s_waitcnt lgkmcnt(5)
    v_mfma_f32_32x32x16_bf16 v[20:35], a[12:15], v[48:51], v[20:35]
    ds_read_b128 v[44:47], v3 offset:9216
    s_waitcnt lgkmcnt(5)
    v_mfma_f32_32x32x16_bf16 v[20:35], a[16:19], v[52:55], v[20:35]
    buffer_load_dwordx2 v[132:133], v10, s[4:7], s39 offen offset:1024 sc1
    buffer_load_dwordx2 v[134:135], v10, s[4:7], s39 offen offset:1536 sc1
    ds_read_b128 v[48:51], v3 offset:10240
    s_waitcnt lgkmcnt(5)
    v_mfma_f32_32x32x16_bf16 v[20:35], a[20:23], v[56:59], v[20:35]
    ds_read_b128 v[52:55], v3 offset:11264
    s_waitcnt lgkmcnt(5)
    v_mfma_f32_32x32x16_bf16 v[20:35], a[24:27], v[60:63], v[20:35]
    s_add_u32 m0, s29, 0
    s_add_u32 s34, s30, 0
    buffer_load_dwordx4 v2, s[4:7], s34 offen offset:0 sc1 lds
    ds_read_b128 v[56:59], v3 offset:12288
    s_waitcnt lgkmcnt(5)
    v_mfma_f32_32x32x16_bf16 v[20:35], a[28:31], v[36:39], v[20:35]
    ds_read_b128 v[60:63], v3 offset:13312
    s_waitcnt lgkmcnt(5)
    v_mfma_f32_32x32x16_bf16 v[20:35], a[32:35], v[40:43], v[20:35]
    buffer_load_dwordx4 v2, s[4:7], s34 offen offset:1024 sc1 lds
    ds_read_b128 v[36:39], v3 offset:14336
    s_waitcnt lgkmcnt(5)
    v_mfma_f32_32x32x16_bf16 v[20:35], a[36:39], v[44:47], v[20:35]
    ds_read_b128 v[40:43], v3 offset:15360
    s_waitcnt lgkmcnt(5)
    v_mfma_f32_32x32x16_bf16 v[20:35], a[40:43], v[48:51], v[20:35]
    buffer_load_dwordx4 v2, s[4:7], s34 offen offset:2048 sc1 lds
    ds_read_b128 v[44:47], v3 offset:16384
    s_waitcnt lgkmcnt(5)
    v_mfma_f32_32x32x16_bf16 v[20:35], a[44:47], v[52:55], v[20:35]
    ds_read_b128 v[48:51], v3 offset:17408
    s_waitcnt lgkmcnt(5)
    v_mfma_f32_32x32x16_bf16 v[20:35], a[48:51], v[56:59], v[20:35]
    buffer_load_dwordx4 v2, s[4:7], s34 offen offset:3072 sc1 lds
    ds_read_b128 v[52:55], v3 offset:18432
    s_waitcnt lgkmcnt(5)
    v_mfma_f32_32x32x16_bf16 v[20:35], a[52:55], v[60:63], v[20:35]
    ds_read_b128 v[56:59], v3 offset:19456
    s_waitcnt lgkmcnt(5)
    v_mfma_f32_32x32x16_bf16 v[20:35], a[56:59], v[36:39], v[20:35]
    s_add_u32 m0, s29, 4096
    s_add_u32 s34, s30, 4096
    buffer_load_dwordx4 v2, s[4:7], s34 offen offset:0 sc1 lds
    ds_read_b128 v[60:63], v3 offset:20480
    s_waitcnt lgkmcnt(5)
    v_mfma_f32_32x32x16_bf16 v[20:35], a[60:63], v[40:43], v[20:35]
    ds_read_b128 v[36:39], v3 offset:21504
    s_waitcnt lgkmcnt(5)
    v_mfma_f32_32x32x16_bf16 v[20:35], a[64:67], v[44:47], v[20:35]
    buffer_load_dwordx4 v2, s[4:7], s34 offen offset:1024 sc1 lds
    ds_read_b128 v[40:43], v3 offset:22528
    s_waitcnt lgkmcnt(5)
    v_mfma_f32_32x32x16_bf16 v[20:35], a[68:71], v[48:51], v[20:35]
    ds_read_b128 v[44:47], v3 offset:23552
    s_waitcnt lgkmcnt(5)
    v_mfma_f32_32x32x16_bf16 v[20:35], a[72:75], v[52:55], v[20:35]
    buffer_load_dwordx4 v2, s[4:7], s34 offen offset:2048 sc1 lds
    ds_read_b128 v[48:51], v3 offset:24576
    s_waitcnt lgkmcnt(5)
    v_mfma_f32_32x32x16_bf16 v[20:35], a[76:79], v[56:59], v[20:35]
    ds_read_b128 v[52:55], v3 offset:25600
    s_waitcnt lgkmcnt(5)
    v_mfma_f32_32x32x16_bf16 v[20:35], a[80:83], v[60:63], v[20:35]
    buffer_load_dwordx4 v2, s[4:7], s34 offen offset:3072 sc1 lds
    ds_read_b128 v[56:59], v3 offset:26624
    s_waitcnt lgkmcnt(5)
    v_mfma_f32_32x32x16_bf16 v[20:35], a[84:87], v[36:39], v[20:35]
    ds_read_b128 v[60:63], v3 offset:27648
    s_waitcnt lgkmcnt(5)
    v_mfma_f32_32x32x16_bf16 v[20:35], a[88:91], v[40:43], v[20:35]
    s_add_u32 m0, s29, 8192
    s_add_u32 s34, s30, 8192
    buffer_load_dwordx4 v2, s[4:7], s34 offen offset:0 sc1 lds
    ds_read_b128 v[36:39], v3 offset:28672
    s_waitcnt lgkmcnt(5)
    v_mfma_f32_32x32x16_bf16 v[20:35], a[92:95], v[44:47], v[20:35]
    ds_read_b128 v[40:43], v3 offset:29696
    s_waitcnt lgkmcnt(5)
    v_mfma_f32_32x32x16_bf16 v[20:35], a[96:99], v[48:51], v[20:35]
    buffer_load_dwordx4 v2, s[4:7], s34 offen offset:1024 sc1 lds
    ds_read_b128 v[44:47], v3 offset:30720
    s_waitcnt lgkmcnt(5)
    v_mfma_f32_32x32x16_bf16 v[20:35], a[100:103], v[52:55], v[20:35]
    ds_read_b128 v[48:51], v3 offset:31744
    s_waitcnt lgkmcnt(5)
    v_mfma_f32_32x32x16_bf16 v[20:35], a[104:107], v[56:59], v[20:35]
    s_add_u32 s30, s30, 40960
    s_add_u32 s29, s29, 40960
    s_sub_u32 s34, s29, 122880
    s_cselect_b32 s29, s29, s34
    ds_read_b128 v[52:55], v3 offset:32768
    s_waitcnt lgkmcnt(5)
    v_mfma_f32_32x32x16_bf16 v[20:35], a[108:111], v[60:63], v[20:35]
    ds_read_b128 v[56:59], v3 offset:33792
    s_waitcnt lgkmcnt(5)
    v_mfma_f32_32x32x16_bf16 v[20:35], a[112:115], v[36:39], v[20:35]
    ds_read_b128 v[60:63], v3 offset:34816
    s_waitcnt lgkmcnt(5)
    v_mfma_f32_32x32x16_bf16 v[20:35], a[116:119], v[40:43], v[20:35]
    ds_read_b128 v[36:39], v3 offset:35840
    s_waitcnt lgkmcnt(5)
    v_mfma_f32_32x32x16_bf16 v[20:35], a[120:123], v[44:47], v[20:35]
    ds_read_b128 v[40:43], v3 offset:36864
    s_waitcnt lgkmcnt(5)
    v_mfma_f32_32x32x16_bf16 v[20:35], a[124:127], v[48:51], v[20:35]
    ds_read_b128 v[44:47], v3 offset:37888
    s_waitcnt lgkmcnt(5)
    v_mfma_f32_32x32x16_bf16 v[20:35], a[128:131], v[52:55], v[20:35]
    ds_read_b128 v[48:51], v3 offset:38912
    s_waitcnt lgkmcnt(5)
    v_mfma_f32_32x32x16_bf16 v[20:35], a[132:135], v[56:59], v[20:35]
    ds_read_b128 v[52:55], v3 offset:39936
    s_waitcnt lgkmcnt(5)
    v_mfma_f32_32x32x16_bf16 v[20:35], a[136:139], v[60:63], v[20:35]
    s_waitcnt lgkmcnt(4)
    v_mfma_f32_32x32x16_bf16 v[20:35], a[140:143], v[36:39], v[20:35]
    s_waitcnt lgkmcnt(3)
    v_mfma_f32_32x32x16_bf16 v[20:35], a[144:147], v[40:43], v[20:35]
    s_waitcnt lgkmcnt(2)
    v_mfma_f32_32x32x16_bf16 v[20:35], a[148:151], v[44:47], v[20:35]
    s_waitcnt lgkmcnt(1)
    v_mfma_f32_32x32x16_bf16 v[20:35], a[152:155], v[48:51], v[20:35]
    s_cmp_lg_u32 s26, 0
    s_cbranch_scc1 L_qan3_178
    s_mov_b64 exec, 15
    buffer_load_dword v9, v8, s[4:7], s43 offen sc1
    s_mov_b64 exec, -1
L_qan3_178:
    s_waitcnt lgkmcnt(0)
    v_mfma_f32_32x32x16_bf16 v[20:35], a[156:159], v[52:55], v[20:35]
    s_nop 11
    v_cvt_pk_bf16_f32 v36, v20, v21
    v_cvt_pk_bf16_f32 v37, v22, v23
    v_cvt_pk_bf16_f32 v38, v24, v25
    v_cvt_pk_bf16_f32 v39, v26, v27
    v_cvt_pk_bf16_f32 v40, v28, v29
    v_cvt_pk_bf16_f32 v41, v30, v31
    v_cvt_pk_bf16_f32 v42, v32, v33
    v_cvt_pk_bf16_f32 v43, v34, v35
    ds_write_b128 v4, v[36:39]
    ds_write_b128 v4, v[40:43] offset:1024
    s_waitcnt vmcnt(10) lgkmcnt(0)
    s_barrier
    s_cmp_lg_u32 s26, 1
    s_cbranch_scc1 L_qan2_174
    s_sub_u32 s58, s28, 1
    s_bitcmp1_b64 s[56:57], s58
    s_cselect_b32 s59, 1, 0
    s_bitcmp1_b64 s[54:55], s58
    s_addc_u32 s59, s59, s59
    s_bitcmp1_b64 s[52:53], s58
    s_addc_u32 s59, s59, s59
    s_lshl_b32 s59, s59, 14
    s_add_u32 s59, s59, s33
    s_mov_b64 exec, 1
    v_mov_b32 v36, s28
    buffer_store_dword v36, off, s[4:7], s59 sc1
    s_mov_b64 exec, -1
L_qan2_174:
    ds_read_b128 v[64:67], v170 offset:0
    ds_read_b128 v[68:71], v170 offset:1024
    ds_read_b128 v[112:115], v170 offset:16384
    ds_read_b128 v[72:75], v170 offset:4096
    ds_read_b128 v[76:79], v170 offset:5120
    ds_read_b128 v[116:119], v170 offset:17408
    ds_read_b128 v[80:83], v170 offset:8192
    ds_read_b128 v[84:87], v170 offset:9216
    ds_read_b128 v[120:123], v170 offset:18432
    ds_read_b128 v[88:91], v170 offset:12288
    ds_read_b128 v[92:95], v170 offset:13312
    ds_read_b128 v[124:127], v170 offset:19456
    s_waitcnt lgkmcnt(11)
    v_mfma_f32_16x16x32_bf16 v[152:155], v[64:67], v[136:139], v[12:15]
    s_waitcnt lgkmcnt(10)
    v_mfma_f32_16x16x32_bf16 v[156:159], v[68:71], v[136:139], v[16:19]
    s_waitcnt lgkmcnt(9)
    v_mfma_f32_16x16x32_bf16 v[160:163], v[112:115], v[136:139], 0
    v_swap_b32 v129, v130
    s_waitcnt lgkmcnt(8)
    v_mfma_f32_16x16x32_bf16 v[152:155], v[72:75], v[140:143], v[152:155]
    s_waitcnt lgkmcnt(7)
    v_mfma_f32_16x16x32_bf16 v[156:159], v[76:79], v[140:143], v[156:159]
    s_waitcnt lgkmcnt(6)
    v_mfma_f32_16x16x32_bf16 v[160:163], v[116:119], v[140:143], v[160:163]
    v_swap_b32 v133, v134
    s_waitcnt lgkmcnt(5)
    v_mfma_f32_16x16x32_bf16 v[152:155], v[80:83], v[144:147], v[152:155]
    s_waitcnt lgkmcnt(4)
    v_mfma_f32_16x16x32_bf16 v[156:159], v[84:87], v[144:147], v[156:159]
    s_waitcnt lgkmcnt(3)
    v_mfma_f32_16x16x32_bf16 v[160:163], v[120:123], v[144:147], v[160:163]
    s_waitcnt lgkmcnt(2)
    v_mfma_f32_16x16x32_bf16 v[152:155], v[88:91], v[148:151], v[152:155]
    s_waitcnt lgkmcnt(1)
    v_mfma_f32_16x16x32_bf16 v[156:159], v[92:95], v[148:151], v[156:159]
    s_waitcnt lgkmcnt(0)
    v_mfma_f32_16x16x32_bf16 v[160:163], v[124:127], v[148:151], v[160:163]
    ds_read_b128 v[96:99], v171 offset:2048
    ds_read_b128 v[100:103], v171 offset:3072
    ds_read_b128 v[104:107], v171 offset:6144
    ds_read_b128 v[108:111], v171 offset:7168
    s_add_u32 s37, s37, 262144
    s_add_u32 s38, s38, 131072
    s_add_u32 s39, s39, 131072
    ds_read_b128 v[136:139], v5 offset:0
    ds_read_b128 v[140:143], v5 offset:2048
    ds_read_b128 v[144:147], v5 offset:4096
    ds_read_b128 v[148:151], v5 offset:6144
    v_max3_f32 v36, v152, v153, v154
    v_max3_f32 v36, v36, v155, v156
    v_max3_f32 v36, v36, v157, v158
    v_max3_f32 v36, v36, v159, v162
    v_max_f32 v37, v36, v163
    v_max_f32 v36, v36, v163
    s_nop 1
    v_permlane16_swap_b32 v36, v37
    v_max_f32 v38, v36, v37
    v_max_f32 v36, v36, v37
    s_nop 1
    v_permlane32_swap_b32 v36, v38
    v_max_f32 v36, v36, v38
    v_mul_f32 v36, s40, v36
    v_fma_f32 v152, v152, s40, -v36
    v_fma_f32 v153, v153, s40, -v36
    v_fma_f32 v154, v154, s40, -v36
    v_fma_f32 v155, v155, s40, -v36
    v_fma_f32 v156, v156, s40, -v36
    v_fma_f32 v157, v157, s40, -v36
    v_fma_f32 v158, v158, s40, -v36
    v_fma_f32 v159, v159, s40, -v36
    v_fma_f32 v162, v162, s40, -v36
    v_fma_f32 v163, v163, s40, -v36
    s_cmp_lg_u32 s26, 0
    s_cbranch_scc1 L_qaw_179
    s_waitcnt vmcnt(0)
    ds_write_b32 v11, v9
L_qaw_179:
    s_waitcnt lgkmcnt(0)
    s_barrier
    ds_read_b32 v9, v11
    v_exp_f32 v152, v152
    s_add_u32 m0, s48, 131328
    s_sub_u32 s45, s37, 896
    buffer_load_dwordx4 v6, s[4:7], s37 offen sc1 lds
    v_exp_f32 v153, v153
    v_exp_f32 v154, v154
    buffer_load_dwordx4 v6, s[4:7], s45 offen offset:1024 sc1 lds
    v_exp_f32 v155, v155
    v_exp_f32 v156, v156
    s_add_u32 s45, s37, 16775168
    buffer_load_dwordx4 v7, s[4:7], s45 offen offset:2048 sc1 lds
    v_exp_f32 v157, v157
    v_exp_f32 v158, v158
    s_add_u32 s45, s37, 16774400
    buffer_load_dwordx4 v7, s[4:7], s45 offen offset:3072 sc1 lds
    v_exp_f32 v159, v159
    v_exp_f32 v162, v162
    v_exp_f32 v163, v163
    v_cvt_pk_bf16_f32 v164, v152, v153
    v_cvt_pk_bf16_f32 v165, v154, v155
    v_cvt_pk_bf16_f32 v166, v156, v157
    v_cvt_pk_bf16_f32 v167, v158, v159
    v_cvt_pk_bf16_f32 v168, v162, v163
    v_cvt_pk_bf16_f32 v169, v162, v163
    v_mfma_f32_16x16x32_bf16 v[192:195], v[172:175], v[164:167], 0
    v_mfma_f32_16x16x32_bf16 v[176:179], v[96:99], v[164:167], 0
    v_mfma_f32_16x16x32_bf16 v[180:183], v[100:103], v[164:167], 0
    v_mfma_f32_16x16x32_bf16 v[184:187], v[104:107], v[164:167], 0
    v_mfma_f32_16x16x32_bf16 v[188:191], v[108:111], v[164:167], 0
    s_nop 1
    v_mfma_f32_16x16x16_bf16 v[192:195], v[196:197], v[168:169], v[192:195]
    v_mfma_f32_16x16x16_bf16 v[176:179], v[128:129], v[168:169], v[176:179]
    v_mfma_f32_16x16x16_bf16 v[180:183], v[130:131], v[168:169], v[180:183]
    v_mfma_f32_16x16x16_bf16 v[184:187], v[132:133], v[168:169], v[184:187]
    v_mfma_f32_16x16x16_bf16 v[188:191], v[134:135], v[168:169], v[188:191]
    s_waitcnt lgkmcnt(0)
    s_mov_b64 exec, 15
    v_cmp_gt_u32 vcc, v198, v9
    s_mov_b64 exec, -1
    v_rcp_f32 v36, v192
    s_nop 0
    v_pk_mul_f32 v[176:177], v[176:177], v[36:37] op_sel_hi:[1,0]
    v_pk_mul_f32 v[178:179], v[178:179], v[36:37] op_sel_hi:[1,0]
    v_pk_mul_f32 v[180:181], v[180:181], v[36:37] op_sel_hi:[1,0]
    v_pk_mul_f32 v[182:183], v[182:183], v[36:37] op_sel_hi:[1,0]
    v_pk_mul_f32 v[184:185], v[184:185], v[36:37] op_sel_hi:[1,0]
    v_pk_mul_f32 v[186:187], v[186:187], v[36:37] op_sel_hi:[1,0]
    v_pk_mul_f32 v[188:189], v[188:189], v[36:37] op_sel_hi:[1,0]
    v_pk_mul_f32 v[190:191], v[190:191], v[36:37] op_sel_hi:[1,0]
    v_cvt_pk_bf16_f32 v200, v176, v177
    v_cvt_pk_bf16_f32 v201, v178, v179
    v_cvt_pk_bf16_f32 v202, v180, v181
    v_cvt_pk_bf16_f32 v203, v182, v183
    v_cvt_pk_bf16_f32 v204, v184, v185
    v_cvt_pk_bf16_f32 v205, v186, v187
    v_cvt_pk_bf16_f32 v206, v188, v189
    v_cvt_pk_bf16_f32 v207, v190, v191
    buffer_store_dwordx4 v[200:203], v2, s[4:7], s32 offen sc1
    buffer_store_dwordx4 v[204:207], v2, s[4:7], s32 offen offset:1024 sc1
    s_add_u32 s32, s32, 262144
    s_mov_b32 s28, s41
    s_branch L_qa_171
L_qaz_175:
    s_mov_b64 exec, 3
L_wf_180:
    buffer_load_dword v9, v8, s[4:7], s43 offen sc1
    s_waitcnt vmcnt(0)
    v_cmp_gt_u32 vcc, 64, v9
    s_cbranch_vccz L_wfd_181
    s_sleep 1
    s_sub_u32 s31, s31, 1
    s_cbranch_scc1 L_exit
    s_branch L_wf_180
L_wfd_181:
    s_mov_b64 exec, -1
    s_waitcnt lgkmcnt(0)
    s_barrier
    s_cmp_lg_u32 s26, 1
    s_cbranch_scc1 L_qz1_183
    s_sub_u32 s58, s28, 1
    s_bitcmp1_b64 s[56:57], s58
    s_cselect_b32 s59, 1, 0
    s_bitcmp1_b64 s[54:55], s58
    s_addc_u32 s59, s59, s59
    s_bitcmp1_b64 s[52:53], s58
    s_addc_u32 s59, s59, s59
    s_lshl_b32 s59, s59, 14
    s_add_u32 s59, s59, s33
    s_mov_b64 exec, 1
    v_mov_b32 v9, s28
    buffer_store_dword v9, off, s[4:7], s59 sc1
    s_mov_b64 exec, -1
L_qz1_183:
    s_mul_i32 s42, s26, 16384
    v_add_u32 v4, s42, v2
    ds_write_b128 v4, a[160:163] offset:0
    ds_write_b128 v4, a[164:167] offset:1024
    ds_write_b128 v4, a[168:171] offset:2048
    ds_write_b128 v4, a[172:175] offset:3072
    ds_write_b128 v4, a[176:179] offset:4096
    ds_write_b128 v4, a[180:183] offset:5120
    ds_write_b128 v4, a[184:187] offset:6144
    ds_write_b128 v4, a[188:191] offset:7168
    ds_write_b128 v4, a[192:195] offset:8192
    ds_write_b128 v4, a[196:199] offset:9216
    ds_write_b128 v4, a[200:203] offset:10240
    ds_write_b128 v4, a[204:207] offset:11264
    ds_write_b128 v4, a[208:211] offset:12288
    ds_write_b128 v4, a[212:215] offset:13312
    ds_write_b128 v4, a[216:219] offset:14336
    ds_write_b128 v4, a[220:223] offset:15360
    s_mov_b32 s50, 0
L_qz_182:
    s_add_u32 s41, s28, 1
    s_mov_b64 exec, 12
L_wf_187:
    buffer_load_dword v9, v8, s[4:7], s43 offen sc1
    s_waitcnt vmcnt(0)
    v_cmp_gt_u32 vcc, s41, v9
    s_cbranch_vccz L_wfd_188
    s_sub_u32 s31, s31, 1
    s_cbranch_scc1 L_exit
    s_branch L_wf_187
L_wfd_188:
    s_mov_b64 exec, -1
    s_add_u32 m0, s49, 147712
    s_add_u32 s45, s38, s47
    buffer_load_dwordx4 v2, s[4:7], s45 offen sc1 lds
    buffer_load_dwordx2 v[128:129], v10, s[4:7], s39 offen offset:0 sc1
    buffer_load_dwordx2 v[130:131], v10, s[4:7], s39 offen offset:512 sc1
    buffer_load_dwordx2 v[132:133], v10, s[4:7], s39 offen offset:1024 sc1
    buffer_load_dwordx2 v[134:135], v10, s[4:7], s39 offen offset:1536 sc1
    s_cmp_eq_u32 s50, 0
    s_cbranch_scc1 L_qz2_184
    buffer_store_dwordx4 v[200:203], v2, s[4:7], s32 offen sc1
    buffer_store_dwordx4 v[204:207], v2, s[4:7], s32 offen offset:1024 sc1
    s_add_u32 s32, s32, 262144
    s_waitcnt vmcnt(2)
    s_branch L_qz3_185
L_qz2_184:
    s_waitcnt vmcnt(0)
L_qz3_185:
    s_waitcnt lgkmcnt(0)
    s_barrier
    s_add_u32 s48, s48, 131328
    s_xor_b32 s48, s48, 229376
    s_sub_u32 s48, s48, 131328
    s_add_u32 s49, s49, 131328
    s_xor_b32 s49, s49, 229376
    s_sub_u32 s49, s49, 131328
    s_cmp_lg_u32 s26, 1
    s_cbranch_scc1 L_qz4_186
    s_sub_u32 s42, s28, s50
    s_sub_u32 s58, s42, 1
    s_bitcmp1_b64 s[56:57], s58
    s_cselect_b32 s59, 1, 0
    s_bitcmp1_b64 s[54:55], s58
    s_addc_u32 s59, s59, s59
    s_bitcmp1_b64 s[52:53], s58
    s_addc_u32 s59, s59, s59
    s_lshl_b32 s59, s59, 14
    s_add_u32 s59, s59, s33
    s_mov_b64 exec, 1
    v_mov_b32 v9, s42
    buffer_store_dword v9, off, s[4:7], s59 sc1
    s_mov_b64 exec, -1
L_qz4_186:
    ds_read_b128 v[64:67], v170 offset:0
    ds_read_b128 v[68:71], v170 offset:1024
    ds_read_b128 v[112:115], v170 offset:16384
    ds_read_b128 v[72:75], v170 offset:4096
    ds_read_b128 v[76:79], v170 offset:5120
    ds_read_b128 v[116:119], v170 offset:17408
    ds_read_b128 v[80:83], v170 offset:8192
    ds_read_b128 v[84:87], v170 offset:9216
    ds_read_b128 v[120:123], v170 offset:18432
    ds_read_b128 v[88:91], v170 offset:12288
    ds_read_b128 v[92:95], v170 offset:13312
    ds_read_b128 v[124:127], v170 offset:19456
    s_waitcnt lgkmcnt(11)
    v_mfma_f32_16x16x32_bf16 v[152:155], v[64:67], v[136:139], v[12:15]
    s_waitcnt lgkmcnt(10)
    v_mfma_f32_16x16x32_bf16 v[156:159], v[68:71], v[136:139], v[16:19]
    s_waitcnt lgkmcnt(9)
    v_mfma_f32_16x16x32_bf16 v[160:163], v[112:115], v[136:139], 0
    v_swap_b32 v129, v130
    s_waitcnt lgkmcnt(8)
    v_mfma_f32_16x16x32_bf16 v[152:155], v[72:75], v[140:143], v[152:155]
    s_waitcnt lgkmcnt(7)
    v_mfma_f32_16x16x32_bf16 v[156:159], v[76:79], v[140:143], v[156:159]
    s_waitcnt lgkmcnt(6)
    v_mfma_f32_16x16x32_bf16 v[160:163], v[116:119], v[140:143], v[160:163]
    v_swap_b32 v133, v134
    s_waitcnt lgkmcnt(5)
    v_mfma_f32_16x16x32_bf16 v[152:155], v[80:83], v[144:147], v[152:155]
    s_waitcnt lgkmcnt(4)
    v_mfma_f32_16x16x32_bf16 v[156:159], v[84:87], v[144:147], v[156:159]
    s_waitcnt lgkmcnt(3)
    v_mfma_f32_16x16x32_bf16 v[160:163], v[120:123], v[144:147], v[160:163]
    s_waitcnt lgkmcnt(2)
    v_mfma_f32_16x16x32_bf16 v[152:155], v[88:91], v[148:151], v[152:155]
    s_waitcnt lgkmcnt(1)
    v_mfma_f32_16x16x32_bf16 v[156:159], v[92:95], v[148:151], v[156:159]
    s_waitcnt lgkmcnt(0)
    v_mfma_f32_16x16x32_bf16 v[160:163], v[124:127], v[148:151], v[160:163]
    ds_read_b128 v[96:99], v171 offset:2048
    ds_read_b128 v[100:103], v171 offset:3072
    ds_read_b128 v[104:107], v171 offset:6144
    ds_read_b128 v[108:111], v171 offset:7168
    s_add_u32 s37, s37, 262144
    s_add_u32 s38, s38, 131072
    s_add_u32 s39, s39, 131072
    s_add_u32 m0, s48, 131328
    s_sub_u32 s45, s37, 896
    buffer_load_dwordx4 v6, s[4:7], s37 offen sc1 lds
    buffer_load_dwordx4 v6, s[4:7], s45 offen offset:1024 sc1 lds
    s_add_u32 s45, s37, 16775168
    buffer_load_dwordx4 v7, s[4:7], s45 offen offset:2048 sc1 lds
    s_add_u32 s45, s37, 16774400
    buffer_load_dwordx4 v7, s[4:7], s45 offen offset:3072 sc1 lds
    ds_read_b128 v[136:139], v4 offset:0
    ds_read_b128 v[140:143], v4 offset:1024
    ds_read_b128 v[144:147], v4 offset:2048
    ds_read_b128 v[148:151], v4 offset:3072
    v_add_u32 v4, 4096, v4
    v_max3_f32 v36, v152, v153, v154
    v_max3_f32 v36, v36, v155, v156
    v_max3_f32 v36, v36, v157, v158
    v_max3_f32 v36, v36, v159, v162
    v_max_f32 v37, v36, v163
    v_max_f32 v36, v36, v163
    s_nop 1
    v_permlane16_swap_b32 v36, v37
    v_max_f32 v38, v36, v37
    v_max_f32 v36, v36, v37
    s_nop 1
    v_permlane32_swap_b32 v36, v38
    v_max_f32 v36, v36, v38
    v_mul_f32 v36, s40, v36
    v_fma_f32 v152, v152, s40, -v36
    v_fma_f32 v153, v153, s40, -v36
    v_fma_f32 v154, v154, s40, -v36
    v_fma_f32 v155, v155, s40, -v36
    v_fma_f32 v156, v156, s40, -v36
    v_fma_f32 v157, v157, s40, -v36
    v_fma_f32 v158, v158, s40, -v36
    v_fma_f32 v159, v159, s40, -v36
    v_fma_f32 v162, v162, s40, -v36
    v_fma_f32 v163, v163, s40, -v36
    v_exp_f32 v152, v152
    v_exp_f32 v153, v153
    v_exp_f32 v154, v154
    v_exp_f32 v155, v155
    v_exp_f32 v156, v156
    v_exp_f32 v157, v157
    v_exp_f32 v158, v158
    v_exp_f32 v159, v159
    v_exp_f32 v162, v162
    v_exp_f32 v163, v163
    v_cvt_pk_bf16_f32 v164, v152, v153
    v_cvt_pk_bf16_f32 v165, v154, v155
    v_cvt_pk_bf16_f32 v166, v156, v157
    v_cvt_pk_bf16_f32 v167, v158, v159
    v_cvt_pk_bf16_f32 v168, v162, v163
    v_cvt_pk_bf16_f32 v169, v162, v163
    v_mfma_f32_16x16x32_bf16 v[192:195], v[172:175], v[164:167], 0
    s_waitcnt lgkmcnt(7)
    v_mfma_f32_16x16x32_bf16 v[176:179], v[96:99], v[164:167], 0
    s_waitcnt lgkmcnt(6)
    v_mfma_f32_16x16x32_bf16 v[180:183], v[100:103], v[164:167], 0
    s_waitcnt lgkmcnt(5)
    v_mfma_f32_16x16x32_bf16 v[184:187], v[104:107], v[164:167], 0
    s_waitcnt lgkmcnt(4)
    v_mfma_f32_16x16x32_bf16 v[188:191], v[108:111], v[164:167], 0
    v_mfma_f32_16x16x16_bf16 v[192:195], v[196:197], v[168:169], v[192:195]
    v_mfma_f32_16x16x16_bf16 v[176:179], v[128:129], v[168:169], v[176:179]
    v_mfma_f32_16x16x16_bf16 v[180:183], v[130:131], v[168:169], v[180:183]
    s_nop 0
    v_mfma_f32_16x16x16_bf16 v[184:187], v[132:133], v[168:169], v[184:187]
    s_nop 0
    v_mfma_f32_16x16x16_bf16 v[188:191], v[134:135], v[168:169], v[188:191]
    s_nop 1
    v_rcp_f32 v36, v192
    s_nop 0
    v_pk_mul_f32 v[176:177], v[176:177], v[36:37] op_sel_hi:[1,0]
    v_pk_mul_f32 v[178:179], v[178:179], v[36:37] op_sel_hi:[1,0]
    v_pk_mul_f32 v[180:181], v[180:181], v[36:37] op_sel_hi:[1,0]
    v_pk_mul_f32 v[182:183], v[182:183], v[36:37] op_sel_hi:[1,0]
    v_pk_mul_f32 v[184:185], v[184:185], v[36:37] op_sel_hi:[1,0]
    v_pk_mul_f32 v[186:187], v[186:187], v[36:37] op_sel_hi:[1,0]
    v_pk_mul_f32 v[188:189], v[188:189], v[36:37] op_sel_hi:[1,0]
    v_pk_mul_f32 v[190:191], v[190:191], v[36:37] op_sel_hi:[1,0]
    v_cvt_pk_bf16_f32 v200, v176, v177
    v_cvt_pk_bf16_f32 v201, v178, v179
    v_cvt_pk_bf16_f32 v202, v180, v181
    v_cvt_pk_bf16_f32 v203, v182, v183
    v_cvt_pk_bf16_f32 v204, v184, v185
    v_cvt_pk_bf16_f32 v205, v186, v187
    v_cvt_pk_bf16_f32 v206, v188, v189
    v_cvt_pk_bf16_f32 v207, v190, v191
    v_xor_b32 v170, 229376, v170
    v_xor_b32 v171, 229376, v171
    s_mov_b32 s50, 1
    s_mov_b32 s28, s41
    s_cmp_lt_u32 s28, 64
    s_cbranch_scc1 L_qz_182
    buffer_store_dwordx4 v[200:203], v2, s[4:7], s32 offen sc1
    buffer_store_dwordx4 v[204:207], v2, s[4:7], s32 offen offset:1024 sc1
    s_add_u32 s32, s32, 262144
    s_waitcnt vmcnt(0)
    s_barrier
    s_cmp_lg_u32 s26, 0
    s_cbranch_scc1 L_exit
    s_sub_u32 s58, 64, 1
    s_bitcmp1_b64 s[56:57], s58
    s_cselect_b32 s59, 1, 0
    s_bitcmp1_b64 s[54:55], s58
    s_addc_u32 s59, s59, s59
    s_bitcmp1_b64 s[52:53], s58
    s_addc_u32 s59, s59, s59
    s_lshl_b32 s59, s59, 14
    s_add_u32 s59, s59, s33
    s_mov_b64 exec, 1
    v_mov_b32 v9, 64
    buffer_store_dword v9, off, s[4:7], s59 sc1
    s_mov_b64 exec, -1
    s_mov_b32 s58, 62
    s_bitcmp1_b64 s[56:57], s58
    s_cselect_b32 s59, 1, 0
    s_bitcmp1_b64 s[54:55], s58
    s_addc_u32 s59, s59, s59
    s_bitcmp1_b64 s[52:53], s58
    s_addc_u32 s59, s59, s59
    s_lshl_b32 s59, s59, 14
    s_add_u32 s59, s59, s33
    s_mov_b64 exec, 1
    v_mov_b32 v9, 64
    buffer_store_dword v9, off, s[4:7], s59 sc1
    s_mov_b64 exec, -1
    s_branch L_exit
L_team:
    s_sub_u32 s27, s24, 5
    s_lshl_b32 s28, s27, 5
    s_add_u32 s28, s28, s25
    s_sub_u32 s29, s28, 64
    s_sub_u32 s33, s28, 4
    s_cmp_ge_u32 s28, 64
    s_cselect_b32 s29, s29, s33
    s_cmp_ge_u32 s28, 84
    s_cbranch_scc1 L_t2_190
    s_cmp_ge_u32 s28, 64
    s_cbranch_scc1 L_t3_191
    s_and_b32 s39, s28, 31
    s_lshl_b32 s39, s39, 1
    s_lshr_b32 s30, s28, 5
    s_add_u32 s39, s39, s30
    s_load_dwordx2 s[16:17], s[0:1], 0
    v_and_b32 v2, 31, v0
    v_bfe_u32 v3, v0, 5, 1
    v_mul_u32_u24 v4, 1280, v2
    v_lshl_add_u32 v4, v3, 4, v4
    s_mul_i32 s30, s39, 40960
    s_mul_i32 s32, s26, 320
    s_add_u32 s30, s30, s32
    s_waitcnt lgkmcnt(0)
    s_mov_b32 s18, 2621440
    s_mov_b32 s19, 0x20000
    buffer_load_dwordx4 v[160:163], v4, s[16:19], s30 offen offset:0
    buffer_load_dwordx4 v[164:167], v4, s[16:19], s30 offen offset:32
    buffer_load_dwordx4 v[168:171], v4, s[16:19], s30 offen offset:64
    buffer_load_dwordx4 v[172:175], v4, s[16:19], s30 offen offset:96
    buffer_load_dwordx4 v[176:179], v4, s[16:19], s30 offen offset:128
    buffer_load_dwordx4 v[180:183], v4, s[16:19], s30 offen offset:160
    buffer_load_dwordx4 v[184:187], v4, s[16:19], s30 offen offset:192
    buffer_load_dwordx4 v[188:191], v4, s[16:19], s30 offen offset:224
    buffer_load_dwordx4 v[192:195], v4, s[16:19], s30 offen offset:256
    buffer_load_dwordx4 v[196:199], v4, s[16:19], s30 offen offset:288
    s_or_b32 s99, s26, s98
    s_cbranch_scc1 L_ci_195
    s_lshl_b32 s99, s24, 2
    s_lshl_b32 s95, 1, s25
    s_atomic_or s95, s[96:97], s99 glc
L_ci_195:
    v_mov_b32 v8, 0
    v_mov_b32 v9, 0
    s_waitcnt vmcnt(9)
    v_lshlrev_b32 v16, 16, v160
    v_and_b32 v17, 0xffff0000, v160
    v_add_f32 v8, v8, v16
    v_fmac_f32 v9, v16, v16
    v_add_f32 v8, v8, v17
    v_fmac_f32 v9, v17, v17
    v_lshlrev_b32 v18, 16, v161
    v_and_b32 v19, 0xffff0000, v161
    v_add_f32 v8, v8, v18
    v_fmac_f32 v9, v18, v18
    v_add_f32 v8, v8, v19
    v_fmac_f32 v9, v19, v19
    v_lshlrev_b32 v20, 16, v162
    v_and_b32 v21, 0xffff0000, v162
    v_add_f32 v8, v8, v20
    v_fmac_f32 v9, v20, v20
    v_add_f32 v8, v8, v21
    v_fmac_f32 v9, v21, v21
    v_lshlrev_b32 v22, 16, v163
    v_and_b32 v23, 0xffff0000, v163
    v_add_f32 v8, v8, v22
    v_fmac_f32 v9, v22, v22
    v_add_f32 v8, v8, v23
    v_fmac_f32 v9, v23, v23
    s_waitcnt vmcnt(8)
    v_lshlrev_b32 v24, 16, v164
    v_and_b32 v25, 0xffff0000, v164
    v_add_f32 v8, v8, v24
    v_fmac_f32 v9, v24, v24
    v_add_f32 v8, v8, v25
    v_fmac_f32 v9, v25, v25
    v_lshlrev_b32 v26, 16, v165
    v_and_b32 v27, 0xffff0000, v165
    v_add_f32 v8, v8, v26
    v_fmac_f32 v9, v26, v26
    v_add_f32 v8, v8, v27
    v_fmac_f32 v9, v27, v27
    v_lshlrev_b32 v28, 16, v166
    v_and_b32 v29, 0xffff0000, v166
    v_add_f32 v8, v8, v28
    v_fmac_f32 v9, v28, v28
    v_add_f32 v8, v8, v29
    v_fmac_f32 v9, v29, v29
    v_lshlrev_b32 v30, 16, v167
    v_and_b32 v31, 0xffff0000, v167
    v_add_f32 v8, v8, v30
    v_fmac_f32 v9, v30, v30
    v_add_f32 v8, v8, v31
    v_fmac_f32 v9, v31, v31
    s_waitcnt vmcnt(7)
    v_lshlrev_b32 v32, 16, v168
    v_and_b32 v33, 0xffff0000, v168
    v_add_f32 v8, v8, v32
    v_fmac_f32 v9, v32, v32
    v_add_f32 v8, v8, v33
    v_fmac_f32 v9, v33, v33
    v_lshlrev_b32 v34, 16, v169
    v_and_b32 v35, 0xffff0000, v169
    v_add_f32 v8, v8, v34
    v_fmac_f32 v9, v34, v34
    v_add_f32 v8, v8, v35
    v_fmac_f32 v9, v35, v35
    v_lshlrev_b32 v36, 16, v170
    v_and_b32 v37, 0xffff0000, v170
    v_add_f32 v8, v8, v36
    v_fmac_f32 v9, v36, v36
    v_add_f32 v8, v8, v37
    v_fmac_f32 v9, v37, v37
    v_lshlrev_b32 v38, 16, v171
    v_and_b32 v39, 0xffff0000, v171
    v_add_f32 v8, v8, v38
    v_fmac_f32 v9, v38, v38
    v_add_f32 v8, v8, v39
    v_fmac_f32 v9, v39, v39
    s_waitcnt vmcnt(6)
    v_lshlrev_b32 v40, 16, v172
    v_and_b32 v41, 0xffff0000, v172
    v_add_f32 v8, v8, v40
    v_fmac_f32 v9, v40, v40
    v_add_f32 v8, v8, v41
    v_fmac_f32 v9, v41, v41
    v_lshlrev_b32 v42, 16, v173
    v_and_b32 v43, 0xffff0000, v173
    v_add_f32 v8, v8, v42
    v_fmac_f32 v9, v42, v42
    v_add_f32 v8, v8, v43
    v_fmac_f32 v9, v43, v43
    v_lshlrev_b32 v44, 16, v174
    v_and_b32 v45, 0xffff0000, v174
    v_add_f32 v8, v8, v44
    v_fmac_f32 v9, v44, v44
    v_add_f32 v8, v8, v45
    v_fmac_f32 v9, v45, v45
    v_lshlrev_b32 v46, 16, v175
    v_and_b32 v47, 0xffff0000, v175
    v_add_f32 v8, v8, v46
    v_fmac_f32 v9, v46, v46
    v_add_f32 v8, v8, v47
    v_fmac_f32 v9, v47, v47
    s_waitcnt vmcnt(5)
    v_lshlrev_b32 v48, 16, v176
    v_and_b32 v49, 0xffff0000, v176
    v_add_f32 v8, v8, v48
    v_fmac_f32 v9, v48, v48
    v_add_f32 v8, v8, v49
    v_fmac_f32 v9, v49, v49
    v_lshlrev_b32 v50, 16, v177
    v_and_b32 v51, 0xffff0000, v177
    v_add_f32 v8, v8, v50
    v_fmac_f32 v9, v50, v50
    v_add_f32 v8, v8, v51
    v_fmac_f32 v9, v51, v51
    v_lshlrev_b32 v52, 16, v178
    v_and_b32 v53, 0xffff0000, v178
    v_add_f32 v8, v8, v52
    v_fmac_f32 v9, v52, v52
    v_add_f32 v8, v8, v53
    v_fmac_f32 v9, v53, v53
    v_lshlrev_b32 v54, 16, v179
    v_and_b32 v55, 0xffff0000, v179
    v_add_f32 v8, v8, v54
    v_fmac_f32 v9, v54, v54
    v_add_f32 v8, v8, v55
    v_fmac_f32 v9, v55, v55
    s_waitcnt vmcnt(4)
    v_lshlrev_b32 v56, 16, v180
    v_and_b32 v57, 0xffff0000, v180
    v_add_f32 v8, v8, v56
    v_fmac_f32 v9, v56, v56
    v_add_f32 v8, v8, v57
    v_fmac_f32 v9, v57, v57
    v_lshlrev_b32 v58, 16, v181
    v_and_b32 v59, 0xffff0000, v181
    v_add_f32 v8, v8, v58
    v_fmac_f32 v9, v58, v58
    v_add_f32 v8, v8, v59
    v_fmac_f32 v9, v59, v59
    v_lshlrev_b32 v60, 16, v182
    v_and_b32 v61, 0xffff0000, v182
    v_add_f32 v8, v8, v60
    v_fmac_f32 v9, v60, v60
    v_add_f32 v8, v8, v61
    v_fmac_f32 v9, v61, v61
    v_lshlrev_b32 v62, 16, v183
    v_and_b32 v63, 0xffff0000, v183
    v_add_f32 v8, v8, v62
    v_fmac_f32 v9, v62, v62
    v_add_f32 v8, v8, v63
    v_fmac_f32 v9, v63, v63
    s_waitcnt vmcnt(3)
    v_lshlrev_b32 v64, 16, v184
    v_and_b32 v65, 0xffff0000, v184
    v_add_f32 v8, v8, v64
    v_fmac_f32 v9, v64, v64
    v_add_f32 v8, v8, v65
    v_fmac_f32 v9, v65, v65
    v_lshlrev_b32 v66, 16, v185
    v_and_b32 v67, 0xffff0000, v185
    v_add_f32 v8, v8, v66
    v_fmac_f32 v9, v66, v66
    v_add_f32 v8, v8, v67
    v_fmac_f32 v9, v67, v67
    v_lshlrev_b32 v68, 16, v186
    v_and_b32 v69, 0xffff0000, v186
    v_add_f32 v8, v8, v68
    v_fmac_f32 v9, v68, v68
    v_add_f32 v8, v8, v69
    v_fmac_f32 v9, v69, v69
    v_lshlrev_b32 v70, 16, v187
    v_and_b32 v71, 0xffff0000, v187
    v_add_f32 v8, v8, v70
    v_fmac_f32 v9, v70, v70
    v_add_f32 v8, v8, v71
    v_fmac_f32 v9, v71, v71
    s_waitcnt vmcnt(2)
    v_lshlrev_b32 v72, 16, v188
    v_and_b32 v73, 0xffff0000, v188
    v_add_f32 v8, v8, v72
    v_fmac_f32 v9, v72, v72
    v_add_f32 v8, v8, v73
    v_fmac_f32 v9, v73, v73
    v_lshlrev_b32 v74, 16, v189
    v_and_b32 v75, 0xffff0000, v189
    v_add_f32 v8, v8, v74
    v_fmac_f32 v9, v74, v74
    v_add_f32 v8, v8, v75
    v_fmac_f32 v9, v75, v75
    v_lshlrev_b32 v76, 16, v190
    v_and_b32 v77, 0xffff0000, v190
    v_add_f32 v8, v8, v76
    v_fmac_f32 v9, v76, v76
    v_add_f32 v8, v8, v77
    v_fmac_f32 v9, v77, v77
    v_lshlrev_b32 v78, 16, v191
    v_and_b32 v79, 0xffff0000, v191
    v_add_f32 v8, v8, v78
    v_fmac_f32 v9, v78, v78
    v_add_f32 v8, v8, v79
    v_fmac_f32 v9, v79, v79
    s_waitcnt vmcnt(1)
    v_lshlrev_b32 v80, 16, v192
    v_and_b32 v81, 0xffff0000, v192
    v_add_f32 v8, v8, v80
    v_fmac_f32 v9, v80, v80
    v_add_f32 v8, v8, v81
    v_fmac_f32 v9, v81, v81
    v_lshlrev_b32 v82, 16, v193
    v_and_b32 v83, 0xffff0000, v193
    v_add_f32 v8, v8, v82
    v_fmac_f32 v9, v82, v82
    v_add_f32 v8, v8, v83
    v_fmac_f32 v9, v83, v83
    v_lshlrev_b32 v84, 16, v194
    v_and_b32 v85, 0xffff0000, v194
    v_add_f32 v8, v8, v84
    v_fmac_f32 v9, v84, v84
    v_add_f32 v8, v8, v85
    v_fmac_f32 v9, v85, v85
    v_lshlrev_b32 v86, 16, v195
    v_and_b32 v87, 0xffff0000, v195
    v_add_f32 v8, v8, v86
    v_fmac_f32 v9, v86, v86
    v_add_f32 v8, v8, v87
    v_fmac_f32 v9, v87, v87
    s_waitcnt vmcnt(0)
    v_lshlrev_b32 v88, 16, v196
    v_and_b32 v89, 0xffff0000, v196
    v_add_f32 v8, v8, v88
    v_fmac_f32 v9, v88, v88
    v_add_f32 v8, v8, v89
    v_fmac_f32 v9, v89, v89
    v_lshlrev_b32 v90, 16, v197
    v_and_b32 v91, 0xffff0000, v197
    v_add_f32 v8, v8, v90
    v_fmac_f32 v9, v90, v90
    v_add_f32 v8, v8, v91
    v_fmac_f32 v9, v91, v91
    v_lshlrev_b32 v92, 16, v198
    v_and_b32 v93, 0xffff0000, v198
    v_add_f32 v8, v8, v92
    v_fmac_f32 v9, v92, v92
    v_add_f32 v8, v8, v93
    v_fmac_f32 v9, v93, v93
    v_lshlrev_b32 v94, 16, v199
    v_and_b32 v95, 0xffff0000, v199
    v_add_f32 v8, v8, v94
    v_fmac_f32 v9, v94, v94
    v_add_f32 v8, v8, v95
    v_fmac_f32 v9, v95, v95
    v_and_b32 v2, 31, v0
    v_lshrrev_b32 v3, 5, v0
    v_lshlrev_b32 v4, 6, v2
    v_lshl_add_u32 v5, v3, 3, v4
    ds_write_b64 v5, v[8:9] offset:8192
    s_waitcnt lgkmcnt(0)
    s_barrier
    ds_read_b128 v[96:99], v4 offset:8192
    ds_read_b128 v[100:103], v4 offset:8208
    ds_read_b128 v[104:107], v4 offset:8224
    ds_read_b128 v[108:111], v4 offset:8240
    s_waitcnt lgkmcnt(0)
    v_add_f32 v96, v96, v104
    v_add_f32 v97, v97, v105
    v_add_f32 v98, v98, v106
    v_add_f32 v99, v99, v107
    v_add_f32 v100, v100, v108
    v_add_f32 v101, v101, v109
    v_add_f32 v102, v102, v110
    v_add_f32 v103, v103, v111
    v_add_f32 v96, v96, v100
    v_add_f32 v97, v97, v101
    v_add_f32 v98, v98, v102
    v_add_f32 v99, v99, v103
    v_add_f32 v96, v96, v98
    v_add_f32 v97, v97, v99
    v_mul_f32 v96, 986500301, v96
    v_mul_f32 v97, 986500301, v97
    v_fma_f32 v97, -v96, v96, v97
    v_max_f32 v97, 0, v97
    v_add_f32 v97, 925353388, v97
    v_rsq_f32 v97, v97
    s_nop 0
    v_mul_f32 v96, v96, v97
    v_fma_f32 v16, v16, v97, -v96
    v_fma_f32 v17, v17, v97, -v96
    v_fma_f32 v18, v18, v97, -v96
    v_fma_f32 v19, v19, v97, -v96
    v_fma_f32 v20, v20, v97, -v96
    v_fma_f32 v21, v21, v97, -v96
    v_fma_f32 v22, v22, v97, -v96
    v_fma_f32 v23, v23, v97, -v96
    v_fma_f32 v24, v24, v97, -v96
    v_fma_f32 v25, v25, v97, -v96
    v_fma_f32 v26, v26, v97, -v96
    v_fma_f32 v27, v27, v97, -v96
    v_fma_f32 v28, v28, v97, -v96
    v_fma_f32 v29, v29, v97, -v96
    v_fma_f32 v30, v30, v97, -v96
    v_fma_f32 v31, v31, v97, -v96
    v_fma_f32 v32, v32, v97, -v96
    v_fma_f32 v33, v33, v97, -v96
    v_fma_f32 v34, v34, v97, -v96
    v_fma_f32 v35, v35, v97, -v96
    v_fma_f32 v36, v36, v97, -v96
    v_fma_f32 v37, v37, v97, -v96
    v_fma_f32 v38, v38, v97, -v96
    v_fma_f32 v39, v39, v97, -v96
    v_fma_f32 v40, v40, v97, -v96
    v_fma_f32 v41, v41, v97, -v96
    v_fma_f32 v42, v42, v97, -v96
    v_fma_f32 v43, v43, v97, -v96
    v_fma_f32 v44, v44, v97, -v96
    v_fma_f32 v45, v45, v97, -v96
    v_fma_f32 v46, v46, v97, -v96
    v_fma_f32 v47, v47, v97, -v96
    v_fma_f32 v48, v48, v97, -v96
    v_fma_f32 v49, v49, v97, -v96
    v_fma_f32 v50, v50, v97, -v96
    v_fma_f32 v51, v51, v97, -v96
    v_fma_f32 v52, v52, v97, -v96
    v_fma_f32 v53, v53, v97, -v96
    v_fma_f32 v54, v54, v97, -v96
    v_fma_f32 v55, v55, v97, -v96
    v_fma_f32 v56, v56, v97, -v96
    v_fma_f32 v57, v57, v97, -v96
    v_fma_f32 v58, v58, v97, -v96
    v_fma_f32 v59, v59, v97, -v96
    v_fma_f32 v60, v60, v97, -v96
    v_fma_f32 v61, v61, v97, -v96
    v_fma_f32 v62, v62, v97, -v96
    v_fma_f32 v63, v63, v97, -v96
    v_fma_f32 v64, v64, v97, -v96
    v_fma_f32 v65, v65, v97, -v96
    v_fma_f32 v66, v66, v97, -v96
    v_fma_f32 v67, v67, v97, -v96
    v_fma_f32 v68, v68, v97, -v96
    v_fma_f32 v69, v69, v97, -v96
    v_fma_f32 v70, v70, v97, -v96
    v_fma_f32 v71, v71, v97, -v96
    v_fma_f32 v72, v72, v97, -v96
    v_fma_f32 v73, v73, v97, -v96
    v_fma_f32 v74, v74, v97, -v96
    v_fma_f32 v75, v75, v97, -v96
    v_fma_f32 v76, v76, v97, -v96
    v_fma_f32 v77, v77, v97, -v96
    v_fma_f32 v78, v78, v97, -v96
    v_fma_f32 v79, v79, v97, -v96
    v_fma_f32 v80, v80, v97, -v96
    v_fma_f32 v81, v81, v97, -v96
    v_fma_f32 v82, v82, v97, -v96
    v_fma_f32 v83, v83, v97, -v96
    v_fma_f32 v84, v84, v97, -v96
    v_fma_f32 v85, v85, v97, -v96
    v_fma_f32 v86, v86, v97, -v96
    v_fma_f32 v87, v87, v97, -v96
    v_fma_f32 v88, v88, v97, -v96
    v_fma_f32 v89, v89, v97, -v96
    v_fma_f32 v90, v90, v97, -v96
    v_fma_f32 v91, v91, v97, -v96
    v_fma_f32 v92, v92, v97, -v96
    v_fma_f32 v93, v93, v97, -v96
    v_fma_f32 v94, v94, v97, -v96
    v_fma_f32 v95, v95, v97, -v96
    s_cmp_lg_u32 s98, 0
    s_cbranch_scc1 L_cc_196
    v_mov_b32 v254, 163832
    s_cmp_lg_u32 s26, 0
    s_cbranch_scc1 L_ccw_197
    s_waitcnt lgkmcnt(0)
    v_mov_b32 v255, s95
    ds_write_b32 v254, v255
    s_waitcnt lgkmcnt(0)
L_ccw_197:
    s_barrier
    ds_read_b32 v255, v254
    s_waitcnt lgkmcnt(0)
    v_readfirstlane_b32 s99, v255
    s_barrier
    s_bitcmp1_b32 s99, s25
    s_cbranch_scc1 L_reclaim
L_cc_196:
    v_mbcnt_lo_u32_b32 v10, -1, 0
    v_lshlrev_b32 v10, 2, v10
    s_mov_b64 exec, 2
L_gs_198:
    global_load_dword v11, v10, s[96:97] offset:128 sc1
    s_waitcnt vmcnt(0)
    v_cmp_eq_u32 vcc, 0, v11
    s_cbranch_vccz L_gsd_199
    s_sleep 1
    s_sub_u32 s31, s31, 1
    s_cbranch_scc1 L_exit
    s_branch L_gs_198
L_gsd_199:
    s_mov_b64 exec, -1
    v_and_b32 v2, 63, v0
    v_lshlrev_b32 v10, 4, v2
    s_mul_i32 s30, s26, 640
    s_add_u32 s30, s30, 3670016
    s_add_u32 s32, s30, 1536
    s_lshl_b32 s33, s26, 11
    s_add_u32 m0, s33, 16384
    v_bfe_u32 v3, v0, 5, 1
    v_lshlrev_b32 v3, 5, v3
    buffer_load_dwordx4 v10, s[4:7], s30 offen sc1 lds
    buffer_load_dwordx4 v10, s[4:7], s32 offen offset:1024 sc1 lds
    v_add_u32 v3, s33, v3
    s_mul_i32 s30, s39, 40960
    s_mul_i32 s32, s26, 10240
    s_add_u32 s30, s30, s32
    s_add_u32 s30, s30, 4194304
    s_waitcnt vmcnt(0)
    ds_read_b128 v[96:99], v3 offset:16384
    ds_read_b128 v[104:107], v3 offset:17408
    ds_read_b128 v[100:103], v3 offset:16400
    ds_read_b128 v[108:111], v3 offset:17424
    ds_read_b128 v[112:115], v3 offset:16448
    ds_read_b128 v[120:123], v3 offset:17472
    ds_read_b128 v[116:119], v3 offset:16464
    ds_read_b128 v[124:127], v3 offset:17488
    s_waitcnt lgkmcnt(4)
    v_fma_f32 v16, v16, v104, v96
    v_fma_f32 v17, v17, v105, v97
    v_fma_f32 v18, v18, v106, v98
    v_fma_f32 v19, v19, v107, v99
    v_fma_f32 v20, v20, v108, v100
    v_fma_f32 v21, v21, v109, v101
    v_fma_f32 v22, v22, v110, v102
    v_fma_f32 v23, v23, v111, v103
    v_cvt_pk_bf16_f32 v160, v16, v17
    v_cvt_pk_bf16_f32 v161, v18, v19
    v_cvt_pk_bf16_f32 v162, v20, v21
    v_cvt_pk_bf16_f32 v163, v22, v23
    ds_read_b128 v[96:99], v3 offset:16512
    ds_read_b128 v[104:107], v3 offset:17536
    ds_read_b128 v[100:103], v3 offset:16528
    ds_read_b128 v[108:111], v3 offset:17552
    s_waitcnt lgkmcnt(4)
    v_fma_f32 v24, v24, v120, v112
    v_fma_f32 v25, v25, v121, v113
    v_fma_f32 v26, v26, v122, v114
    v_fma_f32 v27, v27, v123, v115
    v_fma_f32 v28, v28, v124, v116
    v_fma_f32 v29, v29, v125, v117
    v_fma_f32 v30, v30, v126, v118
    v_fma_f32 v31, v31, v127, v119
    v_cvt_pk_bf16_f32 v164, v24, v25
    v_cvt_pk_bf16_f32 v165, v26, v27
    v_cvt_pk_bf16_f32 v166, v28, v29
    v_cvt_pk_bf16_f32 v167, v30, v31
    ds_read_b128 v[112:115], v3 offset:16576
    ds_read_b128 v[120:123], v3 offset:17600
    ds_read_b128 v[116:119], v3 offset:16592
    ds_read_b128 v[124:127], v3 offset:17616
    s_waitcnt lgkmcnt(4)
    v_fma_f32 v32, v32, v104, v96
    v_fma_f32 v33, v33, v105, v97
    v_fma_f32 v34, v34, v106, v98
    v_fma_f32 v35, v35, v107, v99
    v_fma_f32 v36, v36, v108, v100
    v_fma_f32 v37, v37, v109, v101
    v_fma_f32 v38, v38, v110, v102
    v_fma_f32 v39, v39, v111, v103
    v_cvt_pk_bf16_f32 v168, v32, v33
    v_cvt_pk_bf16_f32 v169, v34, v35
    v_cvt_pk_bf16_f32 v170, v36, v37
    v_cvt_pk_bf16_f32 v171, v38, v39
    ds_read_b128 v[96:99], v3 offset:16640
    ds_read_b128 v[104:107], v3 offset:17664
    ds_read_b128 v[100:103], v3 offset:16656
    ds_read_b128 v[108:111], v3 offset:17680
    s_waitcnt lgkmcnt(4)
    v_fma_f32 v40, v40, v120, v112
    v_fma_f32 v41, v41, v121, v113
    v_fma_f32 v42, v42, v122, v114
    v_fma_f32 v43, v43, v123, v115
    v_fma_f32 v44, v44, v124, v116
    v_fma_f32 v45, v45, v125, v117
    v_fma_f32 v46, v46, v126, v118
    v_fma_f32 v47, v47, v127, v119
    v_cvt_pk_bf16_f32 v172, v40, v41
    v_cvt_pk_bf16_f32 v173, v42, v43
    v_cvt_pk_bf16_f32 v174, v44, v45
    v_cvt_pk_bf16_f32 v175, v46, v47
    ds_read_b128 v[112:115], v3 offset:16704
    ds_read_b128 v[120:123], v3 offset:17728
    ds_read_b128 v[116:119], v3 offset:16720
    ds_read_b128 v[124:127], v3 offset:17744
    s_waitcnt lgkmcnt(4)
    v_fma_f32 v48, v48, v104, v96
    v_fma_f32 v49, v49, v105, v97
    v_fma_f32 v50, v50, v106, v98
    v_fma_f32 v51, v51, v107, v99
    v_fma_f32 v52, v52, v108, v100
    v_fma_f32 v53, v53, v109, v101
    v_fma_f32 v54, v54, v110, v102
    v_fma_f32 v55, v55, v111, v103
    v_cvt_pk_bf16_f32 v176, v48, v49
    v_cvt_pk_bf16_f32 v177, v50, v51
    v_cvt_pk_bf16_f32 v178, v52, v53
    v_cvt_pk_bf16_f32 v179, v54, v55
    ds_read_b128 v[96:99], v3 offset:16768
    ds_read_b128 v[104:107], v3 offset:17792
    ds_read_b128 v[100:103], v3 offset:16784
    ds_read_b128 v[108:111], v3 offset:17808
    s_waitcnt lgkmcnt(4)
    v_fma_f32 v56, v56, v120, v112
    v_fma_f32 v57, v57, v121, v113
    v_fma_f32 v58, v58, v122, v114
    v_fma_f32 v59, v59, v123, v115
    v_fma_f32 v60, v60, v124, v116
    v_fma_f32 v61, v61, v125, v117
    v_fma_f32 v62, v62, v126, v118
    v_fma_f32 v63, v63, v127, v119
    v_cvt_pk_bf16_f32 v180, v56, v57
    v_cvt_pk_bf16_f32 v181, v58, v59
    v_cvt_pk_bf16_f32 v182, v60, v61
    v_cvt_pk_bf16_f32 v183, v62, v63
    ds_read_b128 v[112:115], v3 offset:16832
    ds_read_b128 v[120:123], v3 offset:17856
    ds_read_b128 v[116:119], v3 offset:16848
    ds_read_b128 v[124:127], v3 offset:17872
    s_waitcnt lgkmcnt(4)
    v_fma_f32 v64, v64, v104, v96
    v_fma_f32 v65, v65, v105, v97
    v_fma_f32 v66, v66, v106, v98
    v_fma_f32 v67, v67, v107, v99
    v_fma_f32 v68, v68, v108, v100
    v_fma_f32 v69, v69, v109, v101
    v_fma_f32 v70, v70, v110, v102
    v_fma_f32 v71, v71, v111, v103
    v_cvt_pk_bf16_f32 v184, v64, v65
    v_cvt_pk_bf16_f32 v185, v66, v67
    v_cvt_pk_bf16_f32 v186, v68, v69
    v_cvt_pk_bf16_f32 v187, v70, v71
    ds_read_b128 v[96:99], v3 offset:16896
    ds_read_b128 v[104:107], v3 offset:17920
    ds_read_b128 v[100:103], v3 offset:16912
    ds_read_b128 v[108:111], v3 offset:17936
    s_waitcnt lgkmcnt(4)
    v_fma_f32 v72, v72, v120, v112
    v_fma_f32 v73, v73, v121, v113
    v_fma_f32 v74, v74, v122, v114
    v_fma_f32 v75, v75, v123, v115
    v_fma_f32 v76, v76, v124, v116
    v_fma_f32 v77, v77, v125, v117
    v_fma_f32 v78, v78, v126, v118
    v_fma_f32 v79, v79, v127, v119
    v_cvt_pk_bf16_f32 v188, v72, v73
    v_cvt_pk_bf16_f32 v189, v74, v75
    v_cvt_pk_bf16_f32 v190, v76, v77
    v_cvt_pk_bf16_f32 v191, v78, v79
    ds_read_b128 v[112:115], v3 offset:16960
    ds_read_b128 v[120:123], v3 offset:17984
    ds_read_b128 v[116:119], v3 offset:16976
    ds_read_b128 v[124:127], v3 offset:18000
    s_waitcnt lgkmcnt(4)
    v_fma_f32 v80, v80, v104, v96
    v_fma_f32 v81, v81, v105, v97
    v_fma_f32 v82, v82, v106, v98
    v_fma_f32 v83, v83, v107, v99
    v_fma_f32 v84, v84, v108, v100
    v_fma_f32 v85, v85, v109, v101
    v_fma_f32 v86, v86, v110, v102
    v_fma_f32 v87, v87, v111, v103
    v_cvt_pk_bf16_f32 v192, v80, v81
    v_cvt_pk_bf16_f32 v193, v82, v83
    v_cvt_pk_bf16_f32 v194, v84, v85
    v_cvt_pk_bf16_f32 v195, v86, v87
    s_waitcnt lgkmcnt(0)
    v_fma_f32 v88, v88, v120, v112
    v_fma_f32 v89, v89, v121, v113
    v_fma_f32 v90, v90, v122, v114
    v_fma_f32 v91, v91, v123, v115
    v_fma_f32 v92, v92, v124, v116
    v_fma_f32 v93, v93, v125, v117
    v_fma_f32 v94, v94, v126, v118
    v_fma_f32 v95, v95, v127, v119
    v_cvt_pk_bf16_f32 v196, v88, v89
    v_cvt_pk_bf16_f32 v197, v90, v91
    v_cvt_pk_bf16_f32 v198, v92, v93
    v_cvt_pk_bf16_f32 v199, v94, v95
    s_cmp_lt_u32 s39, 6
    s_cbranch_scc1 L_lnh_200
    v_mbcnt_lo_u32_b32 v12, -1, 0
    v_lshlrev_b32 v12, 2, v12
    s_mov_b64 exec, 128
L_gs_201:
    global_load_dword v13, v12, s[96:97] offset:128 sc1
    s_waitcnt vmcnt(0)
    v_cmp_eq_u32 vcc, 0, v13
    s_cbranch_vccz L_gsd_202
    s_sleep 2
    s_sub_u32 s31, s31, 1
    s_cbranch_scc1 L_exit
    s_branch L_gs_201
L_gsd_202:
    s_mov_b64 exec, -1
L_lnh_200:
    buffer_store_dwordx4 v[160:163], v10, s[4:7], s30 offen offset:0 sc1
    buffer_store_dwordx4 v[164:167], v10, s[4:7], s30 offen offset:1024 sc1
    buffer_store_dwordx4 v[168:171], v10, s[4:7], s30 offen offset:2048 sc1
    buffer_store_dwordx4 v[172:175], v10, s[4:7], s30 offen offset:3072 sc1
    s_add_u32 s30, s30, 4096
    buffer_store_dwordx4 v[176:179], v10, s[4:7], s30 offen offset:0 sc1
    buffer_store_dwordx4 v[180:183], v10, s[4:7], s30 offen offset:1024 sc1
    buffer_store_dwordx4 v[184:187], v10, s[4:7], s30 offen offset:2048 sc1
    buffer_store_dwordx4 v[188:191], v10, s[4:7], s30 offen offset:3072 sc1
    s_add_u32 s30, s30, 4096
    buffer_store_dwordx4 v[192:195], v10, s[4:7], s30 offen offset:0 sc1
    buffer_store_dwordx4 v[196:199], v10, s[4:7], s30 offen offset:1024 sc1
    s_waitcnt vmcnt(0)
    s_barrier
    s_cmp_lg_u32 s26, 0
    s_cbranch_scc1 L_lnf_203
    s_cmp_ge_u32 s39, 6
    s_cbranch_scc1 L_lnf_203a
    s_mov_b64 exec, 1
    v_mov_b32 v12, 0
    v_mov_b32 v13, 1
    global_atomic_add v14, v12, v13, s[96:97] offset:64 sc0
    s_waitcnt vmcnt(0)
    v_cmp_ne_u32 vcc, 5, v14
    s_cbranch_vccnz L_ci_204
    global_store_dword v12, v13, s[96:97] offset:156 sc1
L_ci_204:
    s_mov_b64 exec, -1
L_lnf_203a:
    s_mov_b64 exec, 1
    v_mov_b32 v12, 0
    v_mov_b32 v13, 1
    global_atomic_add v14, v12, v13, s[96:97] offset:44 sc0
    s_waitcnt vmcnt(0)
    v_cmp_ne_u32 vcc, 63, v14
    s_cbranch_vccnz L_ci_205
    global_store_dword v12, v13, s[96:97] offset:140 sc1
L_ci_205:
    s_mov_b64 exec, -1
L_lnf_203:
    s_branch L_t1_189
L_t2_190:
    s_or_b32 s99, s26, s98
    s_cbranch_scc1 L_ci_206
    s_lshl_b32 s99, s24, 2
    s_lshl_b32 s95, 1, s25
    s_atomic_or s95, s[96:97], s99 glc
L_ci_206:
    s_cmp_lg_u32 s98, 0
    s_cbranch_scc1 L_cc_207
    v_mov_b32 v254, 163832
    s_cmp_lg_u32 s26, 0
    s_cbranch_scc1 L_ccw_208
    s_waitcnt lgkmcnt(0)
    v_mov_b32 v255, s95
    ds_write_b32 v254, v255
    s_waitcnt lgkmcnt(0)
L_ccw_208:
    s_barrier
    ds_read_b32 v255, v254
    s_waitcnt lgkmcnt(0)
    v_readfirstlane_b32 s99, v255
    s_barrier
    s_bitcmp1_b32 s99, s25
    s_cbranch_scc1 L_reclaim
L_cc_207:
    s_lshl_b32 s32, s26, 7
    s_add_u32 s32, s32, s28
    s_sub_u32 s33, s32, 90
    s_and_b32 s34, s33, -3
    s_cbranch_scc1 L_t4_192
    v_lshlrev_b32 v10, 2, v0
    s_mov_b32 exec_hi, 0
    s_mov_b32 s40, -1
    s_mov_b32 s41, -1
    s_mov_b32 s42, 0
    s_lshl_b32 s46, s33, 6
    s_lshr_b32 s47, s33, 1
    s_lshl_b32 s47, 8192, s47
    s_add_u32 s47, s47, s46
L_pn_209:
    s_mov_b32 s44, 0
    buffer_store_dword v10, v10, s[4:7], s46 offen sc1
L_pp_210:
    s_add_u32 s44, s44, 1
    s_getreg_b32 s45, hwreg(HW_REG_IB_STS, 0, 4)
    s_cmp_eq_u32 s45, 0
    s_cbranch_scc1 L_pd_211
    s_add_u32 s44, s44, 1
    s_getreg_b32 s45, hwreg(HW_REG_IB_STS, 0, 4)
    s_cmp_eq_u32 s45, 0
    s_cbranch_scc1 L_pd_211
    s_add_u32 s44, s44, 1
    s_getreg_b32 s45, hwreg(HW_REG_IB_STS, 0, 4)
    s_cmp_eq_u32 s45, 0
    s_cbranch_scc1 L_pd_211
    s_add_u32 s44, s44, 1
    s_getreg_b32 s45, hwreg(HW_REG_IB_STS, 0, 4)
    s_cmp_eq_u32 s45, 0
    s_cbranch_scc1 L_pd_211
    s_add_u32 s44, s44, 1
    s_getreg_b32 s45, hwreg(HW_REG_IB_STS, 0, 4)
    s_cmp_eq_u32 s45, 0
    s_cbranch_scc1 L_pd_211
    s_add_u32 s44, s44, 1
    s_getreg_b32 s45, hwreg(HW_REG_IB_STS, 0, 4)
    s_cmp_eq_u32 s45, 0
    s_cbranch_scc1 L_pd_211
    s_cmp_lt_u32 s44, 4000
    s_cbranch_scc1 L_pp_210
L_pd_211:
    s_min_u32 s44, s40, s44
    s_mov_b32 s40, s41
    s_mov_b32 s41, s44
    s_add_u32 s44, s46, 1152
    s_mov_b32 s46, s47
    s_mov_b32 s47, s44
    s_add_u32 s42, s42, 1
    s_cmp_lt_u32 s42, 14
    s_cbranch_scc1 L_pn_209
    s_cmp_lt_u32 s40, s41
    s_cselect_b32 s42, 2, 1
    s_lshl_b32 s40, s40, 8
    s_lshl_b32 s41, s41, 20
    s_or_b32 s42, s42, s40
    s_or_b32 s42, s42, s41
    s_mov_b64 exec, 1
    v_mov_b32 v11, s42
    s_lshl_b32 s42, s33, 2
    v_mov_b32 v10, s42
    global_store_dword v10, v11, s[96:97] offset:144 sc1
    s_mov_b64 exec, -1
L_t4_192:
    s_barrier
    s_cmp_lg_u32 s32, 94
    s_cbranch_scc1 L_t5_193
    v_lshlrev_b32 v10, 4, v0
    v_mov_b64 v[12:13], 0
    v_mov_b64 v[14:15], 0
    s_mov_b32 s33, 3538944
    buffer_store_dwordx4 v[12:15], v10, s[4:7], s33 offen offset:0 sc1
    buffer_store_dwordx4 v[12:15], v10, s[4:7], s33 offen offset:1024 sc1
    buffer_store_dwordx4 v[12:15], v10, s[4:7], s33 offen offset:2048 sc1
    buffer_store_dwordx4 v[12:15], v10, s[4:7], s33 offen offset:3072 sc1
    s_mov_b32 s33, 3543040
    buffer_store_dwordx4 v[12:15], v10, s[4:7], s33 offen offset:0 sc1
    buffer_store_dwordx4 v[12:15], v10, s[4:7], s33 offen offset:1024 sc1
    buffer_store_dwordx4 v[12:15], v10, s[4:7], s33 offen offset:2048 sc1
    buffer_store_dwordx4 v[12:15], v10, s[4:7], s33 offen offset:3072 sc1
    s_mov_b32 s33, 3547136
    buffer_store_dwordx4 v[12:15], v10, s[4:7], s33 offen offset:0 sc1
    buffer_store_dwordx4 v[12:15], v10, s[4:7], s33 offen offset:1024 sc1
    buffer_store_dwordx4 v[12:15], v10, s[4:7], s33 offen offset:2048 sc1
    buffer_store_dwordx4 v[12:15], v10, s[4:7], s33 offen offset:3072 sc1
    s_mov_b32 s33, 3551232
    buffer_store_dwordx4 v[12:15], v10, s[4:7], s33 offen offset:0 sc1
    buffer_store_dwordx4 v[12:15], v10, s[4:7], s33 offen offset:1024 sc1
    buffer_store_dwordx4 v[12:15], v10, s[4:7], s33 offen offset:2048 sc1
    buffer_store_dwordx4 v[12:15], v10, s[4:7], s33 offen offset:3072 sc1
    s_waitcnt vmcnt(0)
    s_mov_b64 exec, 1
    v_mov_b32 v13, 1
    global_store_dword v12, v13, s[96:97] offset:160 sc1
    s_mov_b64 exec, -1
L_t5_193:
    s_cmp_lg_u32 s32, 95
    s_cbranch_scc1 L_t1_189
    v_mbcnt_lo_u32_b32 v10, -1, 0
    v_lshlrev_b32 v10, 2, v10
    s_mov_b64 exec, 0xff
L_co_212:
    global_load_dword v11, v10, s[96:97] sc1
    s_waitcnt vmcnt(0)
    v_cmp_ne_u32 vcc, -1, v11
    s_cbranch_vccz L_cod_213
    s_sleep 8
    s_sub_u32 s31, s31, 1
    s_cbranch_scc1 L_exit
    s_branch L_co_212
L_cod_213:
    s_mov_b64 exec, 1
    global_atomic_or v11, v10, v10, s[96:97] offset:32 sc0
    s_waitcnt vmcnt(0)
    v_add_u32 v11, 1, v11
    global_store_dword v10, v11, s[96:97] offset:128 sc1
    s_mov_b64 exec, -1
L_t1_189:
    s_mov_b32 s98, 1
    s_cmp_lt_u32 s28, 36
    s_cbranch_scc1 L_t6_194
L_t3_191:
    s_load_dwordx2 s[8:9], s[0:1], 104
    s_load_dwordx2 s[12:13], s[0:1], 96
    v_lshrrev_b32 v2, 3, v0
    v_and_b32 v3, 7, v0
    v_mul_u32_u24 v4, 40, v2
    s_mov_b32 s30, 153600
    v_mul_lo_u32 v5, s30, v2
    v_lshl_add_u32 v5, v3, 4, v5
    s_lshl_b32 s30, s29, 7
    s_waitcnt lgkmcnt(0)
    s_mov_b32 s10, 4915200
    s_mov_b32 s11, 0x20000
    s_mov_b32 s14, 1280
    s_mov_b32 s15, 0x20000
    buffer_load_dwordx4 v[16:19], v4, s[12:15], 0 offen
    buffer_load_dwordx4 v[20:23], v4, s[12:15], 0 offen offset:16
    buffer_load_dwordx2 v[24:25], v4, s[12:15], 0 offen offset:32
    buffer_load_dwordx4 v[32:35], v5, s[8:11], s30 offen
    s_add_u32 s30, s30, 7680
    buffer_load_dwordx4 v[36:39], v5, s[8:11], s30 offen
    s_add_u32 s30, s30, 7680
    buffer_load_dwordx4 v[40:43], v5, s[8:11], s30 offen
    s_add_u32 s30, s30, 7680
    buffer_load_dwordx4 v[44:47], v5, s[8:11], s30 offen
    s_add_u32 s30, s30, 7680
    buffer_load_dwordx4 v[48:51], v5, s[8:11], s30 offen
    s_add_u32 s30, s30, 7680
    buffer_load_dwordx4 v[52:55], v5, s[8:11], s30 offen
    s_add_u32 s30, s30, 7680
    buffer_load_dwordx4 v[56:59], v5, s[8:11], s30 offen
    s_add_u32 s30, s30, 7680
    buffer_load_dwordx4 v[60:63], v5, s[8:11], s30 offen
    s_add_u32 s30, s30, 7680
    buffer_load_dwordx4 v[64:67], v5, s[8:11], s30 offen
    s_add_u32 s30, s30, 7680
    buffer_load_dwordx4 v[68:71], v5, s[8:11], s30 offen
    s_add_u32 s30, s30, 7680
    buffer_load_dwordx4 v[72:75], v5, s[8:11], s30 offen
    s_add_u32 s30, s30, 7680
    buffer_load_dwordx4 v[76:79], v5, s[8:11], s30 offen
    s_add_u32 s30, s30, 7680
    buffer_load_dwordx4 v[80:83], v5, s[8:11], s30 offen
    s_add_u32 s30, s30, 7680
    buffer_load_dwordx4 v[84:87], v5, s[8:11], s30 offen
    s_add_u32 s30, s30, 7680
    buffer_load_dwordx4 v[88:91], v5, s[8:11], s30 offen
    s_add_u32 s30, s30, 7680
    buffer_load_dwordx4 v[92:95], v5, s[8:11], s30 offen
    s_add_u32 s30, s30, 7680
    buffer_load_dwordx4 v[96:99], v5, s[8:11], s30 offen
    s_add_u32 s30, s30, 7680
    buffer_load_dwordx4 v[100:103], v5, s[8:11], s30 offen
    s_add_u32 s30, s30, 7680
    buffer_load_dwordx4 v[104:107], v5, s[8:11], s30 offen
    s_add_u32 s30, s30, 7680
    buffer_load_dwordx4 v[108:111], v5, s[8:11], s30 offen
    s_or_b32 s99, s26, s98
    s_cbranch_scc1 L_ci_214
    s_lshl_b32 s99, s24, 2
    s_lshl_b32 s95, 1, s25
    s_atomic_or s95, s[96:97], s99 glc
L_ci_214:
    v_mov_b32 v112, 0
    v_mov_b32 v113, 0
    v_mov_b32 v114, 0
    v_mov_b32 v115, 0
    v_mov_b32 v116, 0
    v_mov_b32 v117, 0
    v_mov_b32 v118, 0
    v_mov_b32 v119, 0
    s_mov_b32 s30, 3216550459
    s_waitcnt vmcnt(20)
    v_lshlrev_b32 v120, 16, v16
    v_mul_f32 v6, s30, v120
    v_exp_f32 v6, v6
    s_nop 0
    v_add_f32 v6, 1.0, v6
    v_rcp_f32 v6, v6
    s_nop 0
    v_mul_f32 v120, v120, v6
    v_cvt_pk_bf16_f32 v120, v120, v120
    v_and_b32 v120, 0xffff0000, v120
    v_and_b32 v121, 0xffff0000, v16
    v_mul_f32 v6, s30, v121
    v_exp_f32 v6, v6
    s_nop 0
    v_add_f32 v6, 1.0, v6
    v_rcp_f32 v6, v6
    s_nop 0
    v_mul_f32 v121, v121, v6
    v_cvt_pk_bf16_f32 v121, v121, v121
    v_and_b32 v121, 0xffff0000, v121
    v_lshlrev_b32 v122, 16, v17
    v_mul_f32 v6, s30, v122
    v_exp_f32 v6, v6
    s_nop 0
    v_add_f32 v6, 1.0, v6
    v_rcp_f32 v6, v6
    s_nop 0
    v_mul_f32 v122, v122, v6
    v_cvt_pk_bf16_f32 v122, v122, v122
    v_and_b32 v122, 0xffff0000, v122
    v_and_b32 v123, 0xffff0000, v17
    v_mul_f32 v6, s30, v123
    v_exp_f32 v6, v6
    s_nop 0
    v_add_f32 v6, 1.0, v6
    v_rcp_f32 v6, v6
    s_nop 0
    v_mul_f32 v123, v123, v6
    v_cvt_pk_bf16_f32 v123, v123, v123
    v_and_b32 v123, 0xffff0000, v123
    v_lshlrev_b32 v124, 16, v18
    v_mul_f32 v6, s30, v124
    v_exp_f32 v6, v6
    s_nop 0
    v_add_f32 v6, 1.0, v6
    v_rcp_f32 v6, v6
    s_nop 0
    v_mul_f32 v124, v124, v6
    v_cvt_pk_bf16_f32 v124, v124, v124
    v_and_b32 v124, 0xffff0000, v124
    v_and_b32 v125, 0xffff0000, v18
    v_mul_f32 v6, s30, v125
    v_exp_f32 v6, v6
    s_nop 0
    v_add_f32 v6, 1.0, v6
    v_rcp_f32 v6, v6
    s_nop 0
    v_mul_f32 v125, v125, v6
    v_cvt_pk_bf16_f32 v125, v125, v125
    v_and_b32 v125, 0xffff0000, v125
    v_lshlrev_b32 v126, 16, v19
    v_mul_f32 v6, s30, v126
    v_exp_f32 v6, v6
    s_nop 0
    v_add_f32 v6, 1.0, v6
    v_rcp_f32 v6, v6
    s_nop 0
    v_mul_f32 v126, v126, v6
    v_cvt_pk_bf16_f32 v126, v126, v126
    v_and_b32 v126, 0xffff0000, v126
    v_and_b32 v127, 0xffff0000, v19
    v_mul_f32 v6, s30, v127
    v_exp_f32 v6, v6
    s_nop 0
    v_add_f32 v6, 1.0, v6
    v_rcp_f32 v6, v6
    s_nop 0
    v_mul_f32 v127, v127, v6
    v_cvt_pk_bf16_f32 v127, v127, v127
    v_and_b32 v127, 0xffff0000, v127
    v_lshlrev_b32 v128, 16, v20
    v_mul_f32 v6, s30, v128
    v_exp_f32 v6, v6
    s_nop 0
    v_add_f32 v6, 1.0, v6
    v_rcp_f32 v6, v6
    s_nop 0
    v_mul_f32 v128, v128, v6
    v_cvt_pk_bf16_f32 v128, v128, v128
    v_and_b32 v128, 0xffff0000, v128
    v_and_b32 v129, 0xffff0000, v20
    v_mul_f32 v6, s30, v129
    v_exp_f32 v6, v6
    s_nop 0
    v_add_f32 v6, 1.0, v6
    v_rcp_f32 v6, v6
    s_nop 0
    v_mul_f32 v129, v129, v6
    v_cvt_pk_bf16_f32 v129, v129, v129
    v_and_b32 v129, 0xffff0000, v129
    v_lshlrev_b32 v130, 16, v21
    v_mul_f32 v6, s30, v130
    v_exp_f32 v6, v6
    s_nop 0
    v_add_f32 v6, 1.0, v6
    v_rcp_f32 v6, v6
    s_nop 0
    v_mul_f32 v130, v130, v6
    v_cvt_pk_bf16_f32 v130, v130, v130
    v_and_b32 v130, 0xffff0000, v130
    v_and_b32 v131, 0xffff0000, v21
    v_mul_f32 v6, s30, v131
    v_exp_f32 v6, v6
    s_nop 0
    v_add_f32 v6, 1.0, v6
    v_rcp_f32 v6, v6
    s_nop 0
    v_mul_f32 v131, v131, v6
    v_cvt_pk_bf16_f32 v131, v131, v131
    v_and_b32 v131, 0xffff0000, v131
    v_lshlrev_b32 v132, 16, v22
    v_mul_f32 v6, s30, v132
    v_exp_f32 v6, v6
    s_nop 0
    v_add_f32 v6, 1.0, v6
    v_rcp_f32 v6, v6
    s_nop 0
    v_mul_f32 v132, v132, v6
    v_cvt_pk_bf16_f32 v132, v132, v132
    v_and_b32 v132, 0xffff0000, v132
    v_and_b32 v133, 0xffff0000, v22
    v_mul_f32 v6, s30, v133
    v_exp_f32 v6, v6
    s_nop 0
    v_add_f32 v6, 1.0, v6
    v_rcp_f32 v6, v6
    s_nop 0
    v_mul_f32 v133, v133, v6
    v_cvt_pk_bf16_f32 v133, v133, v133
    v_and_b32 v133, 0xffff0000, v133
    v_lshlrev_b32 v134, 16, v23
    v_mul_f32 v6, s30, v134
    v_exp_f32 v6, v6
    s_nop 0
    v_add_f32 v6, 1.0, v6
    v_rcp_f32 v6, v6
    s_nop 0
    v_mul_f32 v134, v134, v6
    v_cvt_pk_bf16_f32 v134, v134, v134
    v_and_b32 v134, 0xffff0000, v134
    v_and_b32 v135, 0xffff0000, v23
    v_mul_f32 v6, s30, v135
    v_exp_f32 v6, v6
    s_nop 0
    v_add_f32 v6, 1.0, v6
    v_rcp_f32 v6, v6
    s_nop 0
    v_mul_f32 v135, v135, v6
    v_cvt_pk_bf16_f32 v135, v135, v135
    v_and_b32 v135, 0xffff0000, v135
    v_lshlrev_b32 v136, 16, v24
    v_mul_f32 v6, s30, v136
    v_exp_f32 v6, v6
    s_nop 0
    v_add_f32 v6, 1.0, v6
    v_rcp_f32 v6, v6
    s_nop 0
    v_mul_f32 v136, v136, v6
    v_cvt_pk_bf16_f32 v136, v136, v136
    v_and_b32 v136, 0xffff0000, v136
    v_and_b32 v137, 0xffff0000, v24
    v_mul_f32 v6, s30, v137
    v_exp_f32 v6, v6
    s_nop 0
    v_add_f32 v6, 1.0, v6
    v_rcp_f32 v6, v6
    s_nop 0
    v_mul_f32 v137, v137, v6
    v_cvt_pk_bf16_f32 v137, v137, v137
    v_and_b32 v137, 0xffff0000, v137
    v_lshlrev_b32 v138, 16, v25
    v_mul_f32 v6, s30, v138
    v_exp_f32 v6, v6
    s_nop 0
    v_add_f32 v6, 1.0, v6
    v_rcp_f32 v6, v6
    s_nop 0
    v_mul_f32 v138, v138, v6
    v_cvt_pk_bf16_f32 v138, v138, v138
    v_and_b32 v138, 0xffff0000, v138
    v_and_b32 v139, 0xffff0000, v25
    v_mul_f32 v6, s30, v139
    v_exp_f32 v6, v6
    s_nop 0
    v_add_f32 v6, 1.0, v6
    v_rcp_f32 v6, v6
    s_nop 0
    v_mul_f32 v139, v139, v6
    v_cvt_pk_bf16_f32 v139, v139, v139
    v_and_b32 v139, 0xffff0000, v139
    s_waitcnt vmcnt(19)
    v_lshlrev_b32 v6, 16, v32
    v_and_b32 v7, 0xffff0000, v32
    v_fmac_f32 v112, v6, v120
    v_fmac_f32 v113, v7, v120
    v_lshlrev_b32 v6, 16, v33
    v_and_b32 v7, 0xffff0000, v33
    v_fmac_f32 v114, v6, v120
    v_fmac_f32 v115, v7, v120
    v_lshlrev_b32 v6, 16, v34
    v_and_b32 v7, 0xffff0000, v34
    v_fmac_f32 v116, v6, v120
    v_fmac_f32 v117, v7, v120
    v_lshlrev_b32 v6, 16, v35
    v_and_b32 v7, 0xffff0000, v35
    v_fmac_f32 v118, v6, v120
    v_fmac_f32 v119, v7, v120
    s_waitcnt vmcnt(18)
    v_lshlrev_b32 v6, 16, v36
    v_and_b32 v7, 0xffff0000, v36
    v_fmac_f32 v112, v6, v121
    v_fmac_f32 v113, v7, v121
    v_lshlrev_b32 v6, 16, v37
    v_and_b32 v7, 0xffff0000, v37
    v_fmac_f32 v114, v6, v121
    v_fmac_f32 v115, v7, v121
    v_lshlrev_b32 v6, 16, v38
    v_and_b32 v7, 0xffff0000, v38
    v_fmac_f32 v116, v6, v121
    v_fmac_f32 v117, v7, v121
    v_lshlrev_b32 v6, 16, v39
    v_and_b32 v7, 0xffff0000, v39
    v_fmac_f32 v118, v6, v121
    v_fmac_f32 v119, v7, v121
    s_waitcnt vmcnt(17)
    v_lshlrev_b32 v6, 16, v40
    v_and_b32 v7, 0xffff0000, v40
    v_fmac_f32 v112, v6, v122
    v_fmac_f32 v113, v7, v122
    v_lshlrev_b32 v6, 16, v41
    v_and_b32 v7, 0xffff0000, v41
    v_fmac_f32 v114, v6, v122
    v_fmac_f32 v115, v7, v122
    v_lshlrev_b32 v6, 16, v42
    v_and_b32 v7, 0xffff0000, v42
    v_fmac_f32 v116, v6, v122
    v_fmac_f32 v117, v7, v122
    v_lshlrev_b32 v6, 16, v43
    v_and_b32 v7, 0xffff0000, v43
    v_fmac_f32 v118, v6, v122
    v_fmac_f32 v119, v7, v122
    s_waitcnt vmcnt(16)
    v_lshlrev_b32 v6, 16, v44
    v_and_b32 v7, 0xffff0000, v44
    v_fmac_f32 v112, v6, v123
    v_fmac_f32 v113, v7, v123
    v_lshlrev_b32 v6, 16, v45
    v_and_b32 v7, 0xffff0000, v45
    v_fmac_f32 v114, v6, v123
    v_fmac_f32 v115, v7, v123
    v_lshlrev_b32 v6, 16, v46
    v_and_b32 v7, 0xffff0000, v46
    v_fmac_f32 v116, v6, v123
    v_fmac_f32 v117, v7, v123
    v_lshlrev_b32 v6, 16, v47
    v_and_b32 v7, 0xffff0000, v47
    v_fmac_f32 v118, v6, v123
    v_fmac_f32 v119, v7, v123
    s_waitcnt vmcnt(15)
    v_lshlrev_b32 v6, 16, v48
    v_and_b32 v7, 0xffff0000, v48
    v_fmac_f32 v112, v6, v124
    v_fmac_f32 v113, v7, v124
    v_lshlrev_b32 v6, 16, v49
    v_and_b32 v7, 0xffff0000, v49
    v_fmac_f32 v114, v6, v124
    v_fmac_f32 v115, v7, v124
    v_lshlrev_b32 v6, 16, v50
    v_and_b32 v7, 0xffff0000, v50
    v_fmac_f32 v116, v6, v124
    v_fmac_f32 v117, v7, v124
    v_lshlrev_b32 v6, 16, v51
    v_and_b32 v7, 0xffff0000, v51
    v_fmac_f32 v118, v6, v124
    v_fmac_f32 v119, v7, v124
    s_waitcnt vmcnt(14)
    v_lshlrev_b32 v6, 16, v52
    v_and_b32 v7, 0xffff0000, v52
    v_fmac_f32 v112, v6, v125
    v_fmac_f32 v113, v7, v125
    v_lshlrev_b32 v6, 16, v53
    v_and_b32 v7, 0xffff0000, v53
    v_fmac_f32 v114, v6, v125
    v_fmac_f32 v115, v7, v125
    v_lshlrev_b32 v6, 16, v54
    v_and_b32 v7, 0xffff0000, v54
    v_fmac_f32 v116, v6, v125
    v_fmac_f32 v117, v7, v125
    v_lshlrev_b32 v6, 16, v55
    v_and_b32 v7, 0xffff0000, v55
    v_fmac_f32 v118, v6, v125
    v_fmac_f32 v119, v7, v125
    s_waitcnt vmcnt(13)
    v_lshlrev_b32 v6, 16, v56
    v_and_b32 v7, 0xffff0000, v56
    v_fmac_f32 v112, v6, v126
    v_fmac_f32 v113, v7, v126
    v_lshlrev_b32 v6, 16, v57
    v_and_b32 v7, 0xffff0000, v57
    v_fmac_f32 v114, v6, v126
    v_fmac_f32 v115, v7, v126
    v_lshlrev_b32 v6, 16, v58
    v_and_b32 v7, 0xffff0000, v58
    v_fmac_f32 v116, v6, v126
    v_fmac_f32 v117, v7, v126
    v_lshlrev_b32 v6, 16, v59
    v_and_b32 v7, 0xffff0000, v59
    v_fmac_f32 v118, v6, v126
    v_fmac_f32 v119, v7, v126
    s_waitcnt vmcnt(12)
    v_lshlrev_b32 v6, 16, v60
    v_and_b32 v7, 0xffff0000, v60
    v_fmac_f32 v112, v6, v127
    v_fmac_f32 v113, v7, v127
    v_lshlrev_b32 v6, 16, v61
    v_and_b32 v7, 0xffff0000, v61
    v_fmac_f32 v114, v6, v127
    v_fmac_f32 v115, v7, v127
    v_lshlrev_b32 v6, 16, v62
    v_and_b32 v7, 0xffff0000, v62
    v_fmac_f32 v116, v6, v127
    v_fmac_f32 v117, v7, v127
    v_lshlrev_b32 v6, 16, v63
    v_and_b32 v7, 0xffff0000, v63
    v_fmac_f32 v118, v6, v127
    v_fmac_f32 v119, v7, v127
    s_waitcnt vmcnt(11)
    v_lshlrev_b32 v6, 16, v64
    v_and_b32 v7, 0xffff0000, v64
    v_fmac_f32 v112, v6, v128
    v_fmac_f32 v113, v7, v128
    v_lshlrev_b32 v6, 16, v65
    v_and_b32 v7, 0xffff0000, v65
    v_fmac_f32 v114, v6, v128
    v_fmac_f32 v115, v7, v128
    v_lshlrev_b32 v6, 16, v66
    v_and_b32 v7, 0xffff0000, v66
    v_fmac_f32 v116, v6, v128
    v_fmac_f32 v117, v7, v128
    v_lshlrev_b32 v6, 16, v67
    v_and_b32 v7, 0xffff0000, v67
    v_fmac_f32 v118, v6, v128
    v_fmac_f32 v119, v7, v128
    s_waitcnt vmcnt(10)
    v_lshlrev_b32 v6, 16, v68
    v_and_b32 v7, 0xffff0000, v68
    v_fmac_f32 v112, v6, v129
    v_fmac_f32 v113, v7, v129
    v_lshlrev_b32 v6, 16, v69
    v_and_b32 v7, 0xffff0000, v69
    v_fmac_f32 v114, v6, v129
    v_fmac_f32 v115, v7, v129
    v_lshlrev_b32 v6, 16, v70
    v_and_b32 v7, 0xffff0000, v70
    v_fmac_f32 v116, v6, v129
    v_fmac_f32 v117, v7, v129
    v_lshlrev_b32 v6, 16, v71
    v_and_b32 v7, 0xffff0000, v71
    v_fmac_f32 v118, v6, v129
    v_fmac_f32 v119, v7, v129
    s_waitcnt vmcnt(9)
    v_lshlrev_b32 v6, 16, v72
    v_and_b32 v7, 0xffff0000, v72
    v_fmac_f32 v112, v6, v130
    v_fmac_f32 v113, v7, v130
    v_lshlrev_b32 v6, 16, v73
    v_and_b32 v7, 0xffff0000, v73
    v_fmac_f32 v114, v6, v130
    v_fmac_f32 v115, v7, v130
    v_lshlrev_b32 v6, 16, v74
    v_and_b32 v7, 0xffff0000, v74
    v_fmac_f32 v116, v6, v130
    v_fmac_f32 v117, v7, v130
    v_lshlrev_b32 v6, 16, v75
    v_and_b32 v7, 0xffff0000, v75
    v_fmac_f32 v118, v6, v130
    v_fmac_f32 v119, v7, v130
    s_waitcnt vmcnt(8)
    v_lshlrev_b32 v6, 16, v76
    v_and_b32 v7, 0xffff0000, v76
    v_fmac_f32 v112, v6, v131
    v_fmac_f32 v113, v7, v131
    v_lshlrev_b32 v6, 16, v77
    v_and_b32 v7, 0xffff0000, v77
    v_fmac_f32 v114, v6, v131
    v_fmac_f32 v115, v7, v131
    v_lshlrev_b32 v6, 16, v78
    v_and_b32 v7, 0xffff0000, v78
    v_fmac_f32 v116, v6, v131
    v_fmac_f32 v117, v7, v131
    v_lshlrev_b32 v6, 16, v79
    v_and_b32 v7, 0xffff0000, v79
    v_fmac_f32 v118, v6, v131
    v_fmac_f32 v119, v7, v131
    s_waitcnt vmcnt(7)
    v_lshlrev_b32 v6, 16, v80
    v_and_b32 v7, 0xffff0000, v80
    v_fmac_f32 v112, v6, v132
    v_fmac_f32 v113, v7, v132
    v_lshlrev_b32 v6, 16, v81
    v_and_b32 v7, 0xffff0000, v81
    v_fmac_f32 v114, v6, v132
    v_fmac_f32 v115, v7, v132
    v_lshlrev_b32 v6, 16, v82
    v_and_b32 v7, 0xffff0000, v82
    v_fmac_f32 v116, v6, v132
    v_fmac_f32 v117, v7, v132
    v_lshlrev_b32 v6, 16, v83
    v_and_b32 v7, 0xffff0000, v83
    v_fmac_f32 v118, v6, v132
    v_fmac_f32 v119, v7, v132
    s_waitcnt vmcnt(6)
    v_lshlrev_b32 v6, 16, v84
    v_and_b32 v7, 0xffff0000, v84
    v_fmac_f32 v112, v6, v133
    v_fmac_f32 v113, v7, v133
    v_lshlrev_b32 v6, 16, v85
    v_and_b32 v7, 0xffff0000, v85
    v_fmac_f32 v114, v6, v133
    v_fmac_f32 v115, v7, v133
    v_lshlrev_b32 v6, 16, v86
    v_and_b32 v7, 0xffff0000, v86
    v_fmac_f32 v116, v6, v133
    v_fmac_f32 v117, v7, v133
    v_lshlrev_b32 v6, 16, v87
    v_and_b32 v7, 0xffff0000, v87
    v_fmac_f32 v118, v6, v133
    v_fmac_f32 v119, v7, v133
    s_waitcnt vmcnt(5)
    v_lshlrev_b32 v6, 16, v88
    v_and_b32 v7, 0xffff0000, v88
    v_fmac_f32 v112, v6, v134
    v_fmac_f32 v113, v7, v134
    v_lshlrev_b32 v6, 16, v89
    v_and_b32 v7, 0xffff0000, v89
    v_fmac_f32 v114, v6, v134
    v_fmac_f32 v115, v7, v134
    v_lshlrev_b32 v6, 16, v90
    v_and_b32 v7, 0xffff0000, v90
    v_fmac_f32 v116, v6, v134
    v_fmac_f32 v117, v7, v134
    v_lshlrev_b32 v6, 16, v91
    v_and_b32 v7, 0xffff0000, v91
    v_fmac_f32 v118, v6, v134
    v_fmac_f32 v119, v7, v134
    s_waitcnt vmcnt(4)
    v_lshlrev_b32 v6, 16, v92
    v_and_b32 v7, 0xffff0000, v92
    v_fmac_f32 v112, v6, v135
    v_fmac_f32 v113, v7, v135
    v_lshlrev_b32 v6, 16, v93
    v_and_b32 v7, 0xffff0000, v93
    v_fmac_f32 v114, v6, v135
    v_fmac_f32 v115, v7, v135
    v_lshlrev_b32 v6, 16, v94
    v_and_b32 v7, 0xffff0000, v94
    v_fmac_f32 v116, v6, v135
    v_fmac_f32 v117, v7, v135
    v_lshlrev_b32 v6, 16, v95
    v_and_b32 v7, 0xffff0000, v95
    v_fmac_f32 v118, v6, v135
    v_fmac_f32 v119, v7, v135
    s_waitcnt vmcnt(3)
    v_lshlrev_b32 v6, 16, v96
    v_and_b32 v7, 0xffff0000, v96
    v_fmac_f32 v112, v6, v136
    v_fmac_f32 v113, v7, v136
    v_lshlrev_b32 v6, 16, v97
    v_and_b32 v7, 0xffff0000, v97
    v_fmac_f32 v114, v6, v136
    v_fmac_f32 v115, v7, v136
    v_lshlrev_b32 v6, 16, v98
    v_and_b32 v7, 0xffff0000, v98
    v_fmac_f32 v116, v6, v136
    v_fmac_f32 v117, v7, v136
    v_lshlrev_b32 v6, 16, v99
    v_and_b32 v7, 0xffff0000, v99
    v_fmac_f32 v118, v6, v136
    v_fmac_f32 v119, v7, v136
    s_waitcnt vmcnt(2)
    v_lshlrev_b32 v6, 16, v100
    v_and_b32 v7, 0xffff0000, v100
    v_fmac_f32 v112, v6, v137
    v_fmac_f32 v113, v7, v137
    v_lshlrev_b32 v6, 16, v101
    v_and_b32 v7, 0xffff0000, v101
    v_fmac_f32 v114, v6, v137
    v_fmac_f32 v115, v7, v137
    v_lshlrev_b32 v6, 16, v102
    v_and_b32 v7, 0xffff0000, v102
    v_fmac_f32 v116, v6, v137
    v_fmac_f32 v117, v7, v137
    v_lshlrev_b32 v6, 16, v103
    v_and_b32 v7, 0xffff0000, v103
    v_fmac_f32 v118, v6, v137
    v_fmac_f32 v119, v7, v137
    s_waitcnt vmcnt(1)
    v_lshlrev_b32 v6, 16, v104
    v_and_b32 v7, 0xffff0000, v104
    v_fmac_f32 v112, v6, v138
    v_fmac_f32 v113, v7, v138
    v_lshlrev_b32 v6, 16, v105
    v_and_b32 v7, 0xffff0000, v105
    v_fmac_f32 v114, v6, v138
    v_fmac_f32 v115, v7, v138
    v_lshlrev_b32 v6, 16, v106
    v_and_b32 v7, 0xffff0000, v106
    v_fmac_f32 v116, v6, v138
    v_fmac_f32 v117, v7, v138
    v_lshlrev_b32 v6, 16, v107
    v_and_b32 v7, 0xffff0000, v107
    v_fmac_f32 v118, v6, v138
    v_fmac_f32 v119, v7, v138
    s_waitcnt vmcnt(0)
    v_lshlrev_b32 v6, 16, v108
    v_and_b32 v7, 0xffff0000, v108
    v_fmac_f32 v112, v6, v139
    v_fmac_f32 v113, v7, v139
    v_lshlrev_b32 v6, 16, v109
    v_and_b32 v7, 0xffff0000, v109
    v_fmac_f32 v114, v6, v139
    v_fmac_f32 v115, v7, v139
    v_lshlrev_b32 v6, 16, v110
    v_and_b32 v7, 0xffff0000, v110
    v_fmac_f32 v116, v6, v139
    v_fmac_f32 v117, v7, v139
    v_lshlrev_b32 v6, 16, v111
    v_and_b32 v7, 0xffff0000, v111
    v_fmac_f32 v118, v6, v139
    v_fmac_f32 v119, v7, v139
    s_cmp_lg_u32 s98, 0
    s_cbranch_scc1 L_cc_215
    v_mov_b32 v254, 163832
    s_cmp_lg_u32 s26, 0
    s_cbranch_scc1 L_ccw_216
    s_waitcnt lgkmcnt(0)
    v_mov_b32 v255, s95
    ds_write_b32 v254, v255
    s_waitcnt lgkmcnt(0)
L_ccw_216:
    s_barrier
    ds_read_b32 v255, v254
    s_waitcnt lgkmcnt(0)
    v_readfirstlane_b32 s99, v255
    s_barrier
    s_bitcmp1_b32 s99, s25
    s_cbranch_scc1 L_reclaim
L_cc_215:
    v_lshlrev_b32 v6, 5, v0
    ds_write_b128 v6, v[112:115]
    ds_write_b128 v6, v[116:119] offset:16
    s_waitcnt lgkmcnt(0)
    s_barrier
    s_cmp_lg_u32 s26, 0
    s_cbranch_scc1 L_modw_217
    v_lshlrev_b32 v6, 2, v0
    ds_read_b32 v32, v6 offset:0
    ds_read_b32 v33, v6 offset:256
    ds_read_b32 v34, v6 offset:512
    ds_read_b32 v35, v6 offset:768
    ds_read_b32 v36, v6 offset:1024
    ds_read_b32 v37, v6 offset:1280
    ds_read_b32 v38, v6 offset:1536
    ds_read_b32 v39, v6 offset:1792
    s_waitcnt lgkmcnt(0)
    ds_read_b32 v40, v6 offset:2048
    ds_read_b32 v41, v6 offset:2304
    ds_read_b32 v42, v6 offset:2560
    ds_read_b32 v43, v6 offset:2816
    ds_read_b32 v44, v6 offset:3072
    ds_read_b32 v45, v6 offset:3328
    ds_read_b32 v46, v6 offset:3584
    ds_read_b32 v47, v6 offset:3840
    s_waitcnt lgkmcnt(0)
    ds_read_b32 v48, v6 offset:4096
    ds_read_b32 v49, v6 offset:4352
    ds_read_b32 v50, v6 offset:4608
    ds_read_b32 v51, v6 offset:4864
    ds_read_b32 v52, v6 offset:5120
    ds_read_b32 v53, v6 offset:5376
    ds_read_b32 v54, v6 offset:5632
    ds_read_b32 v55, v6 offset:5888
    s_waitcnt lgkmcnt(0)
    ds_read_b32 v56, v6 offset:6144
    ds_read_b32 v57, v6 offset:6400
    ds_read_b32 v58, v6 offset:6656
    ds_read_b32 v59, v6 offset:6912
    ds_read_b32 v60, v6 offset:7168
    ds_read_b32 v61, v6 offset:7424
    ds_read_b32 v62, v6 offset:7680
    ds_read_b32 v63, v6 offset:7936
    s_waitcnt lgkmcnt(0)
    v_add_f32 v32, v32, v48
    v_add_f32 v33, v33, v49
    v_add_f32 v34, v34, v50
    v_add_f32 v35, v35, v51
    v_add_f32 v36, v36, v52
    v_add_f32 v37, v37, v53
    v_add_f32 v38, v38, v54
    v_add_f32 v39, v39, v55
    v_add_f32 v40, v40, v56
    v_add_f32 v41, v41, v57
    v_add_f32 v42, v42, v58
    v_add_f32 v43, v43, v59
    v_add_f32 v44, v44, v60
    v_add_f32 v45, v45, v61
    v_add_f32 v46, v46, v62
    v_add_f32 v47, v47, v63
    v_add_f32 v32, v32, v40
    v_add_f32 v33, v33, v41
    v_add_f32 v34, v34, v42
    v_add_f32 v35, v35, v43
    v_add_f32 v36, v36, v44
    v_add_f32 v37, v37, v45
    v_add_f32 v38, v38, v46
    v_add_f32 v39, v39, v47
    v_add_f32 v32, v32, v36
    v_add_f32 v33, v33, v37
    v_add_f32 v34, v34, v38
    v_add_f32 v35, v35, v39
    v_add_f32 v32, v32, v34
    v_add_f32 v33, v33, v35
    v_add_f32 v32, v32, v33
    v_cvt_pk_bf16_f32 v32, v32, v32
    v_and_b32 v32, 0xffff0000, v32
    v_add_f32 v7, 1.0, v32
    v_cvt_pk_bf16_f32 v7, v7, v7
    v_and_b32 v7, 0xffff0000, v7
    s_sub_u32 s30, s29, 10
    s_cmp_lt_u32 s30, 10
    s_cselect_b64 vcc, -1, 0
    s_sub_u32 s30, s29, 40
    s_cmp_lt_u32 s30, 10
    s_cselect_b64 vcc, -1, vcc
    v_cndmask_b32 v32, v32, v7, vcc
    s_lshl_b32 s30, s29, 8
    s_add_u32 s30, s30, 3670016
    buffer_store_dword v32, v6, s[4:7], s30 offen sc1
    s_waitcnt vmcnt(0)
    s_cmp_ge_u32 s29, 20
    s_cbranch_scc1 L_modw_217b
    s_mov_b64 exec, 1
    v_mov_b32 v8, 0
    v_mov_b32 v9, 1
    global_atomic_add v10, v8, v9, s[96:97] offset:36 sc0
    s_waitcnt vmcnt(0)
    v_cmp_ne_u32 vcc, 19, v10
    s_cbranch_vccnz L_ci_218
    global_store_dword v8, v9, s[96:97] offset:132 sc1
L_ci_218:
    s_mov_b64 exec, -1
L_modw_217b:
    s_mov_b64 exec, 1
    v_mov_b32 v8, 0
    v_mov_b32 v9, 1
    global_atomic_add v10, v8, v9, s[96:97] offset:40 sc0
    s_waitcnt vmcnt(0)
    v_cmp_ne_u32 vcc, 59, v10
    s_cbranch_vccnz L_ci_219
    global_store_dword v8, v9, s[96:97] offset:136 sc1
L_ci_219:
    s_mov_b64 exec, -1
L_modw_217:
L_t6_194:
L_join:
    s_lshl_b32 s32, s27, 5
    s_add_u32 s32, s32, s25
    s_lshl_b32 s32, s32, 2
    s_add_u32 s36, s32, 3579904
    s_add_u32 s37, s32, 3580928
    s_add_u32 s38, s32, 3581952
    s_load_dwordx2 s[8:9], s[0:1], 40
    s_load_dwordx2 s[12:13], s[0:1], 64
    s_load_dwordx2 s[16:17], s[0:1], 80
    v_and_b32 v17, 63, v0
    v_lshlrev_b32 v1, 4, v17
    v_lshlrev_b32 v2, 2, v17
    v_and_b32 v18, 15, v17
    v_lshrrev_b32 v19, 4, v17
    v_bfe_u32 v30, v17, 2, 2
    v_and_b32 v31, 3, v17
    s_mul_i32 s52, s26, 40960
    s_lshr_b32 s53, s25, 3
    s_and_b32 s54, s25, 7
    s_lshr_b32 s55, s25, 4
    s_and_b32 s56, s25, 15
    s_min_u32 s57, s25, 26
    s_waitcnt lgkmcnt(0)
    s_barrier
    s_mov_b32 s10, 5242880
    s_mov_b32 s11, 0x20000
    s_mov_b32 s14, 2211840
    s_mov_b32 s15, 0x20000
    s_mov_b32 s18, 2211840
    s_mov_b32 s19, 0x20000
    s_lshl_b32 s33, s53, 2
    s_add_u32 s33, s33, s26
    s_mul_i32 s33, s33, 327680
    s_mul_i32 s34, s54, 160
    s_add_u32 s33, s33, s34
    v_add_u32 v20, 0, v17
    v_mul_u32_u24 v21, 6554, v20
    v_lshrrev_b32 v21, 16, v21
    v_mul_u32_u24 v22, 10, v21
    v_sub_u32 v22, v20, v22
    v_mul_u32_u24 v21, 1280, v21
    v_lshl_add_u32 v24, v22, 4, v21
    v_add_u32 v20, 64, v17
    v_mul_u32_u24 v21, 6554, v20
    v_lshrrev_b32 v21, 16, v21
    v_mul_u32_u24 v22, 10, v21
    v_sub_u32 v22, v20, v22
    v_mul_u32_u24 v21, 1280, v21
    v_lshl_add_u32 v25, v22, 4, v21
    v_add_u32 v20, 128, v17
    v_mul_u32_u24 v21, 6554, v20
    v_lshrrev_b32 v21, 16, v21
    v_mul_u32_u24 v22, 10, v21
    v_sub_u32 v22, v20, v22
    v_mul_u32_u24 v21, 1280, v21
    v_lshl_add_u32 v26, v22, 4, v21
    v_add_u32 v20, 192, v17
    v_mul_u32_u24 v21, 6554, v20
    v_lshrrev_b32 v21, 16, v21
    v_mul_u32_u24 v22, 10, v21
    v_sub_u32 v22, v20, v22
    v_mul_u32_u24 v21, 1280, v21
    v_lshl_add_u32 v27, v22, 4, v21
    v_add_u32 v20, 256, v17
    v_mul_u32_u24 v21, 6554, v20
    v_lshrrev_b32 v21, 16, v21
    v_mul_u32_u24 v22, 10, v21
    v_sub_u32 v22, v20, v22
    v_mul_u32_u24 v21, 1280, v21
    v_lshl_add_u32 v28, v22, 4, v21
    s_add_u32 m0, s52, 0
    s_add_u32 s32, s33, 0
    buffer_load_dwordx4 v24, s[8:11], s32 offen lds
    s_add_u32 m0, s52, 1024
    s_nop 0
    buffer_load_dwordx4 v25, s[8:11], s32 offen lds
    s_add_u32 m0, s52, 2048
    s_nop 0
    buffer_load_dwordx4 v26, s[8:11], s32 offen lds
    s_add_u32 m0, s52, 3072
    s_nop 0
    buffer_load_dwordx4 v27, s[8:11], s32 offen lds
    s_add_u32 m0, s52, 4096
    s_nop 0
    buffer_load_dwordx4 v28, s[8:11], s32 offen lds
    s_add_u32 m0, s52, 5120
    s_add_u32 s32, s33, 40960
    buffer_load_dwordx4 v24, s[8:11], s32 offen lds
    s_add_u32 m0, s52, 6144
    s_nop 0
    buffer_load_dwordx4 v25, s[8:11], s32 offen lds
    s_add_u32 m0, s52, 7168
    s_nop 0
    buffer_load_dwordx4 v26, s[8:11], s32 offen lds
    s_add_u32 m0, s52, 8192
    s_nop 0
    buffer_load_dwordx4 v27, s[8:11], s32 offen lds
    s_add_u32 m0, s52, 9216
    s_nop 0
    buffer_load_dwordx4 v28, s[8:11], s32 offen lds
    s_add_u32 m0, s52, 10240
    s_add_u32 s32, s33, 81920
    buffer_load_dwordx4 v24, s[8:11], s32 offen lds
    s_add_u32 m0, s52, 11264
    s_nop 0
    buffer_load_dwordx4 v25, s[8:11], s32 offen lds
    s_add_u32 m0, s52, 12288
    s_nop 0
    buffer_load_dwordx4 v26, s[8:11], s32 offen lds
    s_add_u32 m0, s52, 13312
    s_nop 0
    buffer_load_dwordx4 v27, s[8:11], s32 offen lds
    s_add_u32 m0, s52, 14336
    s_nop 0
    buffer_load_dwordx4 v28, s[8:11], s32 offen lds
    s_add_u32 m0, s52, 15360
    s_add_u32 s32, s33, 122880
    buffer_load_dwordx4 v24, s[8:11], s32 offen lds
    s_add_u32 m0, s52, 16384
    s_nop 0
    buffer_load_dwordx4 v25, s[8:11], s32 offen lds
    s_add_u32 m0, s52, 17408
    s_nop 0
    buffer_load_dwordx4 v26, s[8:11], s32 offen lds
    s_add_u32 m0, s52, 18432
    s_nop 0
    buffer_load_dwordx4 v27, s[8:11], s32 offen lds
    s_add_u32 m0, s52, 19456
    s_nop 0
    buffer_load_dwordx4 v28, s[8:11], s32 offen lds
    s_add_u32 m0, s52, 20480
    s_add_u32 s32, s33, 163840
    buffer_load_dwordx4 v24, s[8:11], s32 offen lds
    s_add_u32 m0, s52, 21504
    s_nop 0
    buffer_load_dwordx4 v25, s[8:11], s32 offen lds
    s_add_u32 m0, s52, 22528
    s_nop 0
    buffer_load_dwordx4 v26, s[8:11], s32 offen lds
    s_add_u32 m0, s52, 23552
    s_nop 0
    buffer_load_dwordx4 v27, s[8:11], s32 offen lds
    s_add_u32 m0, s52, 24576
    s_nop 0
    buffer_load_dwordx4 v28, s[8:11], s32 offen lds
    s_add_u32 m0, s52, 25600
    s_add_u32 s32, s33, 204800
    buffer_load_dwordx4 v24, s[8:11], s32 offen lds
    s_add_u32 m0, s52, 26624
    s_nop 0
    buffer_load_dwordx4 v25, s[8:11], s32 offen lds
    s_add_u32 m0, s52, 27648
    s_nop 0
    buffer_load_dwordx4 v26, s[8:11], s32 offen lds
    s_add_u32 m0, s52, 28672
    s_nop 0
    buffer_load_dwordx4 v27, s[8:11], s32 offen lds
    s_add_u32 m0, s52, 29696
    s_nop 0
    buffer_load_dwordx4 v28, s[8:11], s32 offen lds
    s_add_u32 m0, s52, 30720
    s_add_u32 s32, s33, 245760
    buffer_load_dwordx4 v24, s[8:11], s32 offen lds
    s_add_u32 m0, s52, 31744
    s_nop 0
    buffer_load_dwordx4 v25, s[8:11], s32 offen lds
    s_add_u32 m0, s52, 32768
    s_nop 0
    buffer_load_dwordx4 v26, s[8:11], s32 offen lds
    s_add_u32 m0, s52, 33792
    s_nop 0
    buffer_load_dwordx4 v27, s[8:11], s32 offen lds
    s_add_u32 m0, s52, 34816
    s_nop 0
    buffer_load_dwordx4 v28, s[8:11], s32 offen lds
    s_add_u32 m0, s52, 35840
    s_add_u32 s32, s33, 286720
    buffer_load_dwordx4 v24, s[8:11], s32 offen lds
    s_add_u32 m0, s52, 36864
    s_nop 0
    buffer_load_dwordx4 v25, s[8:11], s32 offen lds
    s_add_u32 m0, s52, 37888
    s_nop 0
    buffer_load_dwordx4 v26, s[8:11], s32 offen lds
    s_add_u32 m0, s52, 38912
    s_nop 0
    buffer_load_dwordx4 v27, s[8:11], s32 offen lds
    s_add_u32 m0, s52, 39936
    s_nop 0
    buffer_load_dwordx4 v28, s[8:11], s32 offen lds
    v_lshl_add_u32 v32, v19, 3, v30
    v_mul_u32_u24 v33, 160, v32
    v_lshl_add_u32 v33, v31, 3, v33
    v_add_u32 v33, s52, v33
    s_waitcnt vmcnt(35)
    ds_read_b64_tr_b16 a[0:1], v33 offset:0
    ds_read_b64_tr_b16 a[2:3], v33 offset:640
    ds_read_b64_tr_b16 a[4:5], v33 offset:32
    ds_read_b64_tr_b16 a[6:7], v33 offset:672
    ds_read_b64_tr_b16 a[8:9], v33 offset:64
    ds_read_b64_tr_b16 a[10:11], v33 offset:704
    ds_read_b64_tr_b16 a[12:13], v33 offset:96
    ds_read_b64_tr_b16 a[14:15], v33 offset:736
    ds_read_b64_tr_b16 a[16:17], v33 offset:128
    ds_read_b64_tr_b16 a[18:19], v33 offset:768
    s_waitcnt lgkmcnt(0)
    s_waitcnt vmcnt(30)
    ds_read_b64_tr_b16 a[20:21], v33 offset:5120
    ds_read_b64_tr_b16 a[22:23], v33 offset:5760
    ds_read_b64_tr_b16 a[24:25], v33 offset:5152
    ds_read_b64_tr_b16 a[26:27], v33 offset:5792
    ds_read_b64_tr_b16 a[28:29], v33 offset:5184
    ds_read_b64_tr_b16 a[30:31], v33 offset:5824
    ds_read_b64_tr_b16 a[32:33], v33 offset:5216
    ds_read_b64_tr_b16 a[34:35], v33 offset:5856
    ds_read_b64_tr_b16 a[36:37], v33 offset:5248
    ds_read_b64_tr_b16 a[38:39], v33 offset:5888
    s_waitcnt lgkmcnt(0)
    s_waitcnt vmcnt(25)
    ds_read_b64_tr_b16 a[40:41], v33 offset:10240
    ds_read_b64_tr_b16 a[42:43], v33 offset:10880
    ds_read_b64_tr_b16 a[44:45], v33 offset:10272
    ds_read_b64_tr_b16 a[46:47], v33 offset:10912
    ds_read_b64_tr_b16 a[48:49], v33 offset:10304
    ds_read_b64_tr_b16 a[50:51], v33 offset:10944
    ds_read_b64_tr_b16 a[52:53], v33 offset:10336
    ds_read_b64_tr_b16 a[54:55], v33 offset:10976
    ds_read_b64_tr_b16 a[56:57], v33 offset:10368
    ds_read_b64_tr_b16 a[58:59], v33 offset:11008
    s_waitcnt lgkmcnt(0)
    s_waitcnt vmcnt(20)
    ds_read_b64_tr_b16 a[60:61], v33 offset:15360
    ds_read_b64_tr_b16 a[62:63], v33 offset:16000
    ds_read_b64_tr_b16 a[64:65], v33 offset:15392
    ds_read_b64_tr_b16 a[66:67], v33 offset:16032
    ds_read_b64_tr_b16 a[68:69], v33 offset:15424
    ds_read_b64_tr_b16 a[70:71], v33 offset:16064
    ds_read_b64_tr_b16 a[72:73], v33 offset:15456
    ds_read_b64_tr_b16 a[74:75], v33 offset:16096
    ds_read_b64_tr_b16 a[76:77], v33 offset:15488
    ds_read_b64_tr_b16 a[78:79], v33 offset:16128
    s_waitcnt lgkmcnt(0)
    s_waitcnt vmcnt(15)
    ds_read_b64_tr_b16 a[80:81], v33 offset:20480
    ds_read_b64_tr_b16 a[82:83], v33 offset:21120
    ds_read_b64_tr_b16 a[84:85], v33 offset:20512
    ds_read_b64_tr_b16 a[86:87], v33 offset:21152
    ds_read_b64_tr_b16 a[88:89], v33 offset:20544
    ds_read_b64_tr_b16 a[90:91], v33 offset:21184
    ds_read_b64_tr_b16 a[92:93], v33 offset:20576
    ds_read_b64_tr_b16 a[94:95], v33 offset:21216
    ds_read_b64_tr_b16 a[96:97], v33 offset:20608
    ds_read_b64_tr_b16 a[98:99], v33 offset:21248
    s_waitcnt lgkmcnt(0)
    s_waitcnt vmcnt(10)
    ds_read_b64_tr_b16 a[100:101], v33 offset:25600
    ds_read_b64_tr_b16 a[102:103], v33 offset:26240
    ds_read_b64_tr_b16 a[104:105], v33 offset:25632
    ds_read_b64_tr_b16 a[106:107], v33 offset:26272
    ds_read_b64_tr_b16 a[108:109], v33 offset:25664
    ds_read_b64_tr_b16 a[110:111], v33 offset:26304
    ds_read_b64_tr_b16 a[112:113], v33 offset:25696
    ds_read_b64_tr_b16 a[114:115], v33 offset:26336
    ds_read_b64_tr_b16 a[116:117], v33 offset:25728
    ds_read_b64_tr_b16 a[118:119], v33 offset:26368
    s_waitcnt lgkmcnt(0)
    s_waitcnt vmcnt(5)
    ds_read_b64_tr_b16 a[120:121], v33 offset:30720
    ds_read_b64_tr_b16 a[122:123], v33 offset:31360
    ds_read_b64_tr_b16 a[124:125], v33 offset:30752
    ds_read_b64_tr_b16 a[126:127], v33 offset:31392
    ds_read_b64_tr_b16 a[128:129], v33 offset:30784
    ds_read_b64_tr_b16 a[130:131], v33 offset:31424
    ds_read_b64_tr_b16 a[132:133], v33 offset:30816
    ds_read_b64_tr_b16 a[134:135], v33 offset:31456
    ds_read_b64_tr_b16 a[136:137], v33 offset:30848
    ds_read_b64_tr_b16 a[138:139], v33 offset:31488
    s_waitcnt lgkmcnt(0)
    s_waitcnt vmcnt(0)
    ds_read_b64_tr_b16 a[140:141], v33 offset:35840
    ds_read_b64_tr_b16 a[142:143], v33 offset:36480
    ds_read_b64_tr_b16 a[144:145], v33 offset:35872
    ds_read_b64_tr_b16 a[146:147], v33 offset:36512
    ds_read_b64_tr_b16 a[148:149], v33 offset:35904
    ds_read_b64_tr_b16 a[150:151], v33 offset:36544
    ds_read_b64_tr_b16 a[152:153], v33 offset:35936
    ds_read_b64_tr_b16 a[154:155], v33 offset:36576
    ds_read_b64_tr_b16 a[156:157], v33 offset:35968
    ds_read_b64_tr_b16 a[158:159], v33 offset:36608
    s_waitcnt lgkmcnt(0)
    s_mul_i32 s33, s26, 573440
    s_mul_i32 s34, s56, 80
    s_add_u32 s33, s33, s34
    v_add_u32 v20, 0, v17
    v_mul_u32_u24 v21, 13108, v20
    v_lshrrev_b32 v21, 16, v21
    v_mul_u32_u24 v22, 5, v21
    v_sub_u32 v22, v20, v22
    v_mul_u32_u24 v21, 1280, v21
    v_lshl_add_u32 v24, v22, 4, v21
    v_add_u32 v20, 64, v17
    v_mul_u32_u24 v21, 13108, v20
    v_lshrrev_b32 v21, 16, v21
    v_mul_u32_u24 v22, 5, v21
    v_sub_u32 v22, v20, v22
    v_mul_u32_u24 v21, 1280, v21
    v_lshl_add_u32 v25, v22, 4, v21
    v_add_u32 v20, 128, v17
    v_mul_u32_u24 v21, 13108, v20
    v_lshrrev_b32 v21, 16, v21
    v_mul_u32_u24 v22, 5, v21
    v_sub_u32 v22, v20, v22
    v_mul_u32_u24 v21, 1280, v21
    v_lshl_add_u32 v26, v22, 4, v21
    v_add_u32 v20, 192, v17
    v_mul_u32_u24 v21, 13108, v20
    v_lshrrev_b32 v21, 16, v21
    v_mul_u32_u24 v22, 5, v21
    v_sub_u32 v22, v20, v22
    v_mul_u32_u24 v21, 1280, v21
    v_lshl_add_u32 v27, v22, 4, v21
    v_add_u32 v20, 256, v17
    v_mul_u32_u24 v21, 13108, v20
    v_lshrrev_b32 v21, 16, v21
    v_mul_u32_u24 v22, 5, v21
    v_sub_u32 v22, v20, v22
    v_mul_u32_u24 v21, 1280, v21
    v_lshl_add_u32 v28, v22, 4, v21
    s_add_u32 m0, s52, 0
    s_add_u32 s32, s33, 0
    buffer_load_dwordx4 v24, s[16:19], s32 offen lds
    s_add_u32 m0, s52, 1024
    s_nop 0
    buffer_load_dwordx4 v25, s[16:19], s32 offen lds
    s_add_u32 m0, s52, 2048
    s_nop 0
    buffer_load_dwordx4 v26, s[16:19], s32 offen lds
    s_add_u32 m0, s52, 3072
    s_nop 0
    buffer_load_dwordx4 v27, s[16:19], s32 offen lds
    s_add_u32 m0, s52, 4096
    s_nop 0
    buffer_load_dwordx4 v28, s[16:19], s32 offen lds
    s_add_u32 m0, s52, 5120
    s_add_u32 s32, s33, 81920
    buffer_load_dwordx4 v24, s[16:19], s32 offen lds
    s_add_u32 m0, s52, 6144
    s_nop 0
    buffer_load_dwordx4 v25, s[16:19], s32 offen lds
    s_add_u32 m0, s52, 7168
    s_nop 0
    buffer_load_dwordx4 v26, s[16:19], s32 offen lds
    s_add_u32 m0, s52, 8192
    s_nop 0
    buffer_load_dwordx4 v27, s[16:19], s32 offen lds
    s_add_u32 m0, s52, 9216
    s_nop 0
    buffer_load_dwordx4 v28, s[16:19], s32 offen lds
    s_add_u32 m0, s52, 10240
    s_add_u32 s32, s33, 163840
    buffer_load_dwordx4 v24, s[16:19], s32 offen lds
    s_add_u32 m0, s52, 11264
    s_nop 0
    buffer_load_dwordx4 v25, s[16:19], s32 offen lds
    s_add_u32 m0, s52, 12288
    s_nop 0
    buffer_load_dwordx4 v26, s[16:19], s32 offen lds
    s_add_u32 m0, s52, 13312
    s_nop 0
    buffer_load_dwordx4 v27, s[16:19], s32 offen lds
    s_add_u32 m0, s52, 14336
    s_nop 0
    buffer_load_dwordx4 v28, s[16:19], s32 offen lds
    s_add_u32 m0, s52, 15360
    s_add_u32 s32, s33, 245760
    buffer_load_dwordx4 v24, s[16:19], s32 offen lds
    s_add_u32 m0, s52, 16384
    s_nop 0
    buffer_load_dwordx4 v25, s[16:19], s32 offen lds
    s_add_u32 m0, s52, 17408
    s_nop 0
    buffer_load_dwordx4 v26, s[16:19], s32 offen lds
    s_add_u32 m0, s52, 18432
    s_nop 0
    buffer_load_dwordx4 v27, s[16:19], s32 offen lds
    s_add_u32 m0, s52, 19456
    s_nop 0
    buffer_load_dwordx4 v28, s[16:19], s32 offen lds
    s_add_u32 m0, s52, 20480
    s_add_u32 s32, s33, 327680
    buffer_load_dwordx4 v24, s[16:19], s32 offen lds
    s_add_u32 m0, s52, 21504
    s_nop 0
    buffer_load_dwordx4 v25, s[16:19], s32 offen lds
    s_add_u32 m0, s52, 22528
    s_nop 0
    buffer_load_dwordx4 v26, s[16:19], s32 offen lds
    s_add_u32 m0, s52, 23552
    s_nop 0
    buffer_load_dwordx4 v27, s[16:19], s32 offen lds
    s_add_u32 m0, s52, 24576
    s_nop 0
    buffer_load_dwordx4 v28, s[16:19], s32 offen lds
    s_add_u32 m0, s52, 25600
    s_add_u32 s32, s33, 409600
    buffer_load_dwordx4 v24, s[16:19], s32 offen lds
    s_add_u32 m0, s52, 26624
    s_nop 0
    buffer_load_dwordx4 v25, s[16:19], s32 offen lds
    s_add_u32 m0, s52, 27648
    s_nop 0
    buffer_load_dwordx4 v26, s[16:19], s32 offen lds
    s_add_u32 m0, s52, 28672
    s_nop 0
    buffer_load_dwordx4 v27, s[16:19], s32 offen lds
    s_add_u32 m0, s52, 29696
    s_nop 0
    buffer_load_dwordx4 v28, s[16:19], s32 offen lds
    s_add_u32 m0, s52, 30720
    s_add_u32 s32, s33, 491520
    buffer_load_dwordx4 v24, s[16:19], s32 offen lds
    s_add_u32 m0, s52, 31744
    s_nop 0
    buffer_load_dwordx4 v25, s[16:19], s32 offen lds
    s_add_u32 m0, s52, 32768
    s_nop 0
    buffer_load_dwordx4 v26, s[16:19], s32 offen lds
    s_add_u32 m0, s52, 33792
    s_nop 0
    buffer_load_dwordx4 v27, s[16:19], s32 offen lds
    s_add_u32 m0, s52, 34816
    s_nop 0
    buffer_load_dwordx4 v28, s[16:19], s32 offen lds
    v_mul_u32_u24 v33, 80, v32
    v_add_u32 v33, s52, v33
    v_and_b32 v34, 1, v31
    v_lshl_add_u32 v34, v34, 3, v33
    v_lshl_add_u32 v33, v31, 3, v33
    s_waitcnt vmcnt(30)
    ds_read_b64_tr_b16 a[240:241], v33 offset:0
    ds_read_b64_tr_b16 a[242:243], v33 offset:320
    ds_read_b64_tr_b16 a[244:245], v33 offset:32
    ds_read_b64_tr_b16 a[246:247], v33 offset:352
    ds_read_b64_tr_b16 a[248:249], v34 offset:64
    ds_read_b64_tr_b16 a[250:251], v34 offset:384
    s_waitcnt lgkmcnt(0)
    ds_read_b64_tr_b16 a[252:253], v33 offset:2560
    ds_read_b64_tr_b16 a[254:255], v33 offset:2880
    ds_read_b64_tr_b16 v[104:105], v33 offset:2592
    ds_read_b64_tr_b16 v[106:107], v33 offset:2912
    ds_read_b64_tr_b16 v[108:109], v34 offset:2624
    ds_read_b64_tr_b16 v[110:111], v34 offset:2944
    s_waitcnt lgkmcnt(0)
    s_waitcnt vmcnt(25)
    ds_read_b64_tr_b16 v[112:113], v33 offset:5120
    ds_read_b64_tr_b16 v[114:115], v33 offset:5440
    ds_read_b64_tr_b16 v[116:117], v33 offset:5152
    ds_read_b64_tr_b16 v[118:119], v33 offset:5472
    ds_read_b64_tr_b16 v[120:121], v34 offset:5184
    ds_read_b64_tr_b16 v[122:123], v34 offset:5504
    s_waitcnt lgkmcnt(0)
    ds_read_b64_tr_b16 v[124:125], v33 offset:7680
    ds_read_b64_tr_b16 v[126:127], v33 offset:8000
    ds_read_b64_tr_b16 v[128:129], v33 offset:7712
    ds_read_b64_tr_b16 v[130:131], v33 offset:8032
    ds_read_b64_tr_b16 v[132:133], v34 offset:7744
    ds_read_b64_tr_b16 v[134:135], v34 offset:8064
    s_waitcnt lgkmcnt(0)
    s_waitcnt vmcnt(20)
    ds_read_b64_tr_b16 v[136:137], v33 offset:10240
    ds_read_b64_tr_b16 v[138:139], v33 offset:10560
    ds_read_b64_tr_b16 v[140:141], v33 offset:10272
    ds_read_b64_tr_b16 v[142:143], v33 offset:10592
    ds_read_b64_tr_b16 v[144:145], v34 offset:10304
    ds_read_b64_tr_b16 v[146:147], v34 offset:10624
    s_waitcnt lgkmcnt(0)
    ds_read_b64_tr_b16 v[148:149], v33 offset:12800
    ds_read_b64_tr_b16 v[150:151], v33 offset:13120
    ds_read_b64_tr_b16 v[152:153], v33 offset:12832
    ds_read_b64_tr_b16 v[154:155], v33 offset:13152
    ds_read_b64_tr_b16 v[156:157], v34 offset:12864
    ds_read_b64_tr_b16 v[158:159], v34 offset:13184
    s_waitcnt lgkmcnt(0)
    s_waitcnt vmcnt(15)
    ds_read_b64_tr_b16 v[160:161], v33 offset:15360
    ds_read_b64_tr_b16 v[162:163], v33 offset:15680
    ds_read_b64_tr_b16 v[164:165], v33 offset:15392
    ds_read_b64_tr_b16 v[166:167], v33 offset:15712
    ds_read_b64_tr_b16 v[168:169], v34 offset:15424
    ds_read_b64_tr_b16 v[170:171], v34 offset:15744
    s_waitcnt lgkmcnt(0)
    ds_read_b64_tr_b16 v[172:173], v33 offset:17920
    ds_read_b64_tr_b16 v[174:175], v33 offset:18240
    ds_read_b64_tr_b16 v[176:177], v33 offset:17952
    ds_read_b64_tr_b16 v[178:179], v33 offset:18272
    ds_read_b64_tr_b16 v[180:181], v34 offset:17984
    ds_read_b64_tr_b16 v[182:183], v34 offset:18304
    s_waitcnt lgkmcnt(0)
    s_waitcnt vmcnt(10)
    ds_read_b64_tr_b16 v[184:185], v33 offset:20480
    ds_read_b64_tr_b16 v[186:187], v33 offset:20800
    ds_read_b64_tr_b16 v[188:189], v33 offset:20512
    ds_read_b64_tr_b16 v[190:191], v33 offset:20832
    ds_read_b64_tr_b16 v[192:193], v34 offset:20544
    ds_read_b64_tr_b16 v[194:195], v34 offset:20864
    s_waitcnt lgkmcnt(0)
    ds_read_b64_tr_b16 v[196:197], v33 offset:23040
    ds_read_b64_tr_b16 v[198:199], v33 offset:23360
    ds_read_b64_tr_b16 v[200:201], v33 offset:23072
    ds_read_b64_tr_b16 v[202:203], v33 offset:23392
    ds_read_b64_tr_b16 v[204:205], v34 offset:23104
    ds_read_b64_tr_b16 v[206:207], v34 offset:23424
    s_waitcnt lgkmcnt(0)
    s_waitcnt vmcnt(5)
    ds_read_b64_tr_b16 v[208:209], v33 offset:25600
    ds_read_b64_tr_b16 v[210:211], v33 offset:25920
    ds_read_b64_tr_b16 v[212:213], v33 offset:25632
    ds_read_b64_tr_b16 v[214:215], v33 offset:25952
    ds_read_b64_tr_b16 v[216:217], v34 offset:25664
    ds_read_b64_tr_b16 v[218:219], v34 offset:25984
    s_waitcnt lgkmcnt(0)
    ds_read_b64_tr_b16 v[220:221], v33 offset:28160
    ds_read_b64_tr_b16 v[222:223], v33 offset:28480
    ds_read_b64_tr_b16 v[224:225], v33 offset:28192
    ds_read_b64_tr_b16 v[226:227], v33 offset:28512
    ds_read_b64_tr_b16 v[228:229], v34 offset:28224
    ds_read_b64_tr_b16 v[230:231], v34 offset:28544
    s_waitcnt lgkmcnt(0)
    s_waitcnt vmcnt(0)
    ds_read_b64_tr_b16 v[232:233], v33 offset:30720
    ds_read_b64_tr_b16 v[234:235], v33 offset:31040
    ds_read_b64_tr_b16 v[236:237], v33 offset:30752
    ds_read_b64_tr_b16 v[238:239], v33 offset:31072
    ds_read_b64_tr_b16 v[240:241], v34 offset:30784
    ds_read_b64_tr_b16 v[242:243], v34 offset:31104
    s_waitcnt lgkmcnt(0)
    ds_read_b64_tr_b16 v[244:245], v33 offset:33280
    ds_read_b64_tr_b16 v[246:247], v33 offset:33600
    ds_read_b64_tr_b16 v[248:249], v33 offset:33312
    ds_read_b64_tr_b16 v[250:251], v33 offset:33632
    ds_read_b64_tr_b16 v[252:253], v34 offset:33344
    ds_read_b64_tr_b16 v[254:255], v34 offset:33664
    s_waitcnt lgkmcnt(0)
    s_lshl_b32 s33, s57, 7
    s_lshl_b32 s34, s26, 5
    s_add_u32 s33, s33, s34
    v_add_u32 v20, 0, v17
    v_lshrrev_b32 v21, 1, v20
    v_mul_u32_u24 v22, 2, v21
    v_sub_u32 v22, v20, v22
    v_mul_u32_u24 v21, 3456, v21
    v_lshl_add_u32 v24, v22, 4, v21
    s_add_u32 m0, s52, 0
    s_add_u32 s32, s33, 0
    buffer_load_dwordx4 v24, s[12:15], s32 offen lds
    s_add_u32 m0, s52, 1024
    s_add_u32 s32, s33, 110592
    buffer_load_dwordx4 v24, s[12:15], s32 offen lds
    s_add_u32 m0, s52, 2048
    s_add_u32 s32, s33, 221184
    buffer_load_dwordx4 v24, s[12:15], s32 offen lds
    s_add_u32 m0, s52, 3072
    s_add_u32 s32, s33, 331776
    buffer_load_dwordx4 v24, s[12:15], s32 offen lds
    s_add_u32 m0, s52, 4096
    s_add_u32 s32, s33, 442368
    buffer_load_dwordx4 v24, s[12:15], s32 offen lds
    s_add_u32 m0, s52, 5120
    s_add_u32 s32, s33, 552960
    buffer_load_dwordx4 v24, s[12:15], s32 offen lds
    s_add_u32 m0, s52, 6144
    s_add_u32 s32, s33, 663552
    buffer_load_dwordx4 v24, s[12:15], s32 offen lds
    s_add_u32 m0, s52, 7168
    s_add_u32 s32, s33, 774144
    buffer_load_dwordx4 v24, s[12:15], s32 offen lds
    s_add_u32 m0, s52, 8192
    s_add_u32 s32, s33, 884736
    buffer_load_dwordx4 v24, s[12:15], s32 offen lds
    s_add_u32 m0, s52, 9216
    s_add_u32 s32, s33, 995328
    buffer_load_dwordx4 v24, s[12:15], s32 offen lds
    s_add_u32 m0, s52, 10240
    s_add_u32 s32, s33, 1105920
    buffer_load_dwordx4 v24, s[12:15], s32 offen lds
    s_add_u32 m0, s52, 11264
    s_add_u32 s32, s33, 1216512
    buffer_load_dwordx4 v24, s[12:15], s32 offen lds
    s_add_u32 m0, s52, 12288
    s_add_u32 s32, s33, 1327104
    buffer_load_dwordx4 v24, s[12:15], s32 offen lds
    s_add_u32 m0, s52, 13312
    s_add_u32 s32, s33, 1437696
    buffer_load_dwordx4 v24, s[12:15], s32 offen lds
    s_add_u32 m0, s52, 14336
    s_add_u32 s32, s33, 1548288
    buffer_load_dwordx4 v24, s[12:15], s32 offen lds
    s_add_u32 m0, s52, 15360
    s_add_u32 s32, s33, 1658880
    buffer_load_dwordx4 v24, s[12:15], s32 offen lds
    s_add_u32 m0, s52, 16384
    s_add_u32 s32, s33, 1769472
    buffer_load_dwordx4 v24, s[12:15], s32 offen lds
    s_add_u32 m0, s52, 17408
    s_add_u32 s32, s33, 1880064
    buffer_load_dwordx4 v24, s[12:15], s32 offen lds
    s_add_u32 m0, s52, 18432
    s_add_u32 s32, s33, 1990656
    buffer_load_dwordx4 v24, s[12:15], s32 offen lds
    s_add_u32 m0, s52, 19456
    s_add_u32 s32, s33, 2101248
    buffer_load_dwordx4 v24, s[12:15], s32 offen lds
    v_lshlrev_b32 v33, 5, v32
    v_lshl_add_u32 v33, v31, 3, v33
    v_add_u32 v33, s52, v33
    s_waitcnt vmcnt(19)
    ds_read_b64_tr_b16 a[160:161], v33 offset:0
    ds_read_b64_tr_b16 a[162:163], v33 offset:128
    s_waitcnt vmcnt(18)
    ds_read_b64_tr_b16 a[164:165], v33 offset:1024
    ds_read_b64_tr_b16 a[166:167], v33 offset:1152
    s_waitcnt vmcnt(17)
    ds_read_b64_tr_b16 a[168:169], v33 offset:2048
    ds_read_b64_tr_b16 a[170:171], v33 offset:2176
    s_waitcnt vmcnt(16)
    ds_read_b64_tr_b16 a[172:173], v33 offset:3072
    ds_read_b64_tr_b16 a[174:175], v33 offset:3200
    s_waitcnt lgkmcnt(0)
    s_waitcnt vmcnt(15)
    ds_read_b64_tr_b16 a[176:177], v33 offset:4096
    ds_read_b64_tr_b16 a[178:179], v33 offset:4224
    s_waitcnt vmcnt(14)
    ds_read_b64_tr_b16 a[180:181], v33 offset:5120
    ds_read_b64_tr_b16 a[182:183], v33 offset:5248
    s_waitcnt vmcnt(13)
    ds_read_b64_tr_b16 a[184:185], v33 offset:6144
    ds_read_b64_tr_b16 a[186:187], v33 offset:6272
    s_waitcnt vmcnt(12)
    ds_read_b64_tr_b16 a[188:189], v33 offset:7168
    ds_read_b64_tr_b16 a[190:191], v33 offset:7296
    s_waitcnt lgkmcnt(0)
    s_waitcnt vmcnt(11)
    ds_read_b64_tr_b16 a[192:193], v33 offset:8192
    ds_read_b64_tr_b16 a[194:195], v33 offset:8320
    s_waitcnt vmcnt(10)
    ds_read_b64_tr_b16 a[196:197], v33 offset:9216
    ds_read_b64_tr_b16 a[198:199], v33 offset:9344
    s_waitcnt vmcnt(9)
    ds_read_b64_tr_b16 a[200:201], v33 offset:10240
    ds_read_b64_tr_b16 a[202:203], v33 offset:10368
    s_waitcnt vmcnt(8)
    ds_read_b64_tr_b16 a[204:205], v33 offset:11264
    ds_read_b64_tr_b16 a[206:207], v33 offset:11392
    s_waitcnt lgkmcnt(0)
    s_waitcnt vmcnt(7)
    ds_read_b64_tr_b16 a[208:209], v33 offset:12288
    ds_read_b64_tr_b16 a[210:211], v33 offset:12416
    s_waitcnt vmcnt(6)
    ds_read_b64_tr_b16 a[212:213], v33 offset:13312
    ds_read_b64_tr_b16 a[214:215], v33 offset:13440
    s_waitcnt vmcnt(5)
    ds_read_b64_tr_b16 a[216:217], v33 offset:14336
    ds_read_b64_tr_b16 a[218:219], v33 offset:14464
    s_waitcnt vmcnt(4)
    ds_read_b64_tr_b16 a[220:221], v33 offset:15360
    ds_read_b64_tr_b16 a[222:223], v33 offset:15488
    s_waitcnt lgkmcnt(0)
    s_waitcnt vmcnt(3)
    ds_read_b64_tr_b16 a[224:225], v33 offset:16384
    ds_read_b64_tr_b16 a[226:227], v33 offset:16512
    s_waitcnt vmcnt(2)
    ds_read_b64_tr_b16 a[228:229], v33 offset:17408
    ds_read_b64_tr_b16 a[230:231], v33 offset:17536
    s_waitcnt vmcnt(1)
    ds_read_b64_tr_b16 a[232:233], v33 offset:18432
    ds_read_b64_tr_b16 a[234:235], v33 offset:18560
    s_waitcnt vmcnt(0)
    ds_read_b64_tr_b16 a[236:237], v33 offset:19456
    ds_read_b64_tr_b16 a[238:239], v33 offset:19584
    s_waitcnt lgkmcnt(0)
    s_load_dwordx2 s[8:9], s[0:1], 72
    s_load_dwordx2 s[12:13], s[0:1], 88
    s_load_dwordx2 s[16:17], s[0:1], 0
    s_load_dwordx2 s[20:21], s[0:1], 112
    v_mbcnt_lo_u32_b32 v11, -1, 0
    v_lshlrev_b32 v11, 2, v11
    s_mov_b64 exec, 53
L_gs_220:
    global_load_dword v12, v11, s[96:97] offset:128 sc1
    s_waitcnt vmcnt(0)
    v_cmp_eq_u32 vcc, 0, v12
    s_cbranch_vccz L_gsd_221
    s_sleep 2
    s_sub_u32 s31, s31, 1
    s_cbranch_scc1 L_exit
    s_branch L_gs_220
L_gsd_221:
    s_mov_b64 exec, -1
    v_readlane_b32 s99, v12, 0
    s_nop 0
    s_cmp_eq_u32 s99, 1
    s_cselect_b32 s3, 1, 0
    v_readlane_b32 s2, v12, 4
    s_nop 0
    s_and_b32 s2, s2, 1
    s_lshl_b32 s2, s2, 13
    s_lshl_b32 s32, s27, 14
    s_add_u32 s2, s2, s32
    s_add_u32 s2, s2, 65536
    s_waitcnt lgkmcnt(0)
    s_barrier
    s_mov_b32 s10, 3456
    s_mov_b32 s11, 0x20000
    s_mov_b32 s14, 1280
    s_mov_b32 s15, 0x20000
    s_mov_b32 s18, 2621440
    s_mov_b32 s19, 0x20000
    s_mov_b32 s22, 2621440
    s_mov_b32 s23, 0x20000
    s_cmp_lg_u32 s26, 0
    s_cbranch_scc1 L_par_222
    s_mov_b32 m0, 81920
    s_mov_b32 s32, 3675136
    buffer_load_dwordx4 v1, s[4:7], s32 offen sc1 lds
    s_mov_b32 m0, 82944
    s_mov_b32 s32, 3676160
    buffer_load_dwordx4 v1, s[4:7], s32 offen sc1 lds
    s_mov_b32 m0, 83968
    s_mov_b32 s32, 3677184
    buffer_load_dwordx4 v1, s[4:7], s32 offen sc1 lds
    s_mov_b32 m0, 84992
    s_mov_b32 s32, 3678208
    buffer_load_dwordx4 v1, s[4:7], s32 offen sc1 lds
    s_mov_b32 m0, 86016
    s_mov_b32 s32, 3679232
    buffer_load_dwordx4 v1, s[4:7], s32 offen sc1 lds
    s_mov_b32 m0, 87040
    s_mov_b32 s32, 3680256
    buffer_load_dwordx4 v1, s[4:7], s32 offen sc1 lds
    s_mov_b32 m0, 88064
    s_mov_b32 s32, 3681280
    buffer_load_dwordx4 v1, s[4:7], s32 offen sc1 lds
    s_mov_b32 m0, 89088
    s_mov_b32 s32, 3682304
    buffer_load_dwordx4 v1, s[4:7], s32 offen sc1 lds
    s_mov_b32 m0, 90112
    s_mov_b32 s32, 3683328
    buffer_load_dwordx4 v1, s[4:7], s32 offen sc1 lds
    s_mov_b32 m0, 91136
    s_mov_b32 s32, 3684352
    buffer_load_dwordx4 v1, s[4:7], s32 offen sc1 lds
    v_lshlrev_b32 v20, 1, v17
    s_lshl_b32 s32, s57, 7
    s_mul_i32 s33, s56, 80
    buffer_load_ushort v21, v20, s[8:11], s32 offen
    buffer_load_ushort v22, v20, s[12:15], s33 offen
    v_add_u32 v20, 92160, v2
    s_waitcnt vmcnt(0)
    v_lshlrev_b32 v21, 16, v21
    v_lshlrev_b32 v22, 16, v22
    ds_write_b32 v20, v21
    ds_write_b32 v20, v22 offset:256
    s_waitcnt lgkmcnt(0)
L_par_222:
    s_lshl_b32 s32, s53, 3
    s_lshl_b32 s33, s26, 1
    s_add_u32 s32, s32, s33
    v_add_u32 v3, s32, v17
    v_lshlrev_b32 v3, 8, v3
    s_lshl_b32 s40, s32, 12
    s_add_u32 s40, s40, 50331648
    s_mul_i32 s32, s26, 10240
    v_lshl_add_u32 v21, v19, 2, v18
    v_and_b32 v21, 15, v21
    v_lshlrev_b32 v21, 4, v21
    v_lshl_add_u32 v21, v19, 8, v21
    v_add_u32 v4, s32, v21
    v_lshrrev_b32 v20, 2, v17
    v_lshl_add_u32 v21, v31, 2, v20
    v_and_b32 v21, 15, v21
    v_lshlrev_b32 v21, 4, v21
    v_lshl_add_u32 v21, v31, 8, v21
    s_lshl_b32 s32, s26, 10
    v_add_u32 v5, s32, v21
    v_mul_u32_u24 v21, 10240, v20
    v_lshl_add_u32 v6, v31, 4, v21
    s_mul_i32 s41, s53, 2560
    s_mul_i32 s32, s54, 320
    s_add_u32 s41, s41, s32
    s_add_u32 s41, s41, 83886080
    s_mul_i32 s42, s25, 10240
    s_add_u32 s42, s42, 83886080
    s_mul_i32 s43, s25, 1280
    s_mul_i32 s44, s25, 2560
    s_add_u32 s44, s44, 10485760
    s_lshl_b32 s45, s25, 8
    s_add_u32 s45, s45, 7340032
    v_xor_b32 v22, s56, v20
    v_lshlrev_b32 v21, 2, v31
    v_lshl_add_u32 v7, v22, 4, v21
    v_xor_b32 v22, v18, v19
    v_lshlrev_b32 v22, 4, v22
    v_lshl_add_u32 v22, v18, 8, v22
    v_add_u32 v0, 40960, v22
    v_and_b32 v21, 1, v19
    v_mul_u32_u24 v21, 55296, v21
    v_lshrrev_b32 v22, 1, v19
    v_lshl_add_u32 v21, v22, 8, v21
    v_lshl_add_u32 v21, v18, 4, v21
    s_and_b32 s32, s26, 1
    s_lshl_b32 s32, s32, 9
    v_add_u32 v8, s32, v21
    s_lshr_b32 s32, s26, 1
    s_lshl_b32 s33, s57, 1
    s_add_u32 s32, s32, s33
    s_lshl_b32 s47, s32, 10
    s_add_u32 s47, s47, 117440512
    s_mul_i32 s48, s55, 55296
    s_mul_i32 s32, s26, 14336
    s_add_u32 s48, s48, s32
    s_add_u32 s48, s48, 117440512
    s_cmp_eq_u32 s26, 3
    s_cselect_b32 s49, 10, 12
    s_lshl_b32 s49, s49, 10
    v_mul_u32_u24 v21, 1280, v20
    v_lshl_add_u32 v9, v31, 3, v21
    v_lshlrev_b32 v10, 1, v9
    s_mul_i32 s51, s55, 20480
    s_mul_i32 s32, s56, 80
    s_add_u32 s51, s51, s32
    s_lshl_b32 s32, s26, 5
    s_add_u32 s51, s51, s32
    s_lshl_b32 s50, s51, 1
    s_add_u32 s50, s50, 10485760
    s_lshl_b32 s46, s26, 11
    s_lshl_b32 s39, s27, 7
    s_mov_b32 s28, 0
    s_mov_b32 s58, 0x33333333
    s_cmp_eq_u32 s26, 2
    s_cselect_b32 s58, s58, -1
    s_mov_b32 s59, s58
    s_barrier
    s_cmp_eq_u32 s27, 0
    s_cselect_b32 s14, 1227133513, s14
    s_cselect_b32 s15, 554189330, s15
    s_cmp_eq_u32 s27, 1
    s_cselect_b32 s14, 2454267026, s14
    s_cselect_b32 s15, 1108378660, s15
    s_cmp_eq_u32 s27, 2
    s_cselect_b32 s14, 613566756, s14
    s_cselect_b32 s15, 2216757321, s15
    s_cmp_eq_u32 s27, 3
    s_cselect_b32 s14, 0, s14
    s_cselect_b32 s15, 138547328, s15
    s_cmp_eq_u32 s27, 4
    s_cselect_b32 s14, 0, s14
    s_cselect_b32 s15, 277094656, s15
    s_ff1_i32_b64 s29, s[14:15]
    s_cmp_lt_i32 s29, 0
    s_cbranch_scc1 L_exit
    s_cmp_eq_u32 s3, 0
    s_cbranch_scc1 L_tslow_223
L_team_224:
    s_add_u32 s30, s29, 1
    s_mov_b32 s53, s27
    s_cmp_lg_u32 s28, 0
    s_cbranch_scc1 L_wog_225
    s_mov_b64 exec, 3
L_wf_226:
    buffer_load_dword v11, v3, s[4:7], s2 offen sc1
    s_waitcnt vmcnt(0)
    v_cmp_gt_u32 vcc, s30, v11
    s_cbranch_vccz L_wfd_227
    s_sub_u32 s31, s31, 1
    s_cbranch_scc1 L_exit
    s_branch L_wf_226
L_wfd_227:
    s_mov_b64 exec, -1
    s_lshl_b32 s32, s29, 18
    s_add_u32 s8, s32, s40
    s_add_u32 s9, s8, 4096
    s_add_u32 s10, s8, 131072
    s_add_u32 s11, s9, 131072
    s_mul_i32 s32, s29, 40960
    s_add_u32 s32, s32, s43
    s_lshl_b32 s35, s26, 10
    s_add_u32 s32, s32, s35
    s_add_u32 m0, s35, 94208
    s_nop 0
    buffer_load_dwordx4 v1, s[16:19], s32 offen lds
    buffer_load_dwordx4 v[16:19], v1, s[4:7], s8 offen offset:0 sc1
    buffer_load_dwordx4 v[20:23], v1, s[4:7], s8 offen offset:1024 sc1
    buffer_load_dwordx4 v[24:27], v1, s[4:7], s8 offen offset:2048 sc1
    buffer_load_dwordx4 v[28:31], v1, s[4:7], s8 offen offset:3072 sc1
    buffer_load_dwordx4 v[32:35], v1, s[4:7], s9 offen offset:0 sc1
    buffer_load_dwordx4 v[36:39], v1, s[4:7], s9 offen offset:1024 sc1
    buffer_load_dwordx4 v[40:43], v1, s[4:7], s9 offen offset:2048 sc1
    buffer_load_dwordx4 v[44:47], v1, s[4:7], s9 offen offset:3072 sc1
    buffer_load_dwordx4 v[48:51], v1, s[4:7], s10 offen offset:0 sc1
    buffer_load_dwordx4 v[52:55], v1, s[4:7], s10 offen offset:1024 sc1
    buffer_load_dwordx4 v[56:59], v1, s[4:7], s10 offen offset:2048 sc1
    buffer_load_dwordx4 v[60:63], v1, s[4:7], s10 offen offset:3072 sc1
L_wog_225:
    s_waitcnt vmcnt(11)
    v_mfma_f32_16x16x32_bf16 v[64:67], a[0:3], v[16:19], 0
    v_mfma_f32_16x16x32_bf16 v[68:71], a[4:7], v[16:19], 0
    v_mfma_f32_16x16x32_bf16 v[72:75], a[8:11], v[16:19], 0
    v_mfma_f32_16x16x32_bf16 v[76:79], a[12:15], v[16:19], 0
    v_mfma_f32_16x16x32_bf16 v[80:83], a[16:19], v[16:19], 0
    buffer_load_dwordx4 v[16:19], v1, s[4:7], s11 offen offset:0 sc1
    s_waitcnt vmcnt(11)
    v_mfma_f32_16x16x32_bf16 v[64:67], a[20:23], v[20:23], v[64:67]
    v_mfma_f32_16x16x32_bf16 v[68:71], a[24:27], v[20:23], v[68:71]
    v_mfma_f32_16x16x32_bf16 v[72:75], a[28:31], v[20:23], v[72:75]
    v_mfma_f32_16x16x32_bf16 v[76:79], a[32:35], v[20:23], v[76:79]
    v_mfma_f32_16x16x32_bf16 v[80:83], a[36:39], v[20:23], v[80:83]
    buffer_load_dwordx4 v[20:23], v1, s[4:7], s11 offen offset:1024 sc1
    s_waitcnt vmcnt(11)
    v_mfma_f32_16x16x32_bf16 v[64:67], a[40:43], v[24:27], v[64:67]
    v_mfma_f32_16x16x32_bf16 v[68:71], a[44:47], v[24:27], v[68:71]
    v_mfma_f32_16x16x32_bf16 v[72:75], a[48:51], v[24:27], v[72:75]
    v_mfma_f32_16x16x32_bf16 v[76:79], a[52:55], v[24:27], v[76:79]
    v_mfma_f32_16x16x32_bf16 v[80:83], a[56:59], v[24:27], v[80:83]
    buffer_load_dwordx4 v[24:27], v1, s[4:7], s11 offen offset:2048 sc1
    s_waitcnt vmcnt(11)
    v_mfma_f32_16x16x32_bf16 v[64:67], a[60:63], v[28:31], v[64:67]
    v_mfma_f32_16x16x32_bf16 v[68:71], a[64:67], v[28:31], v[68:71]
    v_mfma_f32_16x16x32_bf16 v[72:75], a[68:71], v[28:31], v[72:75]
    v_mfma_f32_16x16x32_bf16 v[76:79], a[72:75], v[28:31], v[76:79]
    v_mfma_f32_16x16x32_bf16 v[80:83], a[76:79], v[28:31], v[80:83]
    buffer_load_dwordx4 v[28:31], v1, s[4:7], s11 offen offset:3072 sc1
    s_waitcnt vmcnt(11)
    v_mfma_f32_16x16x32_bf16 v[64:67], a[80:83], v[32:35], v[64:67]
    v_mfma_f32_16x16x32_bf16 v[68:71], a[84:87], v[32:35], v[68:71]
    v_mfma_f32_16x16x32_bf16 v[72:75], a[88:91], v[32:35], v[72:75]
    v_mfma_f32_16x16x32_bf16 v[76:79], a[92:95], v[32:35], v[76:79]
    v_mfma_f32_16x16x32_bf16 v[80:83], a[96:99], v[32:35], v[80:83]
    s_waitcnt vmcnt(10)
    v_mfma_f32_16x16x32_bf16 v[64:67], a[100:103], v[36:39], v[64:67]
    v_mfma_f32_16x16x32_bf16 v[68:71], a[104:107], v[36:39], v[68:71]
    v_mfma_f32_16x16x32_bf16 v[72:75], a[108:111], v[36:39], v[72:75]
    v_mfma_f32_16x16x32_bf16 v[76:79], a[112:115], v[36:39], v[76:79]
    v_mfma_f32_16x16x32_bf16 v[80:83], a[116:119], v[36:39], v[80:83]
    s_waitcnt vmcnt(9)
    v_mfma_f32_16x16x32_bf16 v[64:67], a[120:123], v[40:43], v[64:67]
    v_mfma_f32_16x16x32_bf16 v[68:71], a[124:127], v[40:43], v[68:71]
    v_mfma_f32_16x16x32_bf16 v[72:75], a[128:131], v[40:43], v[72:75]
    v_mfma_f32_16x16x32_bf16 v[76:79], a[132:135], v[40:43], v[76:79]
    v_mfma_f32_16x16x32_bf16 v[80:83], a[136:139], v[40:43], v[80:83]
    s_waitcnt vmcnt(8)
    v_mfma_f32_16x16x32_bf16 v[64:67], a[140:143], v[44:47], v[64:67]
    v_mfma_f32_16x16x32_bf16 v[68:71], a[144:147], v[44:47], v[68:71]
    v_mfma_f32_16x16x32_bf16 v[72:75], a[148:151], v[44:47], v[72:75]
    v_mfma_f32_16x16x32_bf16 v[76:79], a[152:155], v[44:47], v[76:79]
    v_mfma_f32_16x16x32_bf16 v[80:83], a[156:159], v[44:47], v[80:83]
    s_waitcnt vmcnt(7)
    v_mfma_f32_16x16x32_bf16 v[84:87], a[0:3], v[48:51], 0
    v_mfma_f32_16x16x32_bf16 v[88:91], a[4:7], v[48:51], 0
    v_mfma_f32_16x16x32_bf16 v[92:95], a[8:11], v[48:51], 0
    v_mfma_f32_16x16x32_bf16 v[96:99], a[12:15], v[48:51], 0
    v_mfma_f32_16x16x32_bf16 v[100:103], a[16:19], v[48:51], 0
    s_waitcnt vmcnt(6)
    v_mfma_f32_16x16x32_bf16 v[84:87], a[20:23], v[52:55], v[84:87]
    v_mfma_f32_16x16x32_bf16 v[88:91], a[24:27], v[52:55], v[88:91]
    v_mfma_f32_16x16x32_bf16 v[92:95], a[28:31], v[52:55], v[92:95]
    v_mfma_f32_16x16x32_bf16 v[96:99], a[32:35], v[52:55], v[96:99]
    v_mfma_f32_16x16x32_bf16 v[100:103], a[36:39], v[52:55], v[100:103]
    ds_write_b128 v4, v[64:67] offset:0
    s_waitcnt vmcnt(5)
    v_mfma_f32_16x16x32_bf16 v[84:87], a[40:43], v[56:59], v[84:87]
    v_mfma_f32_16x16x32_bf16 v[88:91], a[44:47], v[56:59], v[88:91]
    v_mfma_f32_16x16x32_bf16 v[92:95], a[48:51], v[56:59], v[92:95]
    v_mfma_f32_16x16x32_bf16 v[96:99], a[52:55], v[56:59], v[96:99]
    v_mfma_f32_16x16x32_bf16 v[100:103], a[56:59], v[56:59], v[100:103]
    ds_write_b128 v4, v[68:71] offset:1024
    s_waitcnt vmcnt(4)
    v_mfma_f32_16x16x32_bf16 v[84:87], a[60:63], v[60:63], v[84:87]
    v_mfma_f32_16x16x32_bf16 v[88:91], a[64:67], v[60:63], v[88:91]
    v_mfma_f32_16x16x32_bf16 v[92:95], a[68:71], v[60:63], v[92:95]
    v_mfma_f32_16x16x32_bf16 v[96:99], a[72:75], v[60:63], v[96:99]
    v_mfma_f32_16x16x32_bf16 v[100:103], a[76:79], v[60:63], v[100:103]
    ds_write_b128 v4, v[72:75] offset:2048
    s_waitcnt vmcnt(3)
    v_mfma_f32_16x16x32_bf16 v[84:87], a[80:83], v[16:19], v[84:87]
    v_mfma_f32_16x16x32_bf16 v[88:91], a[84:87], v[16:19], v[88:91]
    v_mfma_f32_16x16x32_bf16 v[92:95], a[88:91], v[16:19], v[92:95]
    v_mfma_f32_16x16x32_bf16 v[96:99], a[92:95], v[16:19], v[96:99]
    v_mfma_f32_16x16x32_bf16 v[100:103], a[96:99], v[16:19], v[100:103]
    ds_write_b128 v4, v[76:79] offset:3072
    s_waitcnt vmcnt(2)
    v_mfma_f32_16x16x32_bf16 v[84:87], a[100:103], v[20:23], v[84:87]
    v_mfma_f32_16x16x32_bf16 v[88:91], a[104:107], v[20:23], v[88:91]
    v_mfma_f32_16x16x32_bf16 v[92:95], a[108:111], v[20:23], v[92:95]
    v_mfma_f32_16x16x32_bf16 v[96:99], a[112:115], v[20:23], v[96:99]
    v_mfma_f32_16x16x32_bf16 v[100:103], a[116:119], v[20:23], v[100:103]
    ds_write_b128 v4, v[80:83] offset:4096
    s_waitcnt vmcnt(1)
    v_mfma_f32_16x16x32_bf16 v[84:87], a[120:123], v[24:27], v[84:87]
    v_mfma_f32_16x16x32_bf16 v[88:91], a[124:127], v[24:27], v[88:91]
    v_mfma_f32_16x16x32_bf16 v[92:95], a[128:131], v[24:27], v[92:95]
    v_mfma_f32_16x16x32_bf16 v[96:99], a[132:135], v[24:27], v[96:99]
    v_mfma_f32_16x16x32_bf16 v[100:103], a[136:139], v[24:27], v[100:103]
    s_waitcnt vmcnt(0)
    v_mfma_f32_16x16x32_bf16 v[84:87], a[140:143], v[28:31], v[84:87]
    v_mfma_f32_16x16x32_bf16 v[88:91], a[144:147], v[28:31], v[88:91]
    v_mfma_f32_16x16x32_bf16 v[92:95], a[148:151], v[28:31], v[92:95]
    v_mfma_f32_16x16x32_bf16 v[96:99], a[152:155], v[28:31], v[96:99]
    v_mfma_f32_16x16x32_bf16 v[100:103], a[156:159], v[28:31], v[100:103]
    s_mul_i32 s32, s53, 327680
    s_add_u32 s33, s32, s41
    s_nop 1
    ds_write_b128 v4, v[84:87] offset:5120
    ds_write_b128 v4, v[88:91] offset:6144
    ds_write_b128 v4, v[92:95] offset:7168
    ds_write_b128 v4, v[96:99] offset:8192
    ds_write_b128 v4, v[100:103] offset:9216
    s_waitcnt lgkmcnt(0)
    s_barrier
    ds_read_b128 v[16:19], v5 offset:0
    ds_read_b128 v[20:23], v5 offset:10240
    ds_read_b128 v[24:27], v5 offset:20480
    ds_read_b128 v[28:31], v5 offset:30720
    ds_read_b128 v[32:35], v5 offset:4096
    ds_read_b128 v[36:39], v5 offset:14336
    ds_read_b128 v[40:43], v5 offset:24576
    ds_read_b128 v[44:47], v5 offset:34816
    ds_read_b128 v[48:51], v5 offset:8192
    ds_read_b128 v[52:55], v5 offset:18432
    ds_read_b128 v[56:59], v5 offset:28672
    ds_read_b128 v[60:63], v5 offset:38912
    s_waitcnt lgkmcnt(8)
    s_add_u32 s34, s26, 0
    s_cmp_ge_u32 s34, 5
    s_cselect_b32 s35, 163520, 0
    s_lshl_b32 s34, s34, 6
    s_add_u32 s34, s34, s35
    s_add_u32 s34, s34, s33
    v_pk_add_f32 v[16:17], v[16:17], v[20:21]
    v_pk_add_f32 v[24:25], v[24:25], v[28:29]
    v_pk_add_f32 v[16:17], v[16:17], v[24:25]
    v_pk_add_f32 v[18:19], v[18:19], v[22:23]
    v_pk_add_f32 v[26:27], v[26:27], v[30:31]
    v_pk_add_f32 v[18:19], v[18:19], v[26:27]
    buffer_store_dwordx4 v[16:19], v6, s[4:7], s34 offen
    s_waitcnt lgkmcnt(4)
    s_add_u32 s34, s26, 4
    s_cmp_ge_u32 s34, 5
    s_cselect_b32 s35, 163520, 0
    s_lshl_b32 s34, s34, 6
    s_add_u32 s34, s34, s35
    s_add_u32 s34, s34, s33
    v_pk_add_f32 v[32:33], v[32:33], v[36:37]
    v_pk_add_f32 v[40:41], v[40:41], v[44:45]
    v_pk_add_f32 v[32:33], v[32:33], v[40:41]
    v_pk_add_f32 v[34:35], v[34:35], v[38:39]
    v_pk_add_f32 v[42:43], v[42:43], v[46:47]
    v_pk_add_f32 v[34:35], v[34:35], v[42:43]
    buffer_store_dwordx4 v[32:35], v6, s[4:7], s34 offen
    s_waitcnt lgkmcnt(0)
    s_cmp_ge_u32 s26, 2
    s_cbranch_scc1 L_wo2_228
    s_add_u32 s34, s26, 8
    s_cmp_ge_u32 s34, 5
    s_cselect_b32 s35, 163520, 0
    s_lshl_b32 s34, s34, 6
    s_add_u32 s34, s34, s35
    s_add_u32 s34, s34, s33
    v_pk_add_f32 v[48:49], v[48:49], v[52:53]
    v_pk_add_f32 v[56:57], v[56:57], v[60:61]
    v_pk_add_f32 v[48:49], v[48:49], v[56:57]
    v_pk_add_f32 v[50:51], v[50:51], v[54:55]
    v_pk_add_f32 v[58:59], v[58:59], v[62:63]
    v_pk_add_f32 v[50:51], v[50:51], v[58:59]
    buffer_store_dwordx4 v[48:51], v6, s[4:7], s34 offen
L_wo2_228:
    s_waitcnt vmcnt(0)
    s_barrier
    s_cmp_lg_u32 s26, 0
    s_cbranch_scc1 L_lnskip_229
    s_mov_b64 exec, 1
    v_mov_b32 v11, s30
    buffer_store_dword v11, off, s[4:7], s36
    s_mov_b64 exec, -1
    s_mul_i32 s33, s53, 40960
    v_lshlrev_b32 v12, 1, v2
    v_add_u32 v13, 81920, v12
    v_add_u32 v14, 94208, v2
    ds_read_b32 v56, v14 offset:0
    ds_read_b32 v57, v14 offset:256
    ds_read_b32 v58, v14 offset:512
    ds_read_b32 v59, v14 offset:768
    ds_read_b32 v60, v14 offset:1024
    s_waitcnt lgkmcnt(0)
    ds_read_b64 v[64:65], v13 offset:0
    ds_read_b64 v[66:67], v13 offset:512
    ds_read_b64 v[68:69], v13 offset:1024
    ds_read_b64 v[70:71], v13 offset:1536
    ds_read_b64 v[72:73], v13 offset:2048
    ds_read_b64 v[74:75], v13 offset:2560
    ds_read_b64 v[76:77], v13 offset:3072
    ds_read_b64 v[78:79], v13 offset:3584
    ds_read_b64 v[80:81], v13 offset:4096
    ds_read_b64 v[82:83], v13 offset:4608
    ds_read_b64 v[84:85], v13 offset:5120
    ds_read_b64 v[86:87], v13 offset:5632
    ds_read_b64 v[88:89], v13 offset:6144
    ds_read_b64 v[90:91], v13 offset:6656
    ds_read_b64 v[92:93], v13 offset:7168
    s_add_u32 s34, s39, 3579904
    s_mov_b32 exec_lo, 4294967295
    s_mov_b32 exec_hi, 0
L_wf_230:
    buffer_load_dword v11, v2, s[4:7], s34 offen sc1
    s_waitcnt vmcnt(0)
    v_cmp_gt_u32 vcc, s30, v11
    s_cbranch_vccz L_wfd_231
    s_sub_u32 s31, s31, 1
    s_cbranch_scc1 L_exit
    s_branch L_wf_230
L_wfd_231:
    s_mov_b64 exec, -1
    s_add_u32 s60, s32, s42
    s_add_u32 s61, s60, 2560
    s_add_u32 s62, s60, 5120
    s_add_u32 s63, s60, 7680
    buffer_load_dwordx2 v[16:17], v12, s[4:7], s60 offen offset:0 sc1
    buffer_load_dwordx2 v[26:27], v12, s[4:7], s61 offen offset:0 sc1
    buffer_load_dwordx2 v[36:37], v12, s[4:7], s62 offen offset:0 sc1
    buffer_load_dwordx2 v[46:47], v12, s[4:7], s63 offen offset:0 sc1
    buffer_load_dwordx2 v[18:19], v12, s[4:7], s60 offen offset:512 sc1
    buffer_load_dwordx2 v[28:29], v12, s[4:7], s61 offen offset:512 sc1
    buffer_load_dwordx2 v[38:39], v12, s[4:7], s62 offen offset:512 sc1
    buffer_load_dwordx2 v[48:49], v12, s[4:7], s63 offen offset:512 sc1
    buffer_load_dwordx2 v[20:21], v12, s[4:7], s60 offen offset:1024 sc1
    buffer_load_dwordx2 v[30:31], v12, s[4:7], s61 offen offset:1024 sc1
    buffer_load_dwordx2 v[40:41], v12, s[4:7], s62 offen offset:1024 sc1
    buffer_load_dwordx2 v[50:51], v12, s[4:7], s63 offen offset:1024 sc1
    buffer_load_dwordx2 v[22:23], v12, s[4:7], s60 offen offset:1536 sc1
    buffer_load_dwordx2 v[32:33], v12, s[4:7], s61 offen offset:1536 sc1
    buffer_load_dwordx2 v[42:43], v12, s[4:7], s62 offen offset:1536 sc1
    buffer_load_dwordx2 v[52:53], v12, s[4:7], s63 offen offset:1536 sc1
    buffer_load_dwordx2 v[24:25], v12, s[4:7], s60 offen offset:2048 sc1
    buffer_load_dwordx2 v[34:35], v12, s[4:7], s61 offen offset:2048 sc1
    buffer_load_dwordx2 v[44:45], v12, s[4:7], s62 offen offset:2048 sc1
    buffer_load_dwordx2 v[54:55], v12, s[4:7], s63 offen offset:2048 sc1
    s_lshl_b32 s34, s33, 1
    s_add_u32 s34, s34, s44
    s_waitcnt lgkmcnt(0)
    s_waitcnt vmcnt(16)
    v_pk_add_f32 v[16:17], v[16:17], v[26:27]
    v_pk_add_f32 v[36:37], v[36:37], v[46:47]
    v_lshlrev_b32 v26, 16, v56
    v_and_b32 v27, 0xffff0000, v56
    v_pk_add_f32 v[16:17], v[16:17], v[36:37]
    v_pk_fma_f32 v[16:17], v[16:17], v[64:65], v[26:27]
    buffer_store_dwordx2 v[16:17], v12, s[4:7], s34 offen offset:0
    s_waitcnt vmcnt(13)
    v_pk_add_f32 v[18:19], v[18:19], v[28:29]
    v_pk_add_f32 v[38:39], v[38:39], v[48:49]
    v_lshlrev_b32 v28, 16, v57
    v_and_b32 v29, 0xffff0000, v57
    v_pk_add_f32 v[18:19], v[18:19], v[38:39]
    v_pk_fma_f32 v[18:19], v[18:19], v[66:67], v[28:29]
    buffer_store_dwordx2 v[18:19], v12, s[4:7], s34 offen offset:512
    s_waitcnt vmcnt(10)
    v_pk_add_f32 v[20:21], v[20:21], v[30:31]
    v_pk_add_f32 v[40:41], v[40:41], v[50:51]
    v_lshlrev_b32 v30, 16, v58
    v_and_b32 v31, 0xffff0000, v58
    v_pk_add_f32 v[20:21], v[20:21], v[40:41]
    v_pk_fma_f32 v[20:21], v[20:21], v[68:69], v[30:31]
    buffer_store_dwordx2 v[20:21], v12, s[4:7], s34 offen offset:1024
    s_waitcnt vmcnt(7)
    v_pk_add_f32 v[22:23], v[22:23], v[32:33]
    v_pk_add_f32 v[42:43], v[42:43], v[52:53]
    v_lshlrev_b32 v32, 16, v59
    v_and_b32 v33, 0xffff0000, v59
    v_pk_add_f32 v[22:23], v[22:23], v[42:43]
    v_pk_fma_f32 v[22:23], v[22:23], v[70:71], v[32:33]
    buffer_store_dwordx2 v[22:23], v12, s[4:7], s34 offen offset:1536
    s_waitcnt vmcnt(4)
    v_pk_add_f32 v[24:25], v[24:25], v[34:35]
    v_pk_add_f32 v[44:45], v[44:45], v[54:55]
    v_lshlrev_b32 v34, 16, v60
    v_and_b32 v35, 0xffff0000, v60
    v_pk_add_f32 v[24:25], v[24:25], v[44:45]
    v_pk_fma_f32 v[24:25], v[24:25], v[72:73], v[34:35]
    buffer_store_dwordx2 v[24:25], v12, s[4:7], s34 offen offset:2048
    v_add_f32 v94, v16, v17
    v_mul_f32 v95, v16, v16
    v_fmac_f32 v95, v17, v17
    v_add_f32 v94, v94, v18
    v_fmac_f32 v95, v18, v18
    v_add_f32 v94, v94, v19
    v_fmac_f32 v95, v19, v19
    v_add_f32 v94, v94, v20
    v_fmac_f32 v95, v20, v20
    v_add_f32 v94, v94, v21
    v_fmac_f32 v95, v21, v21
    v_add_f32 v94, v94, v22
    v_fmac_f32 v95, v22, v22
    v_add_f32 v94, v94, v23
    v_fmac_f32 v95, v23, v23
    v_add_f32 v94, v94, v24
    v_fmac_f32 v95, v24, v24
    v_add_f32 v94, v94, v25
    v_fmac_f32 v95, v25, v25
    s_nop 0
    v_add_f32_dpp v94, v94, v94 quad_perm:[1,0,3,2] row_mask:0xf bank_mask:0xf
    v_add_f32_dpp v95, v95, v95 quad_perm:[1,0,3,2] row_mask:0xf bank_mask:0xf
    s_nop 0
    v_add_f32_dpp v94, v94, v94 quad_perm:[2,3,0,1] row_mask:0xf bank_mask:0xf
    v_add_f32_dpp v95, v95, v95 quad_perm:[2,3,0,1] row_mask:0xf bank_mask:0xf
    s_nop 0
    v_add_f32_dpp v94, v94, v94 row_half_mirror row_mask:0xf bank_mask:0xf
    v_add_f32_dpp v95, v95, v95 row_half_mirror row_mask:0xf bank_mask:0xf
    s_nop 0
    v_add_f32_dpp v94, v94, v94 row_mirror row_mask:0xf bank_mask:0xf
    v_add_f32_dpp v95, v95, v95 row_mirror row_mask:0xf bank_mask:0xf
    v_mov_b32 v96, v94
    v_mov_b32 v97, v95
    s_nop 0
    v_permlane16_swap_b32 v94, v96
    v_permlane16_swap_b32 v95, v97
    v_add_f32 v94, v94, v96
    v_add_f32 v95, v95, v97
    v_mov_b32 v96, v94
    v_mov_b32 v97, v95
    s_nop 0
    v_permlane32_swap_b32 v94, v96
    v_permlane32_swap_b32 v95, v97
    v_add_f32 v94, v94, v96
    v_add_f32 v95, v95, v97
    v_mul_f32 v94, 986500301, v94
    v_mul_f32 v95, 986500301, v95
    v_fma_f32 v95, -v94, v94, v95
    v_max_f32 v95, 0, v95
    v_add_f32 v95, 925353388, v95
    v_rsq_f32 v95, v95
    s_nop 0
    v_mul_f32 v94, v94, v95
    v_fma_f32 v26, v16, v95, -v94
    v_fma_f32 v27, v17, v95, -v94
    v_fma_f32 v28, v18, v95, -v94
    v_fma_f32 v29, v19, v95, -v94
    v_fma_f32 v30, v20, v95, -v94
    v_fma_f32 v31, v21, v95, -v94
    v_fma_f32 v32, v22, v95, -v94
    v_fma_f32 v33, v23, v95, -v94
    v_fma_f32 v34, v24, v95, -v94
    v_fma_f32 v35, v25, v95, -v94
    v_pk_fma_f32 v[26:27], v[26:27], v[84:85], v[74:75]
    v_pk_fma_f32 v[28:29], v[28:29], v[86:87], v[76:77]
    v_pk_fma_f32 v[30:31], v[30:31], v[88:89], v[78:79]
    v_pk_fma_f32 v[32:33], v[32:33], v[90:91], v[80:81]
    v_pk_fma_f32 v[34:35], v[34:35], v[92:93], v[82:83]
    v_add_f32 v94, v26, v27
    v_mul_f32 v95, v26, v26
    v_fmac_f32 v95, v27, v27
    v_add_f32 v94, v94, v28
    v_fmac_f32 v95, v28, v28
    v_add_f32 v94, v94, v29
    v_fmac_f32 v95, v29, v29
    v_add_f32 v94, v94, v30
    v_fmac_f32 v95, v30, v30
    v_add_f32 v94, v94, v31
    v_fmac_f32 v95, v31, v31
    v_add_f32 v94, v94, v32
    v_fmac_f32 v95, v32, v32
    v_add_f32 v94, v94, v33
    v_fmac_f32 v95, v33, v33
    v_add_f32 v94, v94, v34
    v_fmac_f32 v95, v34, v34
    v_add_f32 v94, v94, v35
    v_fmac_f32 v95, v35, v35
    s_nop 0
    v_add_f32_dpp v94, v94, v94 quad_perm:[1,0,3,2] row_mask:0xf bank_mask:0xf
    v_add_f32_dpp v95, v95, v95 quad_perm:[1,0,3,2] row_mask:0xf bank_mask:0xf
    s_nop 0
    v_add_f32_dpp v94, v94, v94 quad_perm:[2,3,0,1] row_mask:0xf bank_mask:0xf
    v_add_f32_dpp v95, v95, v95 quad_perm:[2,3,0,1] row_mask:0xf bank_mask:0xf
    s_nop 0
    v_add_f32_dpp v94, v94, v94 row_half_mirror row_mask:0xf bank_mask:0xf
    v_add_f32_dpp v95, v95, v95 row_half_mirror row_mask:0xf bank_mask:0xf
    s_nop 0
    v_add_f32_dpp v94, v94, v94 row_mirror row_mask:0xf bank_mask:0xf
    v_add_f32_dpp v95, v95, v95 row_mirror row_mask:0xf bank_mask:0xf
    v_mov_b32 v96, v94
    v_mov_b32 v97, v95
    s_nop 0
    v_permlane16_swap_b32 v94, v96
    v_permlane16_swap_b32 v95, v97
    v_add_f32 v94, v94, v96
    v_add_f32 v95, v95, v97
    v_mov_b32 v96, v94
    v_mov_b32 v97, v95
    s_nop 0
    v_permlane32_swap_b32 v94, v96
    v_permlane32_swap_b32 v95, v97
    v_add_f32 v94, v94, v96
    v_add_f32 v95, v95, v97
    v_mul_f32 v94, 986500301, v94
    v_mul_f32 v95, 986500301, v95
    v_fma_f32 v95, -v94, v94, v95
    v_max_f32 v95, 0, v95
    v_add_f32 v95, 925353388, v95
    v_rsq_f32 v95, v95
    s_nop 0
    v_mul_f32 v94, v94, v95
    s_add_u32 s34, s33, s45
    v_fma_f32 v26, v26, v95, -v94
    v_fma_f32 v27, v27, v95, -v94
    v_cvt_pk_bf16_f32 v56, v26, v27
    buffer_store_dword v56, v7, s[4:7], s34 offen
    s_add_u32 s34, s34, 8192
    v_fma_f32 v28, v28, v95, -v94
    v_fma_f32 v29, v29, v95, -v94
    v_cvt_pk_bf16_f32 v57, v28, v29
    buffer_store_dword v57, v7, s[4:7], s34 offen
    s_add_u32 s34, s34, 8192
    v_fma_f32 v30, v30, v95, -v94
    v_fma_f32 v31, v31, v95, -v94
    v_cvt_pk_bf16_f32 v58, v30, v31
    buffer_store_dword v58, v7, s[4:7], s34 offen
    s_add_u32 s34, s34, 8192
    v_fma_f32 v32, v32, v95, -v94
    v_fma_f32 v33, v33, v95, -v94
    v_cvt_pk_bf16_f32 v59, v32, v33
    buffer_store_dword v59, v7, s[4:7], s34 offen
    s_add_u32 s34, s34, 8192
    v_fma_f32 v34, v34, v95, -v94
    v_fma_f32 v35, v35, v95, -v94
    v_cvt_pk_bf16_f32 v60, v34, v35
    buffer_store_dword v60, v7, s[4:7], s34 offen
    s_waitcnt vmcnt(0)
    s_mov_b64 exec, 1
    v_mov_b32 v11, s30
    buffer_store_dword v11, off, s[4:7], s37
    s_mov_b64 exec, -1
    s_add_u32 s34, s39, 3580928
    s_mov_b32 exec_lo, 4294967295
    s_mov_b32 exec_hi, 0
L_wf_232:
    buffer_load_dword v11, v2, s[4:7], s34 offen sc1
    s_waitcnt vmcnt(0)
    v_cmp_gt_u32 vcc, s30, v11
    s_cbranch_vccz L_wfd_233
    s_sub_u32 s31, s31, 1
    s_cbranch_scc1 L_exit
    s_branch L_wf_232
L_wfd_233:
    s_mov_b64 exec, -1
L_lnskip_229:
    s_barrier
    s_mul_i32 s33, s53, 40960
    s_cmp_ge_u32 s25, 27
    s_cbranch_scc1 L_m1skip_234
    s_add_u32 s34, s33, s46
    s_add_u32 m0, s46, 40960
    s_add_u32 s60, s34, 7340032
    buffer_load_dwordx4 v1, s[4:7], s60 offen offset:0 sc1 lds
    buffer_load_dwordx4 v1, s[4:7], s60 offen offset:1024 sc1 lds
    s_add_u32 m0, s46, 49152
    s_add_u32 s60, s34, 7348224
    buffer_load_dwordx4 v1, s[4:7], s60 offen offset:0 sc1 lds
    buffer_load_dwordx4 v1, s[4:7], s60 offen offset:1024 sc1 lds
    s_add_u32 m0, s46, 57344
    s_add_u32 s60, s34, 7356416
    buffer_load_dwordx4 v1, s[4:7], s60 offen offset:0 sc1 lds
    buffer_load_dwordx4 v1, s[4:7], s60 offen offset:1024 sc1 lds
    s_add_u32 m0, s46, 65536
    s_add_u32 s60, s34, 7364608
    buffer_load_dwordx4 v1, s[4:7], s60 offen offset:0 sc1 lds
    buffer_load_dwordx4 v1, s[4:7], s60 offen offset:1024 sc1 lds
    s_add_u32 m0, s46, 73728
    s_add_u32 s60, s34, 7372800
    buffer_load_dwordx4 v1, s[4:7], s60 offen offset:0 sc1 lds
    buffer_load_dwordx4 v1, s[4:7], s60 offen offset:1024 sc1 lds
    v_lshrrev_b32 v12, 8, v1
    v_lshlrev_b32 v12, 4, v12
    s_lshl_b32 s35, s26, 6
    s_add_u32 s35, s35, 92160
    v_add_u32 v12, s35, v12
    ds_read_b128 v[72:75], v12
    v_xor_b32 v13, 64, v0
    v_xor_b32 v14, 0x80, v0
    v_xor_b32 v15, 0xc0, v0
    s_mul_i32 s34, s53, 110592
    s_add_u32 s60, s34, s47
    s_waitcnt vmcnt(6) lgkmcnt(0)
    s_barrier
    ds_read_b128 v[16:19], v0 offset:0
    ds_read_b128 v[20:23], v0 offset:4096
    ds_read_b128 v[24:27], v13 offset:0
    ds_read_b128 v[28:31], v13 offset:4096
    ds_read_b128 v[32:35], v14 offset:0
    ds_read_b128 v[36:39], v14 offset:4096
    ds_read_b128 v[40:43], v15 offset:0
    ds_read_b128 v[44:47], v15 offset:4096
    ds_read_b128 v[48:51], v0 offset:8192
    s_waitcnt lgkmcnt(8)
    v_mfma_f32_16x16x32_bf16 v[64:67], a[160:163], v[16:19], v[72:75]
    ds_read_b128 v[52:55], v0 offset:12288
    s_waitcnt lgkmcnt(8)
    v_mfma_f32_16x16x32_bf16 v[68:71], a[160:163], v[20:23], v[72:75]
    ds_read_b128 v[16:19], v13 offset:8192
    s_waitcnt lgkmcnt(8)
    v_mfma_f32_16x16x32_bf16 v[64:67], a[164:167], v[24:27], v[64:67]
    ds_read_b128 v[20:23], v13 offset:12288
    s_waitcnt lgkmcnt(8)
    v_mfma_f32_16x16x32_bf16 v[68:71], a[164:167], v[28:31], v[68:71]
    ds_read_b128 v[24:27], v14 offset:8192
    s_waitcnt lgkmcnt(8)
    v_mfma_f32_16x16x32_bf16 v[64:67], a[168:171], v[32:35], v[64:67]
    ds_read_b128 v[28:31], v14 offset:12288
    s_waitcnt lgkmcnt(8)
    v_mfma_f32_16x16x32_bf16 v[68:71], a[168:171], v[36:39], v[68:71]
    ds_read_b128 v[32:35], v15 offset:8192
    s_waitcnt lgkmcnt(8)
    v_mfma_f32_16x16x32_bf16 v[64:67], a[172:175], v[40:43], v[64:67]
    ds_read_b128 v[36:39], v15 offset:12288
    s_waitcnt lgkmcnt(8)
    v_mfma_f32_16x16x32_bf16 v[68:71], a[172:175], v[44:47], v[68:71]
    s_waitcnt vmcnt(2)
    s_barrier
    ds_read_b128 v[40:43], v0 offset:16384
    s_waitcnt lgkmcnt(8)
    v_mfma_f32_16x16x32_bf16 v[64:67], a[176:179], v[48:51], v[64:67]
    ds_read_b128 v[44:47], v0 offset:20480
    s_waitcnt lgkmcnt(8)
    v_mfma_f32_16x16x32_bf16 v[68:71], a[176:179], v[52:55], v[68:71]
    ds_read_b128 v[48:51], v13 offset:16384
    s_waitcnt lgkmcnt(8)
    v_mfma_f32_16x16x32_bf16 v[64:67], a[180:183], v[16:19], v[64:67]
    ds_read_b128 v[52:55], v13 offset:20480
    s_waitcnt lgkmcnt(8)
    v_mfma_f32_16x16x32_bf16 v[68:71], a[180:183], v[20:23], v[68:71]
    ds_read_b128 v[16:19], v14 offset:16384
    s_waitcnt lgkmcnt(8)
    v_mfma_f32_16x16x32_bf16 v[64:67], a[184:187], v[24:27], v[64:67]
    ds_read_b128 v[20:23], v14 offset:20480
    s_waitcnt lgkmcnt(8)
    v_mfma_f32_16x16x32_bf16 v[68:71], a[184:187], v[28:31], v[68:71]
    ds_read_b128 v[24:27], v15 offset:16384
    s_waitcnt lgkmcnt(8)
    v_mfma_f32_16x16x32_bf16 v[64:67], a[188:191], v[32:35], v[64:67]
    ds_read_b128 v[28:31], v15 offset:20480
    s_waitcnt lgkmcnt(8)
    v_mfma_f32_16x16x32_bf16 v[68:71], a[188:191], v[36:39], v[68:71]
    ds_read_b128 v[32:35], v0 offset:24576
    s_waitcnt lgkmcnt(8)
    v_mfma_f32_16x16x32_bf16 v[64:67], a[192:195], v[40:43], v[64:67]
    ds_read_b128 v[36:39], v0 offset:28672
    s_waitcnt lgkmcnt(8)
    v_mfma_f32_16x16x32_bf16 v[68:71], a[192:195], v[44:47], v[68:71]
    ds_read_b128 v[40:43], v13 offset:24576
    s_waitcnt lgkmcnt(8)
    v_mfma_f32_16x16x32_bf16 v[64:67], a[196:199], v[48:51], v[64:67]
    ds_read_b128 v[44:47], v13 offset:28672
    s_waitcnt lgkmcnt(8)
    v_mfma_f32_16x16x32_bf16 v[68:71], a[196:199], v[52:55], v[68:71]
    ds_read_b128 v[48:51], v14 offset:24576
    s_waitcnt lgkmcnt(8)
    v_mfma_f32_16x16x32_bf16 v[64:67], a[200:203], v[16:19], v[64:67]
    ds_read_b128 v[52:55], v14 offset:28672
    s_waitcnt lgkmcnt(8)
    v_mfma_f32_16x16x32_bf16 v[68:71], a[200:203], v[20:23], v[68:71]
    ds_read_b128 v[16:19], v15 offset:24576
    s_waitcnt lgkmcnt(8)
    v_mfma_f32_16x16x32_bf16 v[64:67], a[204:207], v[24:27], v[64:67]
    ds_read_b128 v[20:23], v15 offset:28672
    s_waitcnt lgkmcnt(8)
    v_mfma_f32_16x16x32_bf16 v[68:71], a[204:207], v[28:31], v[68:71]
    s_waitcnt vmcnt(0)
    s_barrier
    ds_read_b128 v[24:27], v0 offset:32768
    s_waitcnt lgkmcnt(8)
    v_mfma_f32_16x16x32_bf16 v[64:67], a[208:211], v[32:35], v[64:67]
    ds_read_b128 v[28:31], v0 offset:36864
    s_waitcnt lgkmcnt(8)
    v_mfma_f32_16x16x32_bf16 v[68:71], a[208:211], v[36:39], v[68:71]
    ds_read_b128 v[32:35], v13 offset:32768
    s_waitcnt lgkmcnt(8)
    v_mfma_f32_16x16x32_bf16 v[64:67], a[212:215], v[40:43], v[64:67]
    ds_read_b128 v[36:39], v13 offset:36864
    s_waitcnt lgkmcnt(8)
    v_mfma_f32_16x16x32_bf16 v[68:71], a[212:215], v[44:47], v[68:71]
    ds_read_b128 v[40:43], v14 offset:32768
    s_waitcnt lgkmcnt(8)
    v_mfma_f32_16x16x32_bf16 v[64:67], a[216:219], v[48:51], v[64:67]
    ds_read_b128 v[44:47], v14 offset:36864
    s_waitcnt lgkmcnt(8)
    v_mfma_f32_16x16x32_bf16 v[68:71], a[216:219], v[52:55], v[68:71]
    ds_read_b128 v[48:51], v15 offset:32768
    s_waitcnt lgkmcnt(8)
    v_mfma_f32_16x16x32_bf16 v[64:67], a[220:223], v[16:19], v[64:67]
    ds_read_b128 v[52:55], v15 offset:36864
    s_waitcnt lgkmcnt(8)
    v_mfma_f32_16x16x32_bf16 v[68:71], a[220:223], v[20:23], v[68:71]
    s_waitcnt lgkmcnt(7)
    v_mfma_f32_16x16x32_bf16 v[64:67], a[224:227], v[24:27], v[64:67]
    s_waitcnt lgkmcnt(6)
    v_mfma_f32_16x16x32_bf16 v[68:71], a[224:227], v[28:31], v[68:71]
    s_waitcnt lgkmcnt(5)
    v_mfma_f32_16x16x32_bf16 v[64:67], a[228:231], v[32:35], v[64:67]
    s_waitcnt lgkmcnt(4)
    v_mfma_f32_16x16x32_bf16 v[68:71], a[228:231], v[36:39], v[68:71]
    s_waitcnt lgkmcnt(3)
    v_mfma_f32_16x16x32_bf16 v[64:67], a[232:235], v[40:43], v[64:67]
    s_waitcnt lgkmcnt(2)
    v_mfma_f32_16x16x32_bf16 v[68:71], a[232:235], v[44:47], v[68:71]
    s_waitcnt lgkmcnt(1)
    v_mfma_f32_16x16x32_bf16 v[64:67], a[236:239], v[48:51], v[64:67]
    s_waitcnt lgkmcnt(0)
    v_mfma_f32_16x16x32_bf16 v[68:71], a[236:239], v[52:55], v[68:71]
    s_mov_b32 s62, 3184710632
    v_mov_b32 v12, 3222493025
    s_nop 3
    v_mul_f32 v76, v64, v64
    v_mul_f32 v77, v65, v65
    v_mul_f32 v78, v66, v66
    v_mul_f32 v79, v67, v67
    v_mul_f32 v80, v68, v68
    v_mul_f32 v81, v69, v69
    v_mul_f32 v82, v70, v70
    v_mul_f32 v83, v71, v71
    v_fma_f32 v76, v76, s62, v12
    v_fma_f32 v77, v77, s62, v12
    v_fma_f32 v78, v78, s62, v12
    v_fma_f32 v79, v79, s62, v12
    v_fma_f32 v80, v80, s62, v12
    v_fma_f32 v81, v81, s62, v12
    v_fma_f32 v82, v82, s62, v12
    v_fma_f32 v83, v83, s62, v12
    v_mul_f32 v76, v76, v64
    v_mul_f32 v77, v77, v65
    v_mul_f32 v78, v78, v66
    v_mul_f32 v79, v79, v67
    v_mul_f32 v80, v80, v68
    v_mul_f32 v81, v81, v69
    v_mul_f32 v82, v82, v70
    v_mul_f32 v83, v83, v71
    v_exp_f32 v76, v76
    v_exp_f32 v77, v77
    v_exp_f32 v78, v78
    v_exp_f32 v79, v79
    v_exp_f32 v80, v80
    v_exp_f32 v81, v81
    v_exp_f32 v82, v82
    v_exp_f32 v83, v83
    v_add_f32 v76, 1.0, v76
    v_add_f32 v77, 1.0, v77
    v_add_f32 v78, 1.0, v78
    v_add_f32 v79, 1.0, v79
    v_add_f32 v80, 1.0, v80
    v_add_f32 v81, 1.0, v81
    v_add_f32 v82, 1.0, v82
    v_add_f32 v83, 1.0, v83
    v_rcp_f32 v76, v76
    v_rcp_f32 v77, v77
    v_rcp_f32 v78, v78
    v_rcp_f32 v79, v79
    v_rcp_f32 v80, v80
    v_rcp_f32 v81, v81
    v_rcp_f32 v82, v82
    v_rcp_f32 v83, v83
    v_mul_f32 v76, v76, v64
    v_mul_f32 v77, v77, v65
    v_mul_f32 v78, v78, v66
    v_mul_f32 v79, v79, v67
    v_mul_f32 v80, v80, v68
    v_mul_f32 v81, v81, v69
    v_mul_f32 v82, v82, v70
    v_mul_f32 v83, v83, v71
    v_cvt_pk_bf16_f32 v64, v76, v77
    v_cvt_pk_bf16_f32 v65, v78, v79
    v_cvt_pk_bf16_f32 v66, v80, v81
    v_cvt_pk_bf16_f32 v67, v82, v83
    s_nop 0
    v_permlane16_swap_b32 v64, v66
    v_permlane16_swap_b32 v65, v67
    buffer_store_dwordx4 v[64:67], v8, s[4:7], s60 offen
    s_waitcnt vmcnt(0)
    s_barrier
    s_cmp_lg_u32 s26, 0
    s_cbranch_scc1 L_m1skip_234
    s_mov_b64 exec, 1
    v_mov_b32 v11, s30
    buffer_store_dword v11, off, s[4:7], s38
    s_mov_b64 exec, -1
L_m1skip_234:
    s_lshl_b32 s34, s33, 1
    s_add_u32 s34, s34, s50
    buffer_load_dwordx4 v[84:87], v10, s[4:7], s34 offen sc1
    v_and_b32 v12, 48, v1
    s_lshl_b32 s35, s26, 6
    v_add_u32 v12, s35, v12
    s_mul_i32 s35, s56, 160
    v_add_u32 v13, s35, v12
    v_add_u32 v12, 81920, v12
    v_add_u32 v13, 81920, v13
    ds_read_b128 v[88:91], v12 offset:10496
    ds_read_b128 v[92:95], v13 offset:7680
    s_add_u32 s34, s39, 3581952
    s_mov_b32 exec_lo, 134217727
    s_mov_b32 exec_hi, 0
L_wf_236:
    buffer_load_dword v11, v2, s[4:7], s34 offen sc1
    s_waitcnt vmcnt(0)
    v_cmp_gt_u32 vcc, s30, v11
    s_cbranch_vccz L_wfd_237
    s_sub_u32 s31, s31, 1
    s_cbranch_scc1 L_exit
    s_branch L_wf_236
L_wfd_237:
    s_mov_b64 exec, -1
    s_mul_i32 s34, s53, 110592
    s_add_u32 s60, s34, s48
    s_add_u32 s61, s60, 4096
    s_add_u32 s62, s60, 8192
    s_add_u32 s63, s60, s49
    buffer_load_dwordx4 v[16:19], v1, s[4:7], s60 offen offset:0 sc1
    buffer_load_dwordx4 v[20:23], v1, s[4:7], s60 offen offset:1024 sc1
    buffer_load_dwordx4 v[24:27], v1, s[4:7], s60 offen offset:2048 sc1
    buffer_load_dwordx4 v[28:31], v1, s[4:7], s60 offen offset:3072 sc1
    buffer_load_dwordx4 v[32:35], v1, s[4:7], s61 offen offset:0 sc1
    buffer_load_dwordx4 v[36:39], v1, s[4:7], s61 offen offset:1024 sc1
    buffer_load_dwordx4 v[40:43], v1, s[4:7], s61 offen offset:2048 sc1
    buffer_load_dwordx4 v[44:47], v1, s[4:7], s61 offen offset:3072 sc1
    buffer_load_dwordx4 v[48:51], v1, s[4:7], s62 offen offset:0 sc1
    buffer_load_dwordx4 v[52:55], v1, s[4:7], s62 offen offset:1024 sc1
    buffer_load_dwordx4 v[56:59], v1, s[4:7], s62 offen offset:2048 sc1
    buffer_load_dwordx4 v[60:63], v1, s[4:7], s62 offen offset:3072 sc1
    buffer_load_dwordx4 v[64:67], v1, s[4:7], s63 offen offset:0 sc1
    buffer_load_dwordx4 v[68:71], v1, s[4:7], s63 offen offset:1024 sc1
    s_mov_b64 exec, 3
    buffer_load_dword v11, v3, s[4:7], s2 offen sc1
    s_mov_b64 exec, -1
    s_waitcnt vmcnt(14)
    v_mfma_f32_16x16x32_bf16 v[72:75], a[240:243], v[16:19], 0
    v_mfma_f32_16x16x32_bf16 v[76:79], a[244:247], v[16:19], 0
    v_mfma_f32_16x16x32_bf16 v[80:83], a[248:251], v[16:19], 0
    s_waitcnt vmcnt(13)
    v_mfma_f32_16x16x32_bf16 v[72:75], a[252:255], v[20:23], v[72:75]
    v_mfma_f32_16x16x32_bf16 v[76:79], v[104:107], v[20:23], v[76:79]
    v_mfma_f32_16x16x32_bf16 v[80:83], v[108:111], v[20:23], v[80:83]
    s_waitcnt vmcnt(12)
    v_mfma_f32_16x16x32_bf16 v[72:75], v[112:115], v[24:27], v[72:75]
    v_mfma_f32_16x16x32_bf16 v[76:79], v[116:119], v[24:27], v[76:79]
    v_mfma_f32_16x16x32_bf16 v[80:83], v[120:123], v[24:27], v[80:83]
    s_waitcnt vmcnt(11)
    v_mfma_f32_16x16x32_bf16 v[72:75], v[124:127], v[28:31], v[72:75]
    v_mfma_f32_16x16x32_bf16 v[76:79], v[128:131], v[28:31], v[76:79]
    v_mfma_f32_16x16x32_bf16 v[80:83], v[132:135], v[28:31], v[80:83]
    s_waitcnt vmcnt(10)
    v_mfma_f32_16x16x32_bf16 v[72:75], v[136:139], v[32:35], v[72:75]
    v_mfma_f32_16x16x32_bf16 v[76:79], v[140:143], v[32:35], v[76:79]
    v_mfma_f32_16x16x32_bf16 v[80:83], v[144:147], v[32:35], v[80:83]
    s_waitcnt vmcnt(9)
    v_mfma_f32_16x16x32_bf16 v[72:75], v[148:151], v[36:39], v[72:75]
    v_mfma_f32_16x16x32_bf16 v[76:79], v[152:155], v[36:39], v[76:79]
    v_mfma_f32_16x16x32_bf16 v[80:83], v[156:159], v[36:39], v[80:83]
    s_waitcnt vmcnt(8)
    v_mfma_f32_16x16x32_bf16 v[72:75], v[160:163], v[40:43], v[72:75]
    v_mfma_f32_16x16x32_bf16 v[76:79], v[164:167], v[40:43], v[76:79]
    v_mfma_f32_16x16x32_bf16 v[80:83], v[168:171], v[40:43], v[80:83]
    s_waitcnt vmcnt(7)
    v_mfma_f32_16x16x32_bf16 v[72:75], v[172:175], v[44:47], v[72:75]
    v_mfma_f32_16x16x32_bf16 v[76:79], v[176:179], v[44:47], v[76:79]
    v_mfma_f32_16x16x32_bf16 v[80:83], v[180:183], v[44:47], v[80:83]
    s_waitcnt vmcnt(6)
    v_mfma_f32_16x16x32_bf16 v[72:75], v[184:187], v[48:51], v[72:75]
    v_mfma_f32_16x16x32_bf16 v[76:79], v[188:191], v[48:51], v[76:79]
    v_mfma_f32_16x16x32_bf16 v[80:83], v[192:195], v[48:51], v[80:83]
    s_waitcnt vmcnt(5)
    v_mfma_f32_16x16x32_bf16 v[72:75], v[196:199], v[52:55], v[72:75]
    v_mfma_f32_16x16x32_bf16 v[76:79], v[200:203], v[52:55], v[76:79]
    v_mfma_f32_16x16x32_bf16 v[80:83], v[204:207], v[52:55], v[80:83]
    s_waitcnt vmcnt(4)
    v_mfma_f32_16x16x32_bf16 v[72:75], v[208:211], v[56:59], v[72:75]
    v_mfma_f32_16x16x32_bf16 v[76:79], v[212:215], v[56:59], v[76:79]
    v_mfma_f32_16x16x32_bf16 v[80:83], v[216:219], v[56:59], v[80:83]
    s_waitcnt vmcnt(3)
    v_mfma_f32_16x16x32_bf16 v[72:75], v[220:223], v[60:63], v[72:75]
    v_mfma_f32_16x16x32_bf16 v[76:79], v[224:227], v[60:63], v[76:79]
    v_mfma_f32_16x16x32_bf16 v[80:83], v[228:231], v[60:63], v[80:83]
    s_waitcnt vmcnt(2)
    v_mfma_f32_16x16x32_bf16 v[72:75], v[232:235], v[64:67], v[72:75]
    v_mfma_f32_16x16x32_bf16 v[76:79], v[236:239], v[64:67], v[76:79]
    v_mfma_f32_16x16x32_bf16 v[80:83], v[240:243], v[64:67], v[80:83]
    s_waitcnt vmcnt(1)
    v_mfma_f32_16x16x32_bf16 v[72:75], v[244:247], v[68:71], v[72:75]
    v_mfma_f32_16x16x32_bf16 v[76:79], v[248:251], v[68:71], v[76:79]
    v_mfma_f32_16x16x32_bf16 v[80:83], v[252:255], v[68:71], v[80:83]
    s_mul_i32 s33, s29, 40960
    s_add_u32 s34, s33, s51
    s_bitset0_b64 s[14:15], s29
    s_ff1_i32_b64 s12, s[14:15]
    s_mov_b32 s28, 0
    s_nop 0
    ds_write_b128 v4, v[72:75] offset:0
    ds_write_b128 v4, v[76:79] offset:1024
    ds_write_b128 v4, v[80:83] offset:2048
    s_mov_b64 exec, 3
    s_waitcnt vmcnt(0)
    v_cmp_ge_u32 vcc, s12, v11
    s_mov_b64 exec, -1
    s_cbranch_vccnz L_nopre_239
    s_lshl_b32 s32, s12, 18
    s_add_u32 s8, s32, s40
    s_add_u32 s9, s8, 4096
    s_add_u32 s10, s8, 131072
    s_add_u32 s11, s9, 131072
    s_mul_i32 s32, s12, 40960
    s_add_u32 s32, s32, s43
    s_lshl_b32 s35, s26, 10
    s_add_u32 s32, s32, s35
    s_add_u32 m0, s35, 94208
    s_nop 0
    buffer_load_dwordx4 v1, s[16:19], s32 offen lds
    buffer_load_dwordx4 v[16:19], v1, s[4:7], s8 offen offset:0 sc1
    buffer_load_dwordx4 v[20:23], v1, s[4:7], s8 offen offset:1024 sc1
    buffer_load_dwordx4 v[24:27], v1, s[4:7], s8 offen offset:2048 sc1
    buffer_load_dwordx4 v[28:31], v1, s[4:7], s8 offen offset:3072 sc1
    buffer_load_dwordx4 v[32:35], v1, s[4:7], s9 offen offset:0 sc1
    buffer_load_dwordx4 v[36:39], v1, s[4:7], s9 offen offset:1024 sc1
    buffer_load_dwordx4 v[40:43], v1, s[4:7], s9 offen offset:2048 sc1
    buffer_load_dwordx4 v[44:47], v1, s[4:7], s9 offen offset:3072 sc1
    buffer_load_dwordx4 v[48:51], v1, s[4:7], s10 offen offset:0 sc1
    buffer_load_dwordx4 v[52:55], v1, s[4:7], s10 offen offset:1024 sc1
    buffer_load_dwordx4 v[56:59], v1, s[4:7], s10 offen offset:2048 sc1
    buffer_load_dwordx4 v[60:63], v1, s[4:7], s10 offen offset:3072 sc1
    s_mov_b32 s28, 1
L_nopre_239:
    s_waitcnt lgkmcnt(0)
    s_barrier
    s_cmp_eq_u32 s26, 3
    s_cbranch_scc1 L_m2e_238
    ds_read_b128 v[64:67], v5 offset:0
    ds_read_b128 v[68:71], v5 offset:10240
    ds_read_b128 v[72:75], v5 offset:20480
    ds_read_b128 v[76:79], v5 offset:30720
    s_waitcnt lgkmcnt(0)
    v_pk_add_f32 v[64:65], v[64:65], v[68:69]
    v_pk_add_f32 v[72:73], v[72:73], v[76:77]
    v_pk_add_f32 v[64:65], v[64:65], v[88:89]
    v_pk_add_f32 v[64:65], v[64:65], v[72:73]
    v_pk_fma_f32 v[64:65], v[64:65], v[92:93], v[84:85]
    v_pk_add_f32 v[66:67], v[66:67], v[70:71]
    v_pk_add_f32 v[74:75], v[74:75], v[78:79]
    v_pk_add_f32 v[66:67], v[66:67], v[90:91]
    v_pk_add_f32 v[66:67], v[66:67], v[74:75]
    v_pk_fma_f32 v[66:67], v[66:67], v[94:95], v[86:87]
    v_cvt_pk_bf16_f32 v12, v64, v65
    v_cvt_pk_bf16_f32 v13, v66, v67
    s_mov_b64 exec, s[58:59]
    buffer_store_dwordx2 v[12:13], v9, s[20:23], s34 offen
    s_mov_b64 exec, -1
L_m2e_238:
    s_barrier
    s_mov_b32 s29, s12
    s_cmp_lt_u32 s29, 64
    s_cbranch_scc1 L_team_224
    s_branch L_exit
L_tslow_223:
L_team_240:
    s_add_u32 s30, s29, 1
    s_mov_b32 s53, s27
    s_cmp_lg_u32 s28, 0
    s_cbranch_scc1 L_wog_241
    s_mov_b64 exec, 3
L_wf_242:
    buffer_load_dword v11, v3, s[4:7], s2 offen sc1
    s_waitcnt vmcnt(0)
    v_cmp_gt_u32 vcc, s30, v11
    s_cbranch_vccz L_wfd_243
    s_sub_u32 s31, s31, 1
    s_cbranch_scc1 L_exit
    s_branch L_wf_242
L_wfd_243:
    s_mov_b64 exec, -1
    s_lshl_b32 s32, s29, 18
    s_add_u32 s8, s32, s40
    s_add_u32 s9, s8, 4096
    s_add_u32 s10, s8, 131072
    s_add_u32 s11, s9, 131072
    s_mul_i32 s32, s29, 40960
    s_add_u32 s32, s32, s43
    s_lshl_b32 s35, s26, 10
    s_add_u32 s32, s32, s35
    s_add_u32 m0, s35, 94208
    s_nop 0
    buffer_load_dwordx4 v1, s[16:19], s32 offen lds
    buffer_load_dwordx4 v[16:19], v1, s[4:7], s8 offen offset:0 sc1
    buffer_load_dwordx4 v[20:23], v1, s[4:7], s8 offen offset:1024 sc1
    buffer_load_dwordx4 v[24:27], v1, s[4:7], s8 offen offset:2048 sc1
    buffer_load_dwordx4 v[28:31], v1, s[4:7], s8 offen offset:3072 sc1
    buffer_load_dwordx4 v[32:35], v1, s[4:7], s9 offen offset:0 sc1
    buffer_load_dwordx4 v[36:39], v1, s[4:7], s9 offen offset:1024 sc1
    buffer_load_dwordx4 v[40:43], v1, s[4:7], s9 offen offset:2048 sc1
    buffer_load_dwordx4 v[44:47], v1, s[4:7], s9 offen offset:3072 sc1
    buffer_load_dwordx4 v[48:51], v1, s[4:7], s10 offen offset:0 sc1
    buffer_load_dwordx4 v[52:55], v1, s[4:7], s10 offen offset:1024 sc1
    buffer_load_dwordx4 v[56:59], v1, s[4:7], s10 offen offset:2048 sc1
    buffer_load_dwordx4 v[60:63], v1, s[4:7], s10 offen offset:3072 sc1
L_wog_241:
    s_waitcnt vmcnt(11)
    v_mfma_f32_16x16x32_bf16 v[64:67], a[0:3], v[16:19], 0
    v_mfma_f32_16x16x32_bf16 v[68:71], a[4:7], v[16:19], 0
    v_mfma_f32_16x16x32_bf16 v[72:75], a[8:11], v[16:19], 0
    v_mfma_f32_16x16x32_bf16 v[76:79], a[12:15], v[16:19], 0
    v_mfma_f32_16x16x32_bf16 v[80:83], a[16:19], v[16:19], 0
    buffer_load_dwordx4 v[16:19], v1, s[4:7], s11 offen offset:0 sc1
    s_waitcnt vmcnt(11)
    v_mfma_f32_16x16x32_bf16 v[64:67], a[20:23], v[20:23], v[64:67]
    v_mfma_f32_16x16x32_bf16 v[68:71], a[24:27], v[20:23], v[68:71]
    v_mfma_f32_16x16x32_bf16 v[72:75], a[28:31], v[20:23], v[72:75]
    v_mfma_f32_16x16x32_bf16 v[76:79], a[32:35], v[20:23], v[76:79]
    v_mfma_f32_16x16x32_bf16 v[80:83], a[36:39], v[20:23], v[80:83]
    buffer_load_dwordx4 v[20:23], v1, s[4:7], s11 offen offset:1024 sc1
    s_waitcnt vmcnt(11)
    v_mfma_f32_16x16x32_bf16 v[64:67], a[40:43], v[24:27], v[64:67]
    v_mfma_f32_16x16x32_bf16 v[68:71], a[44:47], v[24:27], v[68:71]
    v_mfma_f32_16x16x32_bf16 v[72:75], a[48:51], v[24:27], v[72:75]
    v_mfma_f32_16x16x32_bf16 v[76:79], a[52:55], v[24:27], v[76:79]
    v_mfma_f32_16x16x32_bf16 v[80:83], a[56:59], v[24:27], v[80:83]
    buffer_load_dwordx4 v[24:27], v1, s[4:7], s11 offen offset:2048 sc1
    s_waitcnt vmcnt(11)
    v_mfma_f32_16x16x32_bf16 v[64:67], a[60:63], v[28:31], v[64:67]
    v_mfma_f32_16x16x32_bf16 v[68:71], a[64:67], v[28:31], v[68:71]
    v_mfma_f32_16x16x32_bf16 v[72:75], a[68:71], v[28:31], v[72:75]
    v_mfma_f32_16x16x32_bf16 v[76:79], a[72:75], v[28:31], v[76:79]
    v_mfma_f32_16x16x32_bf16 v[80:83], a[76:79], v[28:31], v[80:83]
    buffer_load_dwordx4 v[28:31], v1, s[4:7], s11 offen offset:3072 sc1
    s_waitcnt vmcnt(11)
    v_mfma_f32_16x16x32_bf16 v[64:67], a[80:83], v[32:35], v[64:67]
    v_mfma_f32_16x16x32_bf16 v[68:71], a[84:87], v[32:35], v[68:71]
    v_mfma_f32_16x16x32_bf16 v[72:75], a[88:91], v[32:35], v[72:75]
    v_mfma_f32_16x16x32_bf16 v[76:79], a[92:95], v[32:35], v[76:79]
    v_mfma_f32_16x16x32_bf16 v[80:83], a[96:99], v[32:35], v[80:83]
    s_waitcnt vmcnt(10)
    v_mfma_f32_16x16x32_bf16 v[64:67], a[100:103], v[36:39], v[64:67]
    v_mfma_f32_16x16x32_bf16 v[68:71], a[104:107], v[36:39], v[68:71]
    v_mfma_f32_16x16x32_bf16 v[72:75], a[108:111], v[36:39], v[72:75]
    v_mfma_f32_16x16x32_bf16 v[76:79], a[112:115], v[36:39], v[76:79]
    v_mfma_f32_16x16x32_bf16 v[80:83], a[116:119], v[36:39], v[80:83]
    s_waitcnt vmcnt(9)
    v_mfma_f32_16x16x32_bf16 v[64:67], a[120:123], v[40:43], v[64:67]
    v_mfma_f32_16x16x32_bf16 v[68:71], a[124:127], v[40:43], v[68:71]
    v_mfma_f32_16x16x32_bf16 v[72:75], a[128:131], v[40:43], v[72:75]
    v_mfma_f32_16x16x32_bf16 v[76:79], a[132:135], v[40:43], v[76:79]
    v_mfma_f32_16x16x32_bf16 v[80:83], a[136:139], v[40:43], v[80:83]
    s_waitcnt vmcnt(8)
    v_mfma_f32_16x16x32_bf16 v[64:67], a[140:143], v[44:47], v[64:67]
    v_mfma_f32_16x16x32_bf16 v[68:71], a[144:147], v[44:47], v[68:71]
    v_mfma_f32_16x16x32_bf16 v[72:75], a[148:151], v[44:47], v[72:75]
    v_mfma_f32_16x16x32_bf16 v[76:79], a[152:155], v[44:47], v[76:79]
    v_mfma_f32_16x16x32_bf16 v[80:83], a[156:159], v[44:47], v[80:83]
    s_waitcnt vmcnt(7)
    v_mfma_f32_16x16x32_bf16 v[84:87], a[0:3], v[48:51], 0
    v_mfma_f32_16x16x32_bf16 v[88:91], a[4:7], v[48:51], 0
    v_mfma_f32_16x16x32_bf16 v[92:95], a[8:11], v[48:51], 0
    v_mfma_f32_16x16x32_bf16 v[96:99], a[12:15], v[48:51], 0
    v_mfma_f32_16x16x32_bf16 v[100:103], a[16:19], v[48:51], 0
    s_waitcnt vmcnt(6)
    v_mfma_f32_16x16x32_bf16 v[84:87], a[20:23], v[52:55], v[84:87]
    v_mfma_f32_16x16x32_bf16 v[88:91], a[24:27], v[52:55], v[88:91]
    v_mfma_f32_16x16x32_bf16 v[92:95], a[28:31], v[52:55], v[92:95]
    v_mfma_f32_16x16x32_bf16 v[96:99], a[32:35], v[52:55], v[96:99]
    v_mfma_f32_16x16x32_bf16 v[100:103], a[36:39], v[52:55], v[100:103]
    ds_write_b128 v4, v[64:67] offset:0
    s_waitcnt vmcnt(5)
    v_mfma_f32_16x16x32_bf16 v[84:87], a[40:43], v[56:59], v[84:87]
    v_mfma_f32_16x16x32_bf16 v[88:91], a[44:47], v[56:59], v[88:91]
    v_mfma_f32_16x16x32_bf16 v[92:95], a[48:51], v[56:59], v[92:95]
    v_mfma_f32_16x16x32_bf16 v[96:99], a[52:55], v[56:59], v[96:99]
    v_mfma_f32_16x16x32_bf16 v[100:103], a[56:59], v[56:59], v[100:103]
    ds_write_b128 v4, v[68:71] offset:1024
    s_waitcnt vmcnt(4)
    v_mfma_f32_16x16x32_bf16 v[84:87], a[60:63], v[60:63], v[84:87]
    v_mfma_f32_16x16x32_bf16 v[88:91], a[64:67], v[60:63], v[88:91]
    v_mfma_f32_16x16x32_bf16 v[92:95], a[68:71], v[60:63], v[92:95]
    v_mfma_f32_16x16x32_bf16 v[96:99], a[72:75], v[60:63], v[96:99]
    v_mfma_f32_16x16x32_bf16 v[100:103], a[76:79], v[60:63], v[100:103]
    ds_write_b128 v4, v[72:75] offset:2048
    s_waitcnt vmcnt(3)
    v_mfma_f32_16x16x32_bf16 v[84:87], a[80:83], v[16:19], v[84:87]
    v_mfma_f32_16x16x32_bf16 v[88:91], a[84:87], v[16:19], v[88:91]
    v_mfma_f32_16x16x32_bf16 v[92:95], a[88:91], v[16:19], v[92:95]
    v_mfma_f32_16x16x32_bf16 v[96:99], a[92:95], v[16:19], v[96:99]
    v_mfma_f32_16x16x32_bf16 v[100:103], a[96:99], v[16:19], v[100:103]
    ds_write_b128 v4, v[76:79] offset:3072
    s_waitcnt vmcnt(2)
    v_mfma_f32_16x16x32_bf16 v[84:87], a[100:103], v[20:23], v[84:87]
    v_mfma_f32_16x16x32_bf16 v[88:91], a[104:107], v[20:23], v[88:91]
    v_mfma_f32_16x16x32_bf16 v[92:95], a[108:111], v[20:23], v[92:95]
    v_mfma_f32_16x16x32_bf16 v[96:99], a[112:115], v[20:23], v[96:99]
    v_mfma_f32_16x16x32_bf16 v[100:103], a[116:119], v[20:23], v[100:103]
    ds_write_b128 v4, v[80:83] offset:4096
    s_waitcnt vmcnt(1)
    v_mfma_f32_16x16x32_bf16 v[84:87], a[120:123], v[24:27], v[84:87]
    v_mfma_f32_16x16x32_bf16 v[88:91], a[124:127], v[24:27], v[88:91]
    v_mfma_f32_16x16x32_bf16 v[92:95], a[128:131], v[24:27], v[92:95]
    v_mfma_f32_16x16x32_bf16 v[96:99], a[132:135], v[24:27], v[96:99]
    v_mfma_f32_16x16x32_bf16 v[100:103], a[136:139], v[24:27], v[100:103]
    s_waitcnt vmcnt(0)
    v_mfma_f32_16x16x32_bf16 v[84:87], a[140:143], v[28:31], v[84:87]
    v_mfma_f32_16x16x32_bf16 v[88:91], a[144:147], v[28:31], v[88:91]
    v_mfma_f32_16x16x32_bf16 v[92:95], a[148:151], v[28:31], v[92:95]
    v_mfma_f32_16x16x32_bf16 v[96:99], a[152:155], v[28:31], v[96:99]
    v_mfma_f32_16x16x32_bf16 v[100:103], a[156:159], v[28:31], v[100:103]
    s_mul_i32 s32, s53, 327680
    s_add_u32 s33, s32, s41
    s_nop 1
    ds_write_b128 v4, v[84:87] offset:5120
    ds_write_b128 v4, v[88:91] offset:6144
    ds_write_b128 v4, v[92:95] offset:7168
    ds_write_b128 v4, v[96:99] offset:8192
    ds_write_b128 v4, v[100:103] offset:9216
    s_waitcnt lgkmcnt(0)
    s_barrier
    ds_read_b128 v[16:19], v5 offset:0
    ds_read_b128 v[20:23], v5 offset:10240
    ds_read_b128 v[24:27], v5 offset:20480
    ds_read_b128 v[28:31], v5 offset:30720
    ds_read_b128 v[32:35], v5 offset:4096
    ds_read_b128 v[36:39], v5 offset:14336
    ds_read_b128 v[40:43], v5 offset:24576
    ds_read_b128 v[44:47], v5 offset:34816
    ds_read_b128 v[48:51], v5 offset:8192
    ds_read_b128 v[52:55], v5 offset:18432
    ds_read_b128 v[56:59], v5 offset:28672
    ds_read_b128 v[60:63], v5 offset:38912
    s_waitcnt lgkmcnt(8)
    s_add_u32 s34, s26, 0
    s_cmp_ge_u32 s34, 5
    s_cselect_b32 s35, 163520, 0
    s_lshl_b32 s34, s34, 6
    s_add_u32 s34, s34, s35
    s_add_u32 s34, s34, s33
    v_pk_add_f32 v[16:17], v[16:17], v[20:21]
    v_pk_add_f32 v[24:25], v[24:25], v[28:29]
    v_pk_add_f32 v[16:17], v[16:17], v[24:25]
    v_pk_add_f32 v[18:19], v[18:19], v[22:23]
    v_pk_add_f32 v[26:27], v[26:27], v[30:31]
    v_pk_add_f32 v[18:19], v[18:19], v[26:27]
    buffer_store_dwordx4 v[16:19], v6, s[4:7], s34 offen sc1
    s_waitcnt lgkmcnt(4)
    s_add_u32 s34, s26, 4
    s_cmp_ge_u32 s34, 5
    s_cselect_b32 s35, 163520, 0
    s_lshl_b32 s34, s34, 6
    s_add_u32 s34, s34, s35
    s_add_u32 s34, s34, s33
    v_pk_add_f32 v[32:33], v[32:33], v[36:37]
    v_pk_add_f32 v[40:41], v[40:41], v[44:45]
    v_pk_add_f32 v[32:33], v[32:33], v[40:41]
    v_pk_add_f32 v[34:35], v[34:35], v[38:39]
    v_pk_add_f32 v[42:43], v[42:43], v[46:47]
    v_pk_add_f32 v[34:35], v[34:35], v[42:43]
    buffer_store_dwordx4 v[32:35], v6, s[4:7], s34 offen sc1
    s_waitcnt lgkmcnt(0)
    s_cmp_ge_u32 s26, 2
    s_cbranch_scc1 L_wo2_244
    s_add_u32 s34, s26, 8
    s_cmp_ge_u32 s34, 5
    s_cselect_b32 s35, 163520, 0
    s_lshl_b32 s34, s34, 6
    s_add_u32 s34, s34, s35
    s_add_u32 s34, s34, s33
    v_pk_add_f32 v[48:49], v[48:49], v[52:53]
    v_pk_add_f32 v[56:57], v[56:57], v[60:61]
    v_pk_add_f32 v[48:49], v[48:49], v[56:57]
    v_pk_add_f32 v[50:51], v[50:51], v[54:55]
    v_pk_add_f32 v[58:59], v[58:59], v[62:63]
    v_pk_add_f32 v[50:51], v[50:51], v[58:59]
    buffer_store_dwordx4 v[48:51], v6, s[4:7], s34 offen sc1
L_wo2_244:
    s_waitcnt vmcnt(0)
    s_barrier
    s_cmp_lg_u32 s26, 0
    s_cbranch_scc1 L_lnskip_245
    s_mov_b64 exec, 1
    v_mov_b32 v11, s30
    buffer_store_dword v11, off, s[4:7], s36 sc1
    s_mov_b64 exec, -1
    s_mul_i32 s33, s53, 40960
    v_lshlrev_b32 v12, 1, v2
    v_add_u32 v13, 81920, v12
    v_add_u32 v14, 94208, v2
    ds_read_b32 v56, v14 offset:0
    ds_read_b32 v57, v14 offset:256
    ds_read_b32 v58, v14 offset:512
    ds_read_b32 v59, v14 offset:768
    ds_read_b32 v60, v14 offset:1024
    s_waitcnt lgkmcnt(0)
    ds_read_b64 v[64:65], v13 offset:0
    ds_read_b64 v[66:67], v13 offset:512
    ds_read_b64 v[68:69], v13 offset:1024
    ds_read_b64 v[70:71], v13 offset:1536
    ds_read_b64 v[72:73], v13 offset:2048
    ds_read_b64 v[74:75], v13 offset:2560
    ds_read_b64 v[76:77], v13 offset:3072
    ds_read_b64 v[78:79], v13 offset:3584
    ds_read_b64 v[80:81], v13 offset:4096
    ds_read_b64 v[82:83], v13 offset:4608
    ds_read_b64 v[84:85], v13 offset:5120
    ds_read_b64 v[86:87], v13 offset:5632
    ds_read_b64 v[88:89], v13 offset:6144
    ds_read_b64 v[90:91], v13 offset:6656
    ds_read_b64 v[92:93], v13 offset:7168
    s_add_u32 s34, s39, 3579904
    s_mov_b32 exec_lo, 4294967295
    s_mov_b32 exec_hi, 0
L_wf_246:
    buffer_load_dword v11, v2, s[4:7], s34 offen sc1
    s_waitcnt vmcnt(0)
    v_cmp_gt_u32 vcc, s30, v11
    s_cbranch_vccz L_wfd_247
    s_sub_u32 s31, s31, 1
    s_cbranch_scc1 L_exit
    s_branch L_wf_246
L_wfd_247:
    s_mov_b64 exec, -1
    s_add_u32 s60, s32, s42
    s_add_u32 s61, s60, 2560
    s_add_u32 s62, s60, 5120
    s_add_u32 s63, s60, 7680
    buffer_load_dwordx2 v[16:17], v12, s[4:7], s60 offen offset:0 sc1
    buffer_load_dwordx2 v[26:27], v12, s[4:7], s61 offen offset:0 sc1
    buffer_load_dwordx2 v[36:37], v12, s[4:7], s62 offen offset:0 sc1
    buffer_load_dwordx2 v[46:47], v12, s[4:7], s63 offen offset:0 sc1
    buffer_load_dwordx2 v[18:19], v12, s[4:7], s60 offen offset:512 sc1
    buffer_load_dwordx2 v[28:29], v12, s[4:7], s61 offen offset:512 sc1
    buffer_load_dwordx2 v[38:39], v12, s[4:7], s62 offen offset:512 sc1
    buffer_load_dwordx2 v[48:49], v12, s[4:7], s63 offen offset:512 sc1
    buffer_load_dwordx2 v[20:21], v12, s[4:7], s60 offen offset:1024 sc1
    buffer_load_dwordx2 v[30:31], v12, s[4:7], s61 offen offset:1024 sc1
    buffer_load_dwordx2 v[40:41], v12, s[4:7], s62 offen offset:1024 sc1
    buffer_load_dwordx2 v[50:51], v12, s[4:7], s63 offen offset:1024 sc1
    buffer_load_dwordx2 v[22:23], v12, s[4:7], s60 offen offset:1536 sc1
    buffer_load_dwordx2 v[32:33], v12, s[4:7], s61 offen offset:1536 sc1
    buffer_load_dwordx2 v[42:43], v12, s[4:7], s62 offen offset:1536 sc1
    buffer_load_dwordx2 v[52:53], v12, s[4:7], s63 offen offset:1536 sc1
    buffer_load_dwordx2 v[24:25], v12, s[4:7], s60 offen offset:2048 sc1
    buffer_load_dwordx2 v[34:35], v12, s[4:7], s61 offen offset:2048 sc1
    buffer_load_dwordx2 v[44:45], v12, s[4:7], s62 offen offset:2048 sc1
    buffer_load_dwordx2 v[54:55], v12, s[4:7], s63 offen offset:2048 sc1
    s_lshl_b32 s34, s33, 1
    s_add_u32 s34, s34, s44
    s_waitcnt lgkmcnt(0)
    s_waitcnt vmcnt(16)
    v_pk_add_f32 v[16:17], v[16:17], v[26:27]
    v_pk_add_f32 v[36:37], v[36:37], v[46:47]
    v_lshlrev_b32 v26, 16, v56
    v_and_b32 v27, 0xffff0000, v56
    v_pk_add_f32 v[16:17], v[16:17], v[36:37]
    v_pk_fma_f32 v[16:17], v[16:17], v[64:65], v[26:27]
    buffer_store_dwordx2 v[16:17], v12, s[4:7], s34 offen offset:0 sc1
    s_waitcnt vmcnt(13)
    v_pk_add_f32 v[18:19], v[18:19], v[28:29]
    v_pk_add_f32 v[38:39], v[38:39], v[48:49]
    v_lshlrev_b32 v28, 16, v57
    v_and_b32 v29, 0xffff0000, v57
    v_pk_add_f32 v[18:19], v[18:19], v[38:39]
    v_pk_fma_f32 v[18:19], v[18:19], v[66:67], v[28:29]
    buffer_store_dwordx2 v[18:19], v12, s[4:7], s34 offen offset:512 sc1
    s_waitcnt vmcnt(10)
    v_pk_add_f32 v[20:21], v[20:21], v[30:31]
    v_pk_add_f32 v[40:41], v[40:41], v[50:51]
    v_lshlrev_b32 v30, 16, v58
    v_and_b32 v31, 0xffff0000, v58
    v_pk_add_f32 v[20:21], v[20:21], v[40:41]
    v_pk_fma_f32 v[20:21], v[20:21], v[68:69], v[30:31]
    buffer_store_dwordx2 v[20:21], v12, s[4:7], s34 offen offset:1024 sc1
    s_waitcnt vmcnt(7)
    v_pk_add_f32 v[22:23], v[22:23], v[32:33]
    v_pk_add_f32 v[42:43], v[42:43], v[52:53]
    v_lshlrev_b32 v32, 16, v59
    v_and_b32 v33, 0xffff0000, v59
    v_pk_add_f32 v[22:23], v[22:23], v[42:43]
    v_pk_fma_f32 v[22:23], v[22:23], v[70:71], v[32:33]
    buffer_store_dwordx2 v[22:23], v12, s[4:7], s34 offen offset:1536 sc1
    s_waitcnt vmcnt(4)
    v_pk_add_f32 v[24:25], v[24:25], v[34:35]
    v_pk_add_f32 v[44:45], v[44:45], v[54:55]
    v_lshlrev_b32 v34, 16, v60
    v_and_b32 v35, 0xffff0000, v60
    v_pk_add_f32 v[24:25], v[24:25], v[44:45]
    v_pk_fma_f32 v[24:25], v[24:25], v[72:73], v[34:35]
    buffer_store_dwordx2 v[24:25], v12, s[4:7], s34 offen offset:2048 sc1
    v_add_f32 v94, v16, v17
    v_mul_f32 v95, v16, v16
    v_fmac_f32 v95, v17, v17
    v_add_f32 v94, v94, v18
    v_fmac_f32 v95, v18, v18
    v_add_f32 v94, v94, v19
    v_fmac_f32 v95, v19, v19
    v_add_f32 v94, v94, v20
    v_fmac_f32 v95, v20, v20
    v_add_f32 v94, v94, v21
    v_fmac_f32 v95, v21, v21
    v_add_f32 v94, v94, v22
    v_fmac_f32 v95, v22, v22
    v_add_f32 v94, v94, v23
    v_fmac_f32 v95, v23, v23
    v_add_f32 v94, v94, v24
    v_fmac_f32 v95, v24, v24
    v_add_f32 v94, v94, v25
    v_fmac_f32 v95, v25, v25
    s_nop 0
    v_add_f32_dpp v94, v94, v94 quad_perm:[1,0,3,2] row_mask:0xf bank_mask:0xf
    v_add_f32_dpp v95, v95, v95 quad_perm:[1,0,3,2] row_mask:0xf bank_mask:0xf
    s_nop 0
    v_add_f32_dpp v94, v94, v94 quad_perm:[2,3,0,1] row_mask:0xf bank_mask:0xf
    v_add_f32_dpp v95, v95, v95 quad_perm:[2,3,0,1] row_mask:0xf bank_mask:0xf
    s_nop 0
    v_add_f32_dpp v94, v94, v94 row_half_mirror row_mask:0xf bank_mask:0xf
    v_add_f32_dpp v95, v95, v95 row_half_mirror row_mask:0xf bank_mask:0xf
    s_nop 0
    v_add_f32_dpp v94, v94, v94 row_mirror row_mask:0xf bank_mask:0xf
    v_add_f32_dpp v95, v95, v95 row_mirror row_mask:0xf bank_mask:0xf
    v_mov_b32 v96, v94
    v_mov_b32 v97, v95
    s_nop 0
    v_permlane16_swap_b32 v94, v96
    v_permlane16_swap_b32 v95, v97
    v_add_f32 v94, v94, v96
    v_add_f32 v95, v95, v97
    v_mov_b32 v96, v94
    v_mov_b32 v97, v95
    s_nop 0
    v_permlane32_swap_b32 v94, v96
    v_permlane32_swap_b32 v95, v97
    v_add_f32 v94, v94, v96
    v_add_f32 v95, v95, v97
    v_mul_f32 v94, 986500301, v94
    v_mul_f32 v95, 986500301, v95
    v_fma_f32 v95, -v94, v94, v95
    v_max_f32 v95, 0, v95
    v_add_f32 v95, 925353388, v95
    v_rsq_f32 v95, v95
    s_nop 0
    v_mul_f32 v94, v94, v95
    v_fma_f32 v26, v16, v95, -v94
    v_fma_f32 v27, v17, v95, -v94
    v_fma_f32 v28, v18, v95, -v94
    v_fma_f32 v29, v19, v95, -v94
    v_fma_f32 v30, v20, v95, -v94
    v_fma_f32 v31, v21, v95, -v94
    v_fma_f32 v32, v22, v95, -v94
    v_fma_f32 v33, v23, v95, -v94
    v_fma_f32 v34, v24, v95, -v94
    v_fma_f32 v35, v25, v95, -v94
    v_pk_fma_f32 v[26:27], v[26:27], v[84:85], v[74:75]
    v_pk_fma_f32 v[28:29], v[28:29], v[86:87], v[76:77]
    v_pk_fma_f32 v[30:31], v[30:31], v[88:89], v[78:79]
    v_pk_fma_f32 v[32:33], v[32:33], v[90:91], v[80:81]
    v_pk_fma_f32 v[34:35], v[34:35], v[92:93], v[82:83]
    v_add_f32 v94, v26, v27
    v_mul_f32 v95, v26, v26
    v_fmac_f32 v95, v27, v27
    v_add_f32 v94, v94, v28
    v_fmac_f32 v95, v28, v28
    v_add_f32 v94, v94, v29
    v_fmac_f32 v95, v29, v29
    v_add_f32 v94, v94, v30
    v_fmac_f32 v95, v30, v30
    v_add_f32 v94, v94, v31
    v_fmac_f32 v95, v31, v31
    v_add_f32 v94, v94, v32
    v_fmac_f32 v95, v32, v32
    v_add_f32 v94, v94, v33
    v_fmac_f32 v95, v33, v33
    v_add_f32 v94, v94, v34
    v_fmac_f32 v95, v34, v34
    v_add_f32 v94, v94, v35
    v_fmac_f32 v95, v35, v35
    s_nop 0
    v_add_f32_dpp v94, v94, v94 quad_perm:[1,0,3,2] row_mask:0xf bank_mask:0xf
    v_add_f32_dpp v95, v95, v95 quad_perm:[1,0,3,2] row_mask:0xf bank_mask:0xf
    s_nop 0
    v_add_f32_dpp v94, v94, v94 quad_perm:[2,3,0,1] row_mask:0xf bank_mask:0xf
    v_add_f32_dpp v95, v95, v95 quad_perm:[2,3,0,1] row_mask:0xf bank_mask:0xf
    s_nop 0
    v_add_f32_dpp v94, v94, v94 row_half_mirror row_mask:0xf bank_mask:0xf
    v_add_f32_dpp v95, v95, v95 row_half_mirror row_mask:0xf bank_mask:0xf
    s_nop 0
    v_add_f32_dpp v94, v94, v94 row_mirror row_mask:0xf bank_mask:0xf
    v_add_f32_dpp v95, v95, v95 row_mirror row_mask:0xf bank_mask:0xf
    v_mov_b32 v96, v94
    v_mov_b32 v97, v95
    s_nop 0
    v_permlane16_swap_b32 v94, v96
    v_permlane16_swap_b32 v95, v97
    v_add_f32 v94, v94, v96
    v_add_f32 v95, v95, v97
    v_mov_b32 v96, v94
    v_mov_b32 v97, v95
    s_nop 0
    v_permlane32_swap_b32 v94, v96
    v_permlane32_swap_b32 v95, v97
    v_add_f32 v94, v94, v96
    v_add_f32 v95, v95, v97
    v_mul_f32 v94, 986500301, v94
    v_mul_f32 v95, 986500301, v95
    v_fma_f32 v95, -v94, v94, v95
    v_max_f32 v95, 0, v95
    v_add_f32 v95, 925353388, v95
    v_rsq_f32 v95, v95
    s_nop 0
    v_mul_f32 v94, v94, v95
    s_add_u32 s34, s33, s45
    v_fma_f32 v26, v26, v95, -v94
    v_fma_f32 v27, v27, v95, -v94
    v_cvt_pk_bf16_f32 v56, v26, v27
    buffer_store_dword v56, v7, s[4:7], s34 offen sc1
    s_add_u32 s34, s34, 8192
    v_fma_f32 v28, v28, v95, -v94
    v_fma_f32 v29, v29, v95, -v94
    v_cvt_pk_bf16_f32 v57, v28, v29
    buffer_store_dword v57, v7, s[4:7], s34 offen sc1
    s_add_u32 s34, s34, 8192
    v_fma_f32 v30, v30, v95, -v94
    v_fma_f32 v31, v31, v95, -v94
    v_cvt_pk_bf16_f32 v58, v30, v31
    buffer_store_dword v58, v7, s[4:7], s34 offen sc1
    s_add_u32 s34, s34, 8192
    v_fma_f32 v32, v32, v95, -v94
    v_fma_f32 v33, v33, v95, -v94
    v_cvt_pk_bf16_f32 v59, v32, v33
    buffer_store_dword v59, v7, s[4:7], s34 offen sc1
    s_add_u32 s34, s34, 8192
    v_fma_f32 v34, v34, v95, -v94
    v_fma_f32 v35, v35, v95, -v94
    v_cvt_pk_bf16_f32 v60, v34, v35
    buffer_store_dword v60, v7, s[4:7], s34 offen sc1
    s_waitcnt vmcnt(0)
    s_mov_b64 exec, 1
    v_mov_b32 v11, s30
    buffer_store_dword v11, off, s[4:7], s37 sc1
    s_mov_b64 exec, -1
    s_add_u32 s34, s39, 3580928
    s_mov_b32 exec_lo, 4294967295
    s_mov_b32 exec_hi, 0
L_wf_248:
    buffer_load_dword v11, v2, s[4:7], s34 offen sc1
    s_waitcnt vmcnt(0)
    v_cmp_gt_u32 vcc, s30, v11
    s_cbranch_vccz L_wfd_249
    s_sub_u32 s31, s31, 1
    s_cbranch_scc1 L_exit
    s_branch L_wf_248
L_wfd_249:
    s_mov_b64 exec, -1
L_lnskip_245:
    s_barrier
    s_mul_i32 s33, s53, 40960
    s_cmp_ge_u32 s25, 27
    s_cbranch_scc1 L_m1skip_250
    s_add_u32 s34, s33, s46
    s_add_u32 m0, s46, 40960
    s_add_u32 s60, s34, 7340032
    buffer_load_dwordx4 v1, s[4:7], s60 offen offset:0 sc1 lds
    buffer_load_dwordx4 v1, s[4:7], s60 offen offset:1024 sc1 lds
    s_add_u32 m0, s46, 49152
    s_add_u32 s60, s34, 7348224
    buffer_load_dwordx4 v1, s[4:7], s60 offen offset:0 sc1 lds
    buffer_load_dwordx4 v1, s[4:7], s60 offen offset:1024 sc1 lds
    s_add_u32 m0, s46, 57344
    s_add_u32 s60, s34, 7356416
    buffer_load_dwordx4 v1, s[4:7], s60 offen offset:0 sc1 lds
    buffer_load_dwordx4 v1, s[4:7], s60 offen offset:1024 sc1 lds
    s_add_u32 m0, s46, 65536
    s_add_u32 s60, s34, 7364608
    buffer_load_dwordx4 v1, s[4:7], s60 offen offset:0 sc1 lds
    buffer_load_dwordx4 v1, s[4:7], s60 offen offset:1024 sc1 lds
    s_add_u32 m0, s46, 73728
    s_add_u32 s60, s34, 7372800
    buffer_load_dwordx4 v1, s[4:7], s60 offen offset:0 sc1 lds
    buffer_load_dwordx4 v1, s[4:7], s60 offen offset:1024 sc1 lds
    v_lshrrev_b32 v12, 8, v1
    v_lshlrev_b32 v12, 4, v12
    s_lshl_b32 s35, s26, 6
    s_add_u32 s35, s35, 92160
    v_add_u32 v12, s35, v12
    ds_read_b128 v[72:75], v12
    v_xor_b32 v13, 64, v0
    v_xor_b32 v14, 0x80, v0
    v_xor_b32 v15, 0xc0, v0
    s_mul_i32 s34, s53, 110592
    s_add_u32 s60, s34, s47
    s_waitcnt vmcnt(6) lgkmcnt(0)
    s_barrier
    ds_read_b128 v[16:19], v0 offset:0
    ds_read_b128 v[20:23], v0 offset:4096
    ds_read_b128 v[24:27], v13 offset:0
    ds_read_b128 v[28:31], v13 offset:4096
    ds_read_b128 v[32:35], v14 offset:0
    ds_read_b128 v[36:39], v14 offset:4096
    ds_read_b128 v[40:43], v15 offset:0
    ds_read_b128 v[44:47], v15 offset:4096
    ds_read_b128 v[48:51], v0 offset:8192
    s_waitcnt lgkmcnt(8)
    v_mfma_f32_16x16x32_bf16 v[64:67], a[160:163], v[16:19], v[72:75]
    ds_read_b128 v[52:55], v0 offset:12288
    s_waitcnt lgkmcnt(8)
    v_mfma_f32_16x16x32_bf16 v[68:71], a[160:163], v[20:23], v[72:75]
    ds_read_b128 v[16:19], v13 offset:8192
    s_waitcnt lgkmcnt(8)
    v_mfma_f32_16x16x32_bf16 v[64:67], a[164:167], v[24:27], v[64:67]
    ds_read_b128 v[20:23], v13 offset:12288
    s_waitcnt lgkmcnt(8)
    v_mfma_f32_16x16x32_bf16 v[68:71], a[164:167], v[28:31], v[68:71]
    ds_read_b128 v[24:27], v14 offset:8192
    s_waitcnt lgkmcnt(8)
    v_mfma_f32_16x16x32_bf16 v[64:67], a[168:171], v[32:35], v[64:67]
    ds_read_b128 v[28:31], v14 offset:12288
    s_waitcnt lgkmcnt(8)
    v_mfma_f32_16x16x32_bf16 v[68:71], a[168:171], v[36:39], v[68:71]
    ds_read_b128 v[32:35], v15 offset:8192
    s_waitcnt lgkmcnt(8)
    v_mfma_f32_16x16x32_bf16 v[64:67], a[172:175], v[40:43], v[64:67]
    ds_read_b128 v[36:39], v15 offset:12288
    s_waitcnt lgkmcnt(8)
    v_mfma_f32_16x16x32_bf16 v[68:71], a[172:175], v[44:47], v[68:71]
    s_waitcnt vmcnt(2)
    s_barrier
    ds_read_b128 v[40:43], v0 offset:16384
    s_waitcnt lgkmcnt(8)
    v_mfma_f32_16x16x32_bf16 v[64:67], a[176:179], v[48:51], v[64:67]
    ds_read_b128 v[44:47], v0 offset:20480
    s_waitcnt lgkmcnt(8)
    v_mfma_f32_16x16x32_bf16 v[68:71], a[176:179], v[52:55], v[68:71]
    ds_read_b128 v[48:51], v13 offset:16384
    s_waitcnt lgkmcnt(8)
    v_mfma_f32_16x16x32_bf16 v[64:67], a[180:183], v[16:19], v[64:67]
    ds_read_b128 v[52:55], v13 offset:20480
    s_waitcnt lgkmcnt(8)
    v_mfma_f32_16x16x32_bf16 v[68:71], a[180:183], v[20:23], v[68:71]
    ds_read_b128 v[16:19], v14 offset:16384
    s_waitcnt lgkmcnt(8)
    v_mfma_f32_16x16x32_bf16 v[64:67], a[184:187], v[24:27], v[64:67]
    ds_read_b128 v[20:23], v14 offset:20480
    s_waitcnt lgkmcnt(8)
    v_mfma_f32_16x16x32_bf16 v[68:71], a[184:187], v[28:31], v[68:71]
    ds_read_b128 v[24:27], v15 offset:16384
    s_waitcnt lgkmcnt(8)
    v_mfma_f32_16x16x32_bf16 v[64:67], a[188:191], v[32:35], v[64:67]
    ds_read_b128 v[28:31], v15 offset:20480
    s_waitcnt lgkmcnt(8)
    v_mfma_f32_16x16x32_bf16 v[68:71], a[188:191], v[36:39], v[68:71]
    ds_read_b128 v[32:35], v0 offset:24576
    s_waitcnt lgkmcnt(8)
    v_mfma_f32_16x16x32_bf16 v[64:67], a[192:195], v[40:43], v[64:67]
    ds_read_b128 v[36:39], v0 offset:28672
    s_waitcnt lgkmcnt(8)
    v_mfma_f32_16x16x32_bf16 v[68:71], a[192:195], v[44:47], v[68:71]
    ds_read_b128 v[40:43], v13 offset:24576
    s_waitcnt lgkmcnt(8)
    v_mfma_f32_16x16x32_bf16 v[64:67], a[196:199], v[48:51], v[64:67]
    ds_read_b128 v[44:47], v13 offset:28672
    s_waitcnt lgkmcnt(8)
    v_mfma_f32_16x16x32_bf16 v[68:71], a[196:199], v[52:55], v[68:71]
    ds_read_b128 v[48:51], v14 offset:24576
    s_waitcnt lgkmcnt(8)
    v_mfma_f32_16x16x32_bf16 v[64:67], a[200:203], v[16:19], v[64:67]
    ds_read_b128 v[52:55], v14 offset:28672
    s_waitcnt lgkmcnt(8)
    v_mfma_f32_16x16x32_bf16 v[68:71], a[200:203], v[20:23], v[68:71]
    ds_read_b128 v[16:19], v15 offset:24576
    s_waitcnt lgkmcnt(8)
    v_mfma_f32_16x16x32_bf16 v[64:67], a[204:207], v[24:27], v[64:67]
    ds_read_b128 v[20:23], v15 offset:28672
    s_waitcnt lgkmcnt(8)
    v_mfma_f32_16x16x32_bf16 v[68:71], a[204:207], v[28:31], v[68:71]
    s_waitcnt vmcnt(0)
    s_barrier
    ds_read_b128 v[24:27], v0 offset:32768
    s_waitcnt lgkmcnt(8)
    v_mfma_f32_16x16x32_bf16 v[64:67], a[208:211], v[32:35], v[64:67]
    ds_read_b128 v[28:31], v0 offset:36864
    s_waitcnt lgkmcnt(8)
    v_mfma_f32_16x16x32_bf16 v[68:71], a[208:211], v[36:39], v[68:71]
    ds_read_b128 v[32:35], v13 offset:32768
    s_waitcnt lgkmcnt(8)
    v_mfma_f32_16x16x32_bf16 v[64:67], a[212:215], v[40:43], v[64:67]
    ds_read_b128 v[36:39], v13 offset:36864
    s_waitcnt lgkmcnt(8)
    v_mfma_f32_16x16x32_bf16 v[68:71], a[212:215], v[44:47], v[68:71]
    ds_read_b128 v[40:43], v14 offset:32768
    s_waitcnt lgkmcnt(8)
    v_mfma_f32_16x16x32_bf16 v[64:67], a[216:219], v[48:51], v[64:67]
    ds_read_b128 v[44:47], v14 offset:36864
    s_waitcnt lgkmcnt(8)
    v_mfma_f32_16x16x32_bf16 v[68:71], a[216:219], v[52:55], v[68:71]
    ds_read_b128 v[48:51], v15 offset:32768
    s_waitcnt lgkmcnt(8)
    v_mfma_f32_16x16x32_bf16 v[64:67], a[220:223], v[16:19], v[64:67]
    ds_read_b128 v[52:55], v15 offset:36864
    s_waitcnt lgkmcnt(8)
    v_mfma_f32_16x16x32_bf16 v[68:71], a[220:223], v[20:23], v[68:71]
    s_waitcnt lgkmcnt(7)
    v_mfma_f32_16x16x32_bf16 v[64:67], a[224:227], v[24:27], v[64:67]
    s_waitcnt lgkmcnt(6)
    v_mfma_f32_16x16x32_bf16 v[68:71], a[224:227], v[28:31], v[68:71]
    s_waitcnt lgkmcnt(5)
    v_mfma_f32_16x16x32_bf16 v[64:67], a[228:231], v[32:35], v[64:67]
    s_waitcnt lgkmcnt(4)
    v_mfma_f32_16x16x32_bf16 v[68:71], a[228:231], v[36:39], v[68:71]
    s_waitcnt lgkmcnt(3)
    v_mfma_f32_16x16x32_bf16 v[64:67], a[232:235], v[40:43], v[64:67]
    s_waitcnt lgkmcnt(2)
    v_mfma_f32_16x16x32_bf16 v[68:71], a[232:235], v[44:47], v[68:71]
    s_waitcnt lgkmcnt(1)
    v_mfma_f32_16x16x32_bf16 v[64:67], a[236:239], v[48:51], v[64:67]
    s_waitcnt lgkmcnt(0)
    v_mfma_f32_16x16x32_bf16 v[68:71], a[236:239], v[52:55], v[68:71]
    s_mov_b32 s62, 3184710632
    v_mov_b32 v12, 3222493025
    s_nop 3
    v_mul_f32 v76, v64, v64
    v_mul_f32 v77, v65, v65
    v_mul_f32 v78, v66, v66
    v_mul_f32 v79, v67, v67
    v_mul_f32 v80, v68, v68
    v_mul_f32 v81, v69, v69
    v_mul_f32 v82, v70, v70
    v_mul_f32 v83, v71, v71
    v_fma_f32 v76, v76, s62, v12
    v_fma_f32 v77, v77, s62, v12
    v_fma_f32 v78, v78, s62, v12
    v_fma_f32 v79, v79, s62, v12
    v_fma_f32 v80, v80, s62, v12
    v_fma_f32 v81, v81, s62, v12
    v_fma_f32 v82, v82, s62, v12
    v_fma_f32 v83, v83, s62, v12
    v_mul_f32 v76, v76, v64
    v_mul_f32 v77, v77, v65
    v_mul_f32 v78, v78, v66
    v_mul_f32 v79, v79, v67
    v_mul_f32 v80, v80, v68
    v_mul_f32 v81, v81, v69
    v_mul_f32 v82, v82, v70
    v_mul_f32 v83, v83, v71
    v_exp_f32 v76, v76
    v_exp_f32 v77, v77
    v_exp_f32 v78, v78
    v_exp_f32 v79, v79
    v_exp_f32 v80, v80
    v_exp_f32 v81, v81
    v_exp_f32 v82, v82
    v_exp_f32 v83, v83
    v_add_f32 v76, 1.0, v76
    v_add_f32 v77, 1.0, v77
    v_add_f32 v78, 1.0, v78
    v_add_f32 v79, 1.0, v79
    v_add_f32 v80, 1.0, v80
    v_add_f32 v81, 1.0, v81
    v_add_f32 v82, 1.0, v82
    v_add_f32 v83, 1.0, v83
    v_rcp_f32 v76, v76
    v_rcp_f32 v77, v77
    v_rcp_f32 v78, v78
    v_rcp_f32 v79, v79
    v_rcp_f32 v80, v80
    v_rcp_f32 v81, v81
    v_rcp_f32 v82, v82
    v_rcp_f32 v83, v83
    v_mul_f32 v76, v76, v64
    v_mul_f32 v77, v77, v65
    v_mul_f32 v78, v78, v66
    v_mul_f32 v79, v79, v67
    v_mul_f32 v80, v80, v68
    v_mul_f32 v81, v81, v69
    v_mul_f32 v82, v82, v70
    v_mul_f32 v83, v83, v71
    v_cvt_pk_bf16_f32 v64, v76, v77
    v_cvt_pk_bf16_f32 v65, v78, v79
    v_cvt_pk_bf16_f32 v66, v80, v81
    v_cvt_pk_bf16_f32 v67, v82, v83
    s_nop 0
    v_permlane16_swap_b32 v64, v66
    v_permlane16_swap_b32 v65, v67
    buffer_store_dwordx4 v[64:67], v8, s[4:7], s60 offen sc1
    s_waitcnt vmcnt(0)
    s_barrier
    s_cmp_lg_u32 s26, 0
    s_cbranch_scc1 L_m1skip_250
    s_mov_b64 exec, 1
    v_mov_b32 v11, s30
    buffer_store_dword v11, off, s[4:7], s38 sc1
    s_mov_b64 exec, -1
L_m1skip_250:
    s_lshl_b32 s34, s33, 1
    s_add_u32 s34, s34, s50
    buffer_load_dwordx4 v[84:87], v10, s[4:7], s34 offen sc1
    v_and_b32 v12, 48, v1
    s_lshl_b32 s35, s26, 6
    v_add_u32 v12, s35, v12
    s_mul_i32 s35, s56, 160
    v_add_u32 v13, s35, v12
    v_add_u32 v12, 81920, v12
    v_add_u32 v13, 81920, v13
    ds_read_b128 v[88:91], v12 offset:10496
    ds_read_b128 v[92:95], v13 offset:7680
    s_add_u32 s34, s39, 3581952
    s_mov_b32 exec_lo, 134217727
    s_mov_b32 exec_hi, 0
L_wf_252:
    buffer_load_dword v11, v2, s[4:7], s34 offen sc1
    s_waitcnt vmcnt(0)
    v_cmp_gt_u32 vcc, s30, v11
    s_cbranch_vccz L_wfd_253
    s_sub_u32 s31, s31, 1
    s_cbranch_scc1 L_exit
    s_branch L_wf_252
L_wfd_253:
    s_mov_b64 exec, -1
    s_mul_i32 s34, s53, 110592
    s_add_u32 s60, s34, s48
    s_add_u32 s61, s60, 4096
    s_add_u32 s62, s60, 8192
    s_add_u32 s63, s60, s49
    buffer_load_dwordx4 v[16:19], v1, s[4:7], s60 offen offset:0 sc1
    buffer_load_dwordx4 v[20:23], v1, s[4:7], s60 offen offset:1024 sc1
    buffer_load_dwordx4 v[24:27], v1, s[4:7], s60 offen offset:2048 sc1
    buffer_load_dwordx4 v[28:31], v1, s[4:7], s60 offen offset:3072 sc1
    buffer_load_dwordx4 v[32:35], v1, s[4:7], s61 offen offset:0 sc1
    buffer_load_dwordx4 v[36:39], v1, s[4:7], s61 offen offset:1024 sc1
    buffer_load_dwordx4 v[40:43], v1, s[4:7], s61 offen offset:2048 sc1
    buffer_load_dwordx4 v[44:47], v1, s[4:7], s61 offen offset:3072 sc1
    buffer_load_dwordx4 v[48:51], v1, s[4:7], s62 offen offset:0 sc1
    buffer_load_dwordx4 v[52:55], v1, s[4:7], s62 offen offset:1024 sc1
    buffer_load_dwordx4 v[56:59], v1, s[4:7], s62 offen offset:2048 sc1
    buffer_load_dwordx4 v[60:63], v1, s[4:7], s62 offen offset:3072 sc1
    buffer_load_dwordx4 v[64:67], v1, s[4:7], s63 offen offset:0 sc1
    buffer_load_dwordx4 v[68:71], v1, s[4:7], s63 offen offset:1024 sc1
    s_mov_b64 exec, 3
    buffer_load_dword v11, v3, s[4:7], s2 offen sc1
    s_mov_b64 exec, -1
    s_waitcnt vmcnt(14)
    v_mfma_f32_16x16x32_bf16 v[72:75], a[240:243], v[16:19], 0
    v_mfma_f32_16x16x32_bf16 v[76:79], a[244:247], v[16:19], 0
    v_mfma_f32_16x16x32_bf16 v[80:83], a[248:251], v[16:19], 0
    s_waitcnt vmcnt(13)
    v_mfma_f32_16x16x32_bf16 v[72:75], a[252:255], v[20:23], v[72:75]
    v_mfma_f32_16x16x32_bf16 v[76:79], v[104:107], v[20:23], v[76:79]
    v_mfma_f32_16x16x32_bf16 v[80:83], v[108:111], v[20:23], v[80:83]
    s_waitcnt vmcnt(12)
    v_mfma_f32_16x16x32_bf16 v[72:75], v[112:115], v[24:27], v[72:75]
    v_mfma_f32_16x16x32_bf16 v[76:79], v[116:119], v[24:27], v[76:79]
    v_mfma_f32_16x16x32_bf16 v[80:83], v[120:123], v[24:27], v[80:83]
    s_waitcnt vmcnt(11)
    v_mfma_f32_16x16x32_bf16 v[72:75], v[124:127], v[28:31], v[72:75]
    v_mfma_f32_16x16x32_bf16 v[76:79], v[128:131], v[28:31], v[76:79]
    v_mfma_f32_16x16x32_bf16 v[80:83], v[132:135], v[28:31], v[80:83]
    s_waitcnt vmcnt(10)
    v_mfma_f32_16x16x32_bf16 v[72:75], v[136:139], v[32:35], v[72:75]
    v_mfma_f32_16x16x32_bf16 v[76:79], v[140:143], v[32:35], v[76:79]
    v_mfma_f32_16x16x32_bf16 v[80:83], v[144:147], v[32:35], v[80:83]
    s_waitcnt vmcnt(9)
    v_mfma_f32_16x16x32_bf16 v[72:75], v[148:151], v[36:39], v[72:75]
    v_mfma_f32_16x16x32_bf16 v[76:79], v[152:155], v[36:39], v[76:79]
    v_mfma_f32_16x16x32_bf16 v[80:83], v[156:159], v[36:39], v[80:83]
    s_waitcnt vmcnt(8)
    v_mfma_f32_16x16x32_bf16 v[72:75], v[160:163], v[40:43], v[72:75]
    v_mfma_f32_16x16x32_bf16 v[76:79], v[164:167], v[40:43], v[76:79]
    v_mfma_f32_16x16x32_bf16 v[80:83], v[168:171], v[40:43], v[80:83]
    s_waitcnt vmcnt(7)
    v_mfma_f32_16x16x32_bf16 v[72:75], v[172:175], v[44:47], v[72:75]
    v_mfma_f32_16x16x32_bf16 v[76:79], v[176:179], v[44:47], v[76:79]
    v_mfma_f32_16x16x32_bf16 v[80:83], v[180:183], v[44:47], v[80:83]
    s_waitcnt vmcnt(6)
    v_mfma_f32_16x16x32_bf16 v[72:75], v[184:187], v[48:51], v[72:75]
    v_mfma_f32_16x16x32_bf16 v[76:79], v[188:191], v[48:51], v[76:79]
    v_mfma_f32_16x16x32_bf16 v[80:83], v[192:195], v[48:51], v[80:83]
    s_waitcnt vmcnt(5)
    v_mfma_f32_16x16x32_bf16 v[72:75], v[196:199], v[52:55], v[72:75]
    v_mfma_f32_16x16x32_bf16 v[76:79], v[200:203], v[52:55], v[76:79]
    v_mfma_f32_16x16x32_bf16 v[80:83], v[204:207], v[52:55], v[80:83]
    s_waitcnt vmcnt(4)
    v_mfma_f32_16x16x32_bf16 v[72:75], v[208:211], v[56:59], v[72:75]
    v_mfma_f32_16x16x32_bf16 v[76:79], v[212:215], v[56:59], v[76:79]
    v_mfma_f32_16x16x32_bf16 v[80:83], v[216:219], v[56:59], v[80:83]
    s_waitcnt vmcnt(3)
    v_mfma_f32_16x16x32_bf16 v[72:75], v[220:223], v[60:63], v[72:75]
    v_mfma_f32_16x16x32_bf16 v[76:79], v[224:227], v[60:63], v[76:79]
    v_mfma_f32_16x16x32_bf16 v[80:83], v[228:231], v[60:63], v[80:83]
    s_waitcnt vmcnt(2)
    v_mfma_f32_16x16x32_bf16 v[72:75], v[232:235], v[64:67], v[72:75]
    v_mfma_f32_16x16x32_bf16 v[76:79], v[236:239], v[64:67], v[76:79]
    v_mfma_f32_16x16x32_bf16 v[80:83], v[240:243], v[64:67], v[80:83]
    s_waitcnt vmcnt(1)
    v_mfma_f32_16x16x32_bf16 v[72:75], v[244:247], v[68:71], v[72:75]
    v_mfma_f32_16x16x32_bf16 v[76:79], v[248:251], v[68:71], v[76:79]
    v_mfma_f32_16x16x32_bf16 v[80:83], v[252:255], v[68:71], v[80:83]
    s_mul_i32 s33, s29, 40960
    s_add_u32 s34, s33, s51
    s_bitset0_b64 s[14:15], s29
    s_ff1_i32_b64 s12, s[14:15]
    s_mov_b32 s28, 0
    s_nop 0
    ds_write_b128 v4, v[72:75] offset:0
    ds_write_b128 v4, v[76:79] offset:1024
    ds_write_b128 v4, v[80:83] offset:2048
    s_mov_b64 exec, 3
    s_waitcnt vmcnt(0)
    v_cmp_ge_u32 vcc, s12, v11
    s_mov_b64 exec, -1
    s_cbranch_vccnz L_nopre_255
    s_lshl_b32 s32, s12, 18
    s_add_u32 s8, s32, s40
    s_add_u32 s9, s8, 4096
    s_add_u32 s10, s8, 131072
    s_add_u32 s11, s9, 131072
    s_mul_i32 s32, s12, 40960
    s_add_u32 s32, s32, s43
    s_lshl_b32 s35, s26, 10
    s_add_u32 s32, s32, s35
    s_add_u32 m0, s35, 94208
    s_nop 0
    buffer_load_dwordx4 v1, s[16:19], s32 offen lds
    buffer_load_dwordx4 v[16:19], v1, s[4:7], s8 offen offset:0 sc1
    buffer_load_dwordx4 v[20:23], v1, s[4:7], s8 offen offset:1024 sc1
    buffer_load_dwordx4 v[24:27], v1, s[4:7], s8 offen offset:2048 sc1
    buffer_load_dwordx4 v[28:31], v1, s[4:7], s8 offen offset:3072 sc1
    buffer_load_dwordx4 v[32:35], v1, s[4:7], s9 offen offset:0 sc1
    buffer_load_dwordx4 v[36:39], v1, s[4:7], s9 offen offset:1024 sc1
    buffer_load_dwordx4 v[40:43], v1, s[4:7], s9 offen offset:2048 sc1
    buffer_load_dwordx4 v[44:47], v1, s[4:7], s9 offen offset:3072 sc1
    buffer_load_dwordx4 v[48:51], v1, s[4:7], s10 offen offset:0 sc1
    buffer_load_dwordx4 v[52:55], v1, s[4:7], s10 offen offset:1024 sc1
    buffer_load_dwordx4 v[56:59], v1, s[4:7], s10 offen offset:2048 sc1
    buffer_load_dwordx4 v[60:63], v1, s[4:7], s10 offen offset:3072 sc1
    s_mov_b32 s28, 1
L_nopre_255:
    s_waitcnt lgkmcnt(0)
    s_barrier
    s_cmp_eq_u32 s26, 3
    s_cbranch_scc1 L_m2e_254
    ds_read_b128 v[64:67], v5 offset:0
    ds_read_b128 v[68:71], v5 offset:10240
    ds_read_b128 v[72:75], v5 offset:20480
    ds_read_b128 v[76:79], v5 offset:30720
    s_waitcnt lgkmcnt(0)
    v_pk_add_f32 v[64:65], v[64:65], v[68:69]
    v_pk_add_f32 v[72:73], v[72:73], v[76:77]
    v_pk_add_f32 v[64:65], v[64:65], v[88:89]
    v_pk_add_f32 v[64:65], v[64:65], v[72:73]
    v_pk_fma_f32 v[64:65], v[64:65], v[92:93], v[84:85]
    v_pk_add_f32 v[66:67], v[66:67], v[70:71]
    v_pk_add_f32 v[74:75], v[74:75], v[78:79]
    v_pk_add_f32 v[66:67], v[66:67], v[90:91]
    v_pk_add_f32 v[66:67], v[66:67], v[74:75]
    v_pk_fma_f32 v[66:67], v[66:67], v[94:95], v[86:87]
    v_cvt_pk_bf16_f32 v12, v64, v65
    v_cvt_pk_bf16_f32 v13, v66, v67
    s_mov_b64 exec, s[58:59]
    buffer_store_dwordx2 v[12:13], v9, s[20:23], s34 offen
    s_mov_b64 exec, -1
L_m2e_254:
    s_barrier
    s_mov_b32 s29, s12
    s_cmp_lt_u32 s29, 64
    s_cbranch_scc1 L_team_240
    s_branch L_exit
L_last:
    s_endpgm
.section .rodata,"a"
.p2align 6
.amdhsa_kernel adaLN_cond__memory_aug_recurrent_mem_tr__mixer_channel_mlp__prompt_kernel
  .amdhsa_next_free_vgpr 512
  .amdhsa_next_free_sgpr 102
  .amdhsa_accum_offset 256
  .amdhsa_group_segment_fixed_size 0
  .amdhsa_kernarg_size 136
  .amdhsa_user_sgpr_count 2
  .amdhsa_user_sgpr_kernarg_segment_ptr 1
  .amdhsa_system_sgpr_workgroup_id_x 1
.end_amdhsa_kernel
```
